```python
import torch

def _softmax(x, axis=-1):
    return torch.softmax(x, dim=axis)
def _gelu(x):
    return torch.nn.functional.gelu(x, approximate="tanh")
def _silu(x):
    return torch.nn.functional.silu(x)
def _sigmoid(x):
    return torch.sigmoid(x)
def _layernorm(x, axis=-1, eps=1e-5):
    m = x.mean(dim=axis, keepdim=True)
    v = x.var(dim=axis, keepdim=True, unbiased=False)
    return (x - m) / torch.sqrt(v + eps)
def _scatter_add(tgt, idx, src, axis=0):
    return tgt.clone().index_add_(axis, idx, src)
def _segment_sum(src, seg, n):
    out = torch.zeros((n,) + src.shape[1:], dtype=src.dtype)
    return out.index_add_(0, seg, src)
def _pad(x, pw):
    flat = tuple(v for pair in reversed(pw) for v in pair)
    return torch.nn.functional.pad(x, flat)

kernel_name = 'interleave_layers__sliding_block__dense_activation_squared_relu__prompt'

def setup_inputs():

    _w = (lambda a: (lambda t: t.to(torch.bfloat16) if t.is_floating_point() else t)(torch.as_tensor(a)))
    def _A_setup():
        B, S, D = 1, 2048, 640
        return {
            "x": _w((lambda *s: torch.randn(*s, dtype=torch.bfloat16) * 0.05)(B, S, D)),
            "wqkv": _w((lambda *s: torch.randn(*s, dtype=torch.bfloat16) * 0.05)(D, 3 * D)),
            "wo": _w((lambda *s: torch.randn(*s, dtype=torch.bfloat16) * 0.05)(D, D)),
        }
    _A_in = _A_setup()

    def _B_setup():
        B, S, D, F = 1, 2048, 640, 1728
        return {
            "x": _w((lambda *s: torch.randn(*s, dtype=torch.bfloat16) * 0.05)(B, S, D)),
            "w1": _w((lambda *s: torch.randn(*s, dtype=torch.bfloat16) * 0.05)(D, F)),
            "b1": _w((lambda *s: torch.randn(*s, dtype=torch.bfloat16) * 0.2)(F)),
            "w2": _w((lambda *s: torch.randn(*s, dtype=torch.bfloat16) * 0.05)(F, D)),
            "b2": _w((lambda *s: torch.randn(*s, dtype=torch.bfloat16) * 0.8)(D)),
        }
    _B_in = _B_setup()

    return {
        "A_x": _A_in["x"],
        "A_wqkv": _A_in["wqkv"],
        "A_wo": _A_in["wo"],
        "B_x": _B_in["x"],
        "B_w1": _B_in["w1"],
        "B_b1": _B_in["b1"],
        "B_w2": _B_in["w2"],
        "B_b2": _B_in["b2"],
    }

def reference(A_x, A_wqkv, A_wo, B_x, B_w1, B_b1, B_w2, B_b2):
    def _A_ref(x, wqkv, wo):
        B, S, D = x.shape
        H = 32; Dh = D // H; W = 256
        qkv = (lambda x, *d: x.permute(*d))((x @ wqkv).reshape(B, S, 3, H, Dh), 2, 0, 3, 1, 4)
        q, k, v = qkv[0], qkv[1], qkv[2]
        scores = torch.einsum("bhqd,bhkd->bhqk", q, k) * (Dh ** -0.5)
        idx = torch.arange(S)
        mask = (idx[:, None] - idx[None, :] >= 0) & (idx[:, None] - idx[None, :] < W)
        scores = torch.where(mask[None, None], scores, -1e9)
        p = _softmax(scores, axis=-1)
        o = torch.einsum("bhqk,bhkd->bhqd", p, v)
        return (lambda x, *d: x.permute(*d))(o, 0, 2, 1, 3).reshape(B, S, D) @ wo

    def _B_ref(x, w1, b1, w2, b2):
        h = torch.einsum("bsd,df->bsf", x, w1) + b1
        zero = torch.zeros_like(h)
        r = torch.where(h > zero, h, zero)
        h = r * r
        out = torch.einsum("bsf,fd->bsd", h, w2) + b2
        return out

    x = A_x
    x = x + _A_ref(_layernorm(x, axis=-1), A_wqkv, A_wo)
    x = x + _B_ref(_layernorm(x, axis=-1), B_w1, B_b1, B_w2, B_b2)
    x = x + _A_ref(_layernorm(x, axis=-1), A_wqkv, A_wo)
    x = x + _B_ref(_layernorm(x, axis=-1), B_w1, B_b1, B_w2, B_b2)
    return x
```

```asm
; @launch kernel=main_kernel grid=(256,1,1) block=(512,1,1) lds=163840
.amdgcn_target "amdgcn-amd-amdhsa--gfx950"
.text
.globl main_kernel
.p2align 8
.type main_kernel,@function
main_kernel:
  s_cmp_ge_u32 s2, 256
  s_cbranch_scc1 main_end
  s_load_dwordx2 s[8:9], s[0:1], 80
  s_load_dwordx2 s[12:13], s[0:1], 8
  s_load_dwordx2 s[16:17], s[0:1], 16
  s_load_dwordx2 s[20:21], s[0:1], 32
  s_load_dwordx2 s[84:85], s[0:1], 48
  s_load_dwordx2 s[88:89], s[0:1], 40
  s_load_dwordx2 s[92:93], s[0:1], 56
  s_load_dwordx2 s[96:97], s[0:1], 64
  s_load_dwordx2 s[80:81], s[0:1], 72
  s_load_dwordx2 s[6:7], s[0:1], 0
  v_lshrrev_b32 v2, 6, v0
  s_nop 1
  v_readfirstlane_b32 s3, v2
  s_mov_b32 s5, 0
  v_mov_b32 v59, 0
  s_waitcnt lgkmcnt(0)
  s_mov_b32 s10, 100663296
  s_mov_b32 s11, 0x20000
  s_mov_b32 s14, 2457600
  s_mov_b32 s15, 0x20000
  s_mov_b32 s18, 819200
  s_mov_b32 s19, 0x20000
  s_mov_b32 s22, 2211840
  s_mov_b32 s23, 0x20000
  s_mov_b32 s86, 2211840
  s_mov_b32 s87, 0x20000
  s_mov_b32 s90, 3456
  s_mov_b32 s91, 0x20000
  s_mov_b32 s94, 1280
  s_mov_b32 s95, 0x20000
  s_mov_b32 s98, 2621440
  s_mov_b32 s99, 0x20000
  s_mov_b32 s82, 256
  s_mov_b32 s83, 0x20000
main_loop:
  s_mov_b32 s48, s6
  s_mov_b32 s49, s7
  s_mov_b32 s50, 2621440
  s_mov_b32 s51, 0x20000
  s_cmp_eq_u32 s5, 0
  s_cbranch_scc1 main_xs2
  s_mov_b32 s48, s8
  s_mov_b32 s49, s9
  s_mov_b32 s50, s10
main_xs2:
  s_cmp_ge_u32 s2, 240
  s_cbranch_scc1 main_qkv1_aux
  v_and_b32 v1, 63, v0
  s_and_b32 s24, s2, 7
  s_lshr_b32 s25, s2, 3
  s_mov_b32 s28, s3
  s_lshr_b32 s26, s24, 2
  s_mul_i32 s26, s26, 30
  s_add_u32 s26, s26, s25
  s_and_b32 s24, s24, 3
  s_lshl_b32 s24, s24, 2
  s_and_b32 s25, s26, 3
  s_add_u32 s24, s24, s25
  s_lshr_b32 s25, s26, 2
  s_mul_i32 s26, s24, 344
  s_lshr_b32 s26, s26, 8
  s_add_u32 s27, s26, 1
  s_cmp_ge_u32 s28, 4
  s_cbranch_scc0 main_qkv1_cons
  s_sub_u32 s28, s28, 4
  s_lshl_b32 s29, s24, 11
  s_lshl_b32 s30, s28, 16
  s_add_u32 s29, s29, s30
  v_lshlrev_b32 v3, 4, v1
  v_add_u32 v4, s29, v3
  v_add_u32 v6, 30720, v4
  v_lshrrev_b32 v8, 4, v1
  v_and_b32 v9, 15, v1
  v_lshlrev_b32 v10, 2, v8
  v_xor_b32 v9, v9, v10
  v_mov_b32 v12, v4
  v_mov_b32 v13, v4
  v_mov_b32 v14, v6
  v_mov_b32 v15, v6
  s_add_u32 s34, s5, 20185088
  s_mov_b32 s39, 262144
  s_cmp_eq_u32 s5, 0
  s_cbranch_scc0 main_nat3
  s_mov_b32 s34, 0
  s_mov_b32 s39, 128
  s_lshl_b32 s29, s24, 7
  s_lshl_b32 s30, s28, 5
  s_add_u32 s29, s29, s30
  v_lshrrev_b32 v16, 3, v1
  v_and_b32 v17, 7, v1
  v_add_u32 v18, s30, v16
  v_xor_b32 v18, v18, v17
  v_lshlrev_b32 v18, 4, v18
  v_lshlrev_b32 v19, 11, v17
  v_add_u32 v20, v18, v19
  v_add_u32 v21, 65536, v20
  v_add_u32 v23, 131072, v20
  v_add_u32 v16, s29, v16
  v_mul_u32_u24 v16, 1280, v16
  v_lshlrev_b32 v17, 4, v17
  v_add_u32 v12, v16, v17
  v_add_u32 v13, 10240, v12
  v_add_u32 v14, 20480, v12
  v_add_u32 v15, 30720, v12
main_nat3:
  s_lshl_b32 s31, s28, 4
  v_add_u32 v8, s31, v8
  s_mov_b32 s32, 3840
  v_mul_lo_u32 v8, v8, s32
  v_lshlrev_b32 v9, 4, v9
  v_add_u32 v8, v8, v9
  s_lshl_b32 s31, s25, 8
  v_add_u32 v8, s31, v8
  v_add_u32 v9, 14336, v8
  v_add_u32 v10, 28672, v8
  v_add_u32 v11, 43008, v8
  s_lshl_b32 s33, s28, 12
  s_mov_b32 s35, 0
  s_add_u32 m0, s33, 16384
  s_nop 0
  buffer_load_dwordx4 v8, s[12:15], s35 offen offset:0 lds
  buffer_load_dwordx4 v9, s[12:15], s35 offen offset:1024 lds
  buffer_load_dwordx4 v10, s[12:15], s35 offen offset:2048 lds
  buffer_load_dwordx4 v11, s[12:15], s35 offen offset:3072 lds
  s_add_u32 s35, s35, 245760
  s_add_u32 m0, s33, 49152
  s_nop 0
  buffer_load_dwordx4 v8, s[12:15], s35 offen offset:0 lds
  buffer_load_dwordx4 v9, s[12:15], s35 offen offset:1024 lds
  buffer_load_dwordx4 v10, s[12:15], s35 offen offset:2048 lds
  buffer_load_dwordx4 v11, s[12:15], s35 offen offset:3072 lds
  s_add_u32 s35, s35, 245760
  s_add_u32 m0, s33, 81920
  s_nop 0
  buffer_load_dwordx4 v8, s[12:15], s35 offen offset:0 lds
  buffer_load_dwordx4 v9, s[12:15], s35 offen offset:1024 lds
  buffer_load_dwordx4 v10, s[12:15], s35 offen offset:2048 lds
  buffer_load_dwordx4 v11, s[12:15], s35 offen offset:3072 lds
  s_add_u32 s35, s35, 245760
  s_cmp_eq_u32 s5, 0
  s_cbranch_scc0 main_l1x4
  v_mov_b32 v64, 0
  v_mov_b32 v65, 0
  v_mov_b32 v66, 0
  v_mov_b32 v67, 0
  v_mov_b32 v68, 0
  v_mov_b32 v69, 0
  v_mov_b32 v70, 0
  v_mov_b32 v71, 0
  v_mov_b32 v72, 0
  v_mov_b32 v73, 0
  v_mov_b32 v74, 0
  v_mov_b32 v75, 0
  v_mov_b32 v76, 0
  v_mov_b32 v77, 0
  v_mov_b32 v78, 0
  v_mov_b32 v79, 0
  buffer_load_dwordx4 v[128:131], v12, s[48:51], s34 offen
  buffer_load_dwordx4 v[132:135], v13, s[48:51], s34 offen
  buffer_load_dwordx4 v[136:139], v14, s[48:51], s34 offen
  buffer_load_dwordx4 v[140:143], v15, s[48:51], s34 offen
  s_add_u32 s34, s34, 128
  buffer_load_dwordx4 v[144:147], v12, s[48:51], s34 offen
  buffer_load_dwordx4 v[148:151], v13, s[48:51], s34 offen
  buffer_load_dwordx4 v[152:155], v14, s[48:51], s34 offen
  buffer_load_dwordx4 v[156:159], v15, s[48:51], s34 offen
  s_add_u32 s34, s34, 128
  buffer_load_dwordx4 v[160:163], v12, s[48:51], s34 offen
  buffer_load_dwordx4 v[164:167], v13, s[48:51], s34 offen
  buffer_load_dwordx4 v[168:171], v14, s[48:51], s34 offen
  buffer_load_dwordx4 v[172:175], v15, s[48:51], s34 offen
  s_add_u32 s34, s34, 128
  buffer_load_dwordx4 v[176:179], v12, s[48:51], s34 offen
  buffer_load_dwordx4 v[180:183], v13, s[48:51], s34 offen
  buffer_load_dwordx4 v[184:187], v14, s[48:51], s34 offen
  buffer_load_dwordx4 v[188:191], v15, s[48:51], s34 offen
  s_add_u32 s34, s34, 128
  s_waitcnt vmcnt(12)
  ds_write_b128 v20, v[128:131] offset:0
  ds_write_b128 v20, v[132:135] offset:128
  ds_write_b128 v20, v[136:139] offset:256
  ds_write_b128 v20, v[140:143] offset:384
  v_lshlrev_b32 v96, 16, v128
  v_and_b32 v97, 0xffff0000, v128
  v_pk_add_f32 v[64:65], v[64:65], v[96:97]
  v_pk_fma_f32 v[72:73], v[96:97], v[96:97], v[72:73]
  v_lshlrev_b32 v98, 16, v129
  v_and_b32 v99, 0xffff0000, v129
  v_pk_add_f32 v[64:65], v[64:65], v[98:99]
  v_pk_fma_f32 v[72:73], v[98:99], v[98:99], v[72:73]
  v_lshlrev_b32 v96, 16, v130
  v_and_b32 v97, 0xffff0000, v130
  v_pk_add_f32 v[64:65], v[64:65], v[96:97]
  v_pk_fma_f32 v[72:73], v[96:97], v[96:97], v[72:73]
  v_lshlrev_b32 v98, 16, v131
  v_and_b32 v99, 0xffff0000, v131
  v_pk_add_f32 v[64:65], v[64:65], v[98:99]
  v_pk_fma_f32 v[72:73], v[98:99], v[98:99], v[72:73]
  v_lshlrev_b32 v96, 16, v132
  v_and_b32 v97, 0xffff0000, v132
  v_pk_add_f32 v[66:67], v[66:67], v[96:97]
  v_pk_fma_f32 v[74:75], v[96:97], v[96:97], v[74:75]
  v_lshlrev_b32 v98, 16, v133
  v_and_b32 v99, 0xffff0000, v133
  v_pk_add_f32 v[66:67], v[66:67], v[98:99]
  v_pk_fma_f32 v[74:75], v[98:99], v[98:99], v[74:75]
  v_lshlrev_b32 v96, 16, v134
  v_and_b32 v97, 0xffff0000, v134
  v_pk_add_f32 v[66:67], v[66:67], v[96:97]
  v_pk_fma_f32 v[74:75], v[96:97], v[96:97], v[74:75]
  v_lshlrev_b32 v98, 16, v135
  v_and_b32 v99, 0xffff0000, v135
  v_pk_add_f32 v[66:67], v[66:67], v[98:99]
  v_pk_fma_f32 v[74:75], v[98:99], v[98:99], v[74:75]
  v_lshlrev_b32 v96, 16, v136
  v_and_b32 v97, 0xffff0000, v136
  v_pk_add_f32 v[68:69], v[68:69], v[96:97]
  v_pk_fma_f32 v[76:77], v[96:97], v[96:97], v[76:77]
  v_lshlrev_b32 v98, 16, v137
  v_and_b32 v99, 0xffff0000, v137
  v_pk_add_f32 v[68:69], v[68:69], v[98:99]
  v_pk_fma_f32 v[76:77], v[98:99], v[98:99], v[76:77]
  v_lshlrev_b32 v96, 16, v138
  v_and_b32 v97, 0xffff0000, v138
  v_pk_add_f32 v[68:69], v[68:69], v[96:97]
  v_pk_fma_f32 v[76:77], v[96:97], v[96:97], v[76:77]
  v_lshlrev_b32 v98, 16, v139
  v_and_b32 v99, 0xffff0000, v139
  v_pk_add_f32 v[68:69], v[68:69], v[98:99]
  v_pk_fma_f32 v[76:77], v[98:99], v[98:99], v[76:77]
  v_lshlrev_b32 v96, 16, v140
  v_and_b32 v97, 0xffff0000, v140
  v_pk_add_f32 v[70:71], v[70:71], v[96:97]
  v_pk_fma_f32 v[78:79], v[96:97], v[96:97], v[78:79]
  v_lshlrev_b32 v98, 16, v141
  v_and_b32 v99, 0xffff0000, v141
  v_pk_add_f32 v[70:71], v[70:71], v[98:99]
  v_pk_fma_f32 v[78:79], v[98:99], v[98:99], v[78:79]
  v_lshlrev_b32 v96, 16, v142
  v_and_b32 v97, 0xffff0000, v142
  v_pk_add_f32 v[70:71], v[70:71], v[96:97]
  v_pk_fma_f32 v[78:79], v[96:97], v[96:97], v[78:79]
  v_lshlrev_b32 v98, 16, v143
  v_and_b32 v99, 0xffff0000, v143
  v_pk_add_f32 v[70:71], v[70:71], v[98:99]
  v_pk_fma_f32 v[78:79], v[98:99], v[98:99], v[78:79]
  s_waitcnt lgkmcnt(0)
  s_waitcnt vmcnt(24)
  s_barrier
  s_add_u32 m0, s33, 114688
  s_nop 0
  buffer_load_dwordx4 v8, s[12:15], s35 offen offset:0 lds
  buffer_load_dwordx4 v9, s[12:15], s35 offen offset:1024 lds
  buffer_load_dwordx4 v10, s[12:15], s35 offen offset:2048 lds
  buffer_load_dwordx4 v11, s[12:15], s35 offen offset:3072 lds
  s_add_u32 s35, s35, 245760
  buffer_load_dwordx4 v[128:131], v12, s[48:51], s34 offen
  buffer_load_dwordx4 v[132:135], v13, s[48:51], s34 offen
  buffer_load_dwordx4 v[136:139], v14, s[48:51], s34 offen
  buffer_load_dwordx4 v[140:143], v15, s[48:51], s34 offen
  s_add_u32 s34, s34, 128
  s_waitcnt vmcnt(16)
  ds_write_b128 v20, v[144:147] offset:32768
  ds_write_b128 v20, v[148:151] offset:32896
  ds_write_b128 v20, v[152:155] offset:33024
  ds_write_b128 v20, v[156:159] offset:33152
  v_lshlrev_b32 v96, 16, v144
  v_and_b32 v97, 0xffff0000, v144
  v_pk_add_f32 v[64:65], v[64:65], v[96:97]
  v_pk_fma_f32 v[72:73], v[96:97], v[96:97], v[72:73]
  v_lshlrev_b32 v98, 16, v145
  v_and_b32 v99, 0xffff0000, v145
  v_pk_add_f32 v[64:65], v[64:65], v[98:99]
  v_pk_fma_f32 v[72:73], v[98:99], v[98:99], v[72:73]
  v_lshlrev_b32 v96, 16, v146
  v_and_b32 v97, 0xffff0000, v146
  v_pk_add_f32 v[64:65], v[64:65], v[96:97]
  v_pk_fma_f32 v[72:73], v[96:97], v[96:97], v[72:73]
  v_lshlrev_b32 v98, 16, v147
  v_and_b32 v99, 0xffff0000, v147
  v_pk_add_f32 v[64:65], v[64:65], v[98:99]
  v_pk_fma_f32 v[72:73], v[98:99], v[98:99], v[72:73]
  v_lshlrev_b32 v96, 16, v148
  v_and_b32 v97, 0xffff0000, v148
  v_pk_add_f32 v[66:67], v[66:67], v[96:97]
  v_pk_fma_f32 v[74:75], v[96:97], v[96:97], v[74:75]
  v_lshlrev_b32 v98, 16, v149
  v_and_b32 v99, 0xffff0000, v149
  v_pk_add_f32 v[66:67], v[66:67], v[98:99]
  v_pk_fma_f32 v[74:75], v[98:99], v[98:99], v[74:75]
  v_lshlrev_b32 v96, 16, v150
  v_and_b32 v97, 0xffff0000, v150
  v_pk_add_f32 v[66:67], v[66:67], v[96:97]
  v_pk_fma_f32 v[74:75], v[96:97], v[96:97], v[74:75]
  v_lshlrev_b32 v98, 16, v151
  v_and_b32 v99, 0xffff0000, v151
  v_pk_add_f32 v[66:67], v[66:67], v[98:99]
  v_pk_fma_f32 v[74:75], v[98:99], v[98:99], v[74:75]
  v_lshlrev_b32 v96, 16, v152
  v_and_b32 v97, 0xffff0000, v152
  v_pk_add_f32 v[68:69], v[68:69], v[96:97]
  v_pk_fma_f32 v[76:77], v[96:97], v[96:97], v[76:77]
  v_lshlrev_b32 v98, 16, v153
  v_and_b32 v99, 0xffff0000, v153
  v_pk_add_f32 v[68:69], v[68:69], v[98:99]
  v_pk_fma_f32 v[76:77], v[98:99], v[98:99], v[76:77]
  v_lshlrev_b32 v96, 16, v154
  v_and_b32 v97, 0xffff0000, v154
  v_pk_add_f32 v[68:69], v[68:69], v[96:97]
  v_pk_fma_f32 v[76:77], v[96:97], v[96:97], v[76:77]
  v_lshlrev_b32 v98, 16, v155
  v_and_b32 v99, 0xffff0000, v155
  v_pk_add_f32 v[68:69], v[68:69], v[98:99]
  v_pk_fma_f32 v[76:77], v[98:99], v[98:99], v[76:77]
  v_lshlrev_b32 v96, 16, v156
  v_and_b32 v97, 0xffff0000, v156
  v_pk_add_f32 v[70:71], v[70:71], v[96:97]
  v_pk_fma_f32 v[78:79], v[96:97], v[96:97], v[78:79]
  v_lshlrev_b32 v98, 16, v157
  v_and_b32 v99, 0xffff0000, v157
  v_pk_add_f32 v[70:71], v[70:71], v[98:99]
  v_pk_fma_f32 v[78:79], v[98:99], v[98:99], v[78:79]
  v_lshlrev_b32 v96, 16, v158
  v_and_b32 v97, 0xffff0000, v158
  v_pk_add_f32 v[70:71], v[70:71], v[96:97]
  v_pk_fma_f32 v[78:79], v[96:97], v[96:97], v[78:79]
  v_lshlrev_b32 v98, 16, v159
  v_and_b32 v99, 0xffff0000, v159
  v_pk_add_f32 v[70:71], v[70:71], v[98:99]
  v_pk_fma_f32 v[78:79], v[98:99], v[98:99], v[78:79]
  s_waitcnt lgkmcnt(0)
  s_waitcnt vmcnt(28)
  s_barrier
  s_add_u32 m0, s33, 147456
  s_nop 0
  buffer_load_dwordx4 v8, s[12:15], s35 offen offset:0 lds
  buffer_load_dwordx4 v9, s[12:15], s35 offen offset:1024 lds
  buffer_load_dwordx4 v10, s[12:15], s35 offen offset:2048 lds
  buffer_load_dwordx4 v11, s[12:15], s35 offen offset:3072 lds
  s_add_u32 s35, s35, 245760
  buffer_load_dwordx4 v[144:147], v12, s[48:51], s34 offen
  buffer_load_dwordx4 v[148:151], v13, s[48:51], s34 offen
  buffer_load_dwordx4 v[152:155], v14, s[48:51], s34 offen
  buffer_load_dwordx4 v[156:159], v15, s[48:51], s34 offen
  s_add_u32 s34, s34, 128
  s_waitcnt vmcnt(20)
  ds_write_b128 v21, v[160:163] offset:0
  ds_write_b128 v21, v[164:167] offset:128
  ds_write_b128 v21, v[168:171] offset:256
  ds_write_b128 v21, v[172:175] offset:384
  v_lshlrev_b32 v96, 16, v160
  v_and_b32 v97, 0xffff0000, v160
  v_pk_add_f32 v[64:65], v[64:65], v[96:97]
  v_pk_fma_f32 v[72:73], v[96:97], v[96:97], v[72:73]
  v_lshlrev_b32 v98, 16, v161
  v_and_b32 v99, 0xffff0000, v161
  v_pk_add_f32 v[64:65], v[64:65], v[98:99]
  v_pk_fma_f32 v[72:73], v[98:99], v[98:99], v[72:73]
  v_lshlrev_b32 v96, 16, v162
  v_and_b32 v97, 0xffff0000, v162
  v_pk_add_f32 v[64:65], v[64:65], v[96:97]
  v_pk_fma_f32 v[72:73], v[96:97], v[96:97], v[72:73]
  v_lshlrev_b32 v98, 16, v163
  v_and_b32 v99, 0xffff0000, v163
  v_pk_add_f32 v[64:65], v[64:65], v[98:99]
  v_pk_fma_f32 v[72:73], v[98:99], v[98:99], v[72:73]
  v_lshlrev_b32 v96, 16, v164
  v_and_b32 v97, 0xffff0000, v164
  v_pk_add_f32 v[66:67], v[66:67], v[96:97]
  v_pk_fma_f32 v[74:75], v[96:97], v[96:97], v[74:75]
  v_lshlrev_b32 v98, 16, v165
  v_and_b32 v99, 0xffff0000, v165
  v_pk_add_f32 v[66:67], v[66:67], v[98:99]
  v_pk_fma_f32 v[74:75], v[98:99], v[98:99], v[74:75]
  v_lshlrev_b32 v96, 16, v166
  v_and_b32 v97, 0xffff0000, v166
  v_pk_add_f32 v[66:67], v[66:67], v[96:97]
  v_pk_fma_f32 v[74:75], v[96:97], v[96:97], v[74:75]
  v_lshlrev_b32 v98, 16, v167
  v_and_b32 v99, 0xffff0000, v167
  v_pk_add_f32 v[66:67], v[66:67], v[98:99]
  v_pk_fma_f32 v[74:75], v[98:99], v[98:99], v[74:75]
  v_lshlrev_b32 v96, 16, v168
  v_and_b32 v97, 0xffff0000, v168
  v_pk_add_f32 v[68:69], v[68:69], v[96:97]
  v_pk_fma_f32 v[76:77], v[96:97], v[96:97], v[76:77]
  v_lshlrev_b32 v98, 16, v169
  v_and_b32 v99, 0xffff0000, v169
  v_pk_add_f32 v[68:69], v[68:69], v[98:99]
  v_pk_fma_f32 v[76:77], v[98:99], v[98:99], v[76:77]
  v_lshlrev_b32 v96, 16, v170
  v_and_b32 v97, 0xffff0000, v170
  v_pk_add_f32 v[68:69], v[68:69], v[96:97]
  v_pk_fma_f32 v[76:77], v[96:97], v[96:97], v[76:77]
  v_lshlrev_b32 v98, 16, v171
  v_and_b32 v99, 0xffff0000, v171
  v_pk_add_f32 v[68:69], v[68:69], v[98:99]
  v_pk_fma_f32 v[76:77], v[98:99], v[98:99], v[76:77]
  v_lshlrev_b32 v96, 16, v172
  v_and_b32 v97, 0xffff0000, v172
  v_pk_add_f32 v[70:71], v[70:71], v[96:97]
  v_pk_fma_f32 v[78:79], v[96:97], v[96:97], v[78:79]
  v_lshlrev_b32 v98, 16, v173
  v_and_b32 v99, 0xffff0000, v173
  v_pk_add_f32 v[70:71], v[70:71], v[98:99]
  v_pk_fma_f32 v[78:79], v[98:99], v[98:99], v[78:79]
  v_lshlrev_b32 v96, 16, v174
  v_and_b32 v97, 0xffff0000, v174
  v_pk_add_f32 v[70:71], v[70:71], v[96:97]
  v_pk_fma_f32 v[78:79], v[96:97], v[96:97], v[78:79]
  v_lshlrev_b32 v98, 16, v175
  v_and_b32 v99, 0xffff0000, v175
  v_pk_add_f32 v[70:71], v[70:71], v[98:99]
  v_pk_fma_f32 v[78:79], v[98:99], v[98:99], v[78:79]
  s_waitcnt lgkmcnt(0)
  s_waitcnt vmcnt(32)
  s_barrier
  s_add_u32 m0, s33, 16384
  s_nop 0
  buffer_load_dwordx4 v8, s[12:15], s35 offen offset:0 lds
  buffer_load_dwordx4 v9, s[12:15], s35 offen offset:1024 lds
  buffer_load_dwordx4 v10, s[12:15], s35 offen offset:2048 lds
  buffer_load_dwordx4 v11, s[12:15], s35 offen offset:3072 lds
  s_add_u32 s35, s35, 245760
  buffer_load_dwordx4 v[160:163], v12, s[48:51], s34 offen
  buffer_load_dwordx4 v[164:167], v13, s[48:51], s34 offen
  buffer_load_dwordx4 v[168:171], v14, s[48:51], s34 offen
  buffer_load_dwordx4 v[172:175], v15, s[48:51], s34 offen
  s_add_u32 s34, s34, 128
  s_waitcnt vmcnt(24)
  ds_write_b128 v21, v[176:179] offset:32768
  ds_write_b128 v21, v[180:183] offset:32896
  ds_write_b128 v21, v[184:187] offset:33024
  ds_write_b128 v21, v[188:191] offset:33152
  v_lshlrev_b32 v96, 16, v176
  v_and_b32 v97, 0xffff0000, v176
  v_pk_add_f32 v[64:65], v[64:65], v[96:97]
  v_pk_fma_f32 v[72:73], v[96:97], v[96:97], v[72:73]
  v_lshlrev_b32 v98, 16, v177
  v_and_b32 v99, 0xffff0000, v177
  v_pk_add_f32 v[64:65], v[64:65], v[98:99]
  v_pk_fma_f32 v[72:73], v[98:99], v[98:99], v[72:73]
  v_lshlrev_b32 v96, 16, v178
  v_and_b32 v97, 0xffff0000, v178
  v_pk_add_f32 v[64:65], v[64:65], v[96:97]
  v_pk_fma_f32 v[72:73], v[96:97], v[96:97], v[72:73]
  v_lshlrev_b32 v98, 16, v179
  v_and_b32 v99, 0xffff0000, v179
  v_pk_add_f32 v[64:65], v[64:65], v[98:99]
  v_pk_fma_f32 v[72:73], v[98:99], v[98:99], v[72:73]
  v_lshlrev_b32 v96, 16, v180
  v_and_b32 v97, 0xffff0000, v180
  v_pk_add_f32 v[66:67], v[66:67], v[96:97]
  v_pk_fma_f32 v[74:75], v[96:97], v[96:97], v[74:75]
  v_lshlrev_b32 v98, 16, v181
  v_and_b32 v99, 0xffff0000, v181
  v_pk_add_f32 v[66:67], v[66:67], v[98:99]
  v_pk_fma_f32 v[74:75], v[98:99], v[98:99], v[74:75]
  v_lshlrev_b32 v96, 16, v182
  v_and_b32 v97, 0xffff0000, v182
  v_pk_add_f32 v[66:67], v[66:67], v[96:97]
  v_pk_fma_f32 v[74:75], v[96:97], v[96:97], v[74:75]
  v_lshlrev_b32 v98, 16, v183
  v_and_b32 v99, 0xffff0000, v183
  v_pk_add_f32 v[66:67], v[66:67], v[98:99]
  v_pk_fma_f32 v[74:75], v[98:99], v[98:99], v[74:75]
  v_lshlrev_b32 v96, 16, v184
  v_and_b32 v97, 0xffff0000, v184
  v_pk_add_f32 v[68:69], v[68:69], v[96:97]
  v_pk_fma_f32 v[76:77], v[96:97], v[96:97], v[76:77]
  v_lshlrev_b32 v98, 16, v185
  v_and_b32 v99, 0xffff0000, v185
  v_pk_add_f32 v[68:69], v[68:69], v[98:99]
  v_pk_fma_f32 v[76:77], v[98:99], v[98:99], v[76:77]
  v_lshlrev_b32 v96, 16, v186
  v_and_b32 v97, 0xffff0000, v186
  v_pk_add_f32 v[68:69], v[68:69], v[96:97]
  v_pk_fma_f32 v[76:77], v[96:97], v[96:97], v[76:77]
  v_lshlrev_b32 v98, 16, v187
  v_and_b32 v99, 0xffff0000, v187
  v_pk_add_f32 v[68:69], v[68:69], v[98:99]
  v_pk_fma_f32 v[76:77], v[98:99], v[98:99], v[76:77]
  v_lshlrev_b32 v96, 16, v188
  v_and_b32 v97, 0xffff0000, v188
  v_pk_add_f32 v[70:71], v[70:71], v[96:97]
  v_pk_fma_f32 v[78:79], v[96:97], v[96:97], v[78:79]
  v_lshlrev_b32 v98, 16, v189
  v_and_b32 v99, 0xffff0000, v189
  v_pk_add_f32 v[70:71], v[70:71], v[98:99]
  v_pk_fma_f32 v[78:79], v[98:99], v[98:99], v[78:79]
  v_lshlrev_b32 v96, 16, v190
  v_and_b32 v97, 0xffff0000, v190
  v_pk_add_f32 v[70:71], v[70:71], v[96:97]
  v_pk_fma_f32 v[78:79], v[96:97], v[96:97], v[78:79]
  v_lshlrev_b32 v98, 16, v191
  v_and_b32 v99, 0xffff0000, v191
  v_pk_add_f32 v[70:71], v[70:71], v[98:99]
  v_pk_fma_f32 v[78:79], v[98:99], v[98:99], v[78:79]
  s_waitcnt lgkmcnt(0)
  s_waitcnt vmcnt(20)
  s_barrier
  s_add_u32 m0, s33, 49152
  s_nop 0
  buffer_load_dwordx4 v8, s[12:15], s35 offen offset:0 lds
  buffer_load_dwordx4 v9, s[12:15], s35 offen offset:1024 lds
  buffer_load_dwordx4 v10, s[12:15], s35 offen offset:2048 lds
  buffer_load_dwordx4 v11, s[12:15], s35 offen offset:3072 lds
  s_add_u32 s35, s35, 245760
  buffer_load_dwordx4 v[176:179], v12, s[48:51], s34 offen
  buffer_load_dwordx4 v[180:183], v13, s[48:51], s34 offen
  buffer_load_dwordx4 v[184:187], v14, s[48:51], s34 offen
  buffer_load_dwordx4 v[188:191], v15, s[48:51], s34 offen
  s_add_u32 s34, s34, 128
  s_waitcnt vmcnt(24)
  ds_write_b128 v23, v[128:131] offset:0
  ds_write_b128 v23, v[132:135] offset:128
  ds_write_b128 v23, v[136:139] offset:256
  ds_write_b128 v23, v[140:143] offset:384
  v_lshlrev_b32 v96, 16, v128
  v_and_b32 v97, 0xffff0000, v128
  v_pk_add_f32 v[64:65], v[64:65], v[96:97]
  v_pk_fma_f32 v[72:73], v[96:97], v[96:97], v[72:73]
  v_lshlrev_b32 v98, 16, v129
  v_and_b32 v99, 0xffff0000, v129
  v_pk_add_f32 v[64:65], v[64:65], v[98:99]
  v_pk_fma_f32 v[72:73], v[98:99], v[98:99], v[72:73]
  v_lshlrev_b32 v96, 16, v130
  v_and_b32 v97, 0xffff0000, v130
  v_pk_add_f32 v[64:65], v[64:65], v[96:97]
  v_pk_fma_f32 v[72:73], v[96:97], v[96:97], v[72:73]
  v_lshlrev_b32 v98, 16, v131
  v_and_b32 v99, 0xffff0000, v131
  v_pk_add_f32 v[64:65], v[64:65], v[98:99]
  v_pk_fma_f32 v[72:73], v[98:99], v[98:99], v[72:73]
  v_lshlrev_b32 v96, 16, v132
  v_and_b32 v97, 0xffff0000, v132
  v_pk_add_f32 v[66:67], v[66:67], v[96:97]
  v_pk_fma_f32 v[74:75], v[96:97], v[96:97], v[74:75]
  v_lshlrev_b32 v98, 16, v133
  v_and_b32 v99, 0xffff0000, v133
  v_pk_add_f32 v[66:67], v[66:67], v[98:99]
  v_pk_fma_f32 v[74:75], v[98:99], v[98:99], v[74:75]
  v_lshlrev_b32 v96, 16, v134
  v_and_b32 v97, 0xffff0000, v134
  v_pk_add_f32 v[66:67], v[66:67], v[96:97]
  v_pk_fma_f32 v[74:75], v[96:97], v[96:97], v[74:75]
  v_lshlrev_b32 v98, 16, v135
  v_and_b32 v99, 0xffff0000, v135
  v_pk_add_f32 v[66:67], v[66:67], v[98:99]
  v_pk_fma_f32 v[74:75], v[98:99], v[98:99], v[74:75]
  v_lshlrev_b32 v96, 16, v136
  v_and_b32 v97, 0xffff0000, v136
  v_pk_add_f32 v[68:69], v[68:69], v[96:97]
  v_pk_fma_f32 v[76:77], v[96:97], v[96:97], v[76:77]
  v_lshlrev_b32 v98, 16, v137
  v_and_b32 v99, 0xffff0000, v137
  v_pk_add_f32 v[68:69], v[68:69], v[98:99]
  v_pk_fma_f32 v[76:77], v[98:99], v[98:99], v[76:77]
  v_lshlrev_b32 v96, 16, v138
  v_and_b32 v97, 0xffff0000, v138
  v_pk_add_f32 v[68:69], v[68:69], v[96:97]
  v_pk_fma_f32 v[76:77], v[96:97], v[96:97], v[76:77]
  v_lshlrev_b32 v98, 16, v139
  v_and_b32 v99, 0xffff0000, v139
  v_pk_add_f32 v[68:69], v[68:69], v[98:99]
  v_pk_fma_f32 v[76:77], v[98:99], v[98:99], v[76:77]
  v_lshlrev_b32 v96, 16, v140
  v_and_b32 v97, 0xffff0000, v140
  v_pk_add_f32 v[70:71], v[70:71], v[96:97]
  v_pk_fma_f32 v[78:79], v[96:97], v[96:97], v[78:79]
  v_lshlrev_b32 v98, 16, v141
  v_and_b32 v99, 0xffff0000, v141
  v_pk_add_f32 v[70:71], v[70:71], v[98:99]
  v_pk_fma_f32 v[78:79], v[98:99], v[98:99], v[78:79]
  v_lshlrev_b32 v96, 16, v142
  v_and_b32 v97, 0xffff0000, v142
  v_pk_add_f32 v[70:71], v[70:71], v[96:97]
  v_pk_fma_f32 v[78:79], v[96:97], v[96:97], v[78:79]
  v_lshlrev_b32 v98, 16, v143
  v_and_b32 v99, 0xffff0000, v143
  v_pk_add_f32 v[70:71], v[70:71], v[98:99]
  v_pk_fma_f32 v[78:79], v[98:99], v[98:99], v[78:79]
  s_waitcnt lgkmcnt(0)
  s_waitcnt vmcnt(20)
  s_barrier
  s_add_u32 m0, s33, 81920
  s_nop 0
  buffer_load_dwordx4 v8, s[12:15], s35 offen offset:0 lds
  buffer_load_dwordx4 v9, s[12:15], s35 offen offset:1024 lds
  buffer_load_dwordx4 v10, s[12:15], s35 offen offset:2048 lds
  buffer_load_dwordx4 v11, s[12:15], s35 offen offset:3072 lds
  s_add_u32 s35, s35, 245760
  buffer_load_dwordx4 v[128:131], v12, s[48:51], s34 offen
  buffer_load_dwordx4 v[132:135], v13, s[48:51], s34 offen
  buffer_load_dwordx4 v[136:139], v14, s[48:51], s34 offen
  buffer_load_dwordx4 v[140:143], v15, s[48:51], s34 offen
  s_add_u32 s34, s34, 128
  s_waitcnt vmcnt(24)
  ds_write_b128 v20, v[144:147] offset:0
  ds_write_b128 v20, v[148:151] offset:128
  ds_write_b128 v20, v[152:155] offset:256
  ds_write_b128 v20, v[156:159] offset:384
  v_lshlrev_b32 v96, 16, v144
  v_and_b32 v97, 0xffff0000, v144
  v_pk_add_f32 v[64:65], v[64:65], v[96:97]
  v_pk_fma_f32 v[72:73], v[96:97], v[96:97], v[72:73]
  v_lshlrev_b32 v98, 16, v145
  v_and_b32 v99, 0xffff0000, v145
  v_pk_add_f32 v[64:65], v[64:65], v[98:99]
  v_pk_fma_f32 v[72:73], v[98:99], v[98:99], v[72:73]
  v_lshlrev_b32 v96, 16, v146
  v_and_b32 v97, 0xffff0000, v146
  v_pk_add_f32 v[64:65], v[64:65], v[96:97]
  v_pk_fma_f32 v[72:73], v[96:97], v[96:97], v[72:73]
  v_lshlrev_b32 v98, 16, v147
  v_and_b32 v99, 0xffff0000, v147
  v_pk_add_f32 v[64:65], v[64:65], v[98:99]
  v_pk_fma_f32 v[72:73], v[98:99], v[98:99], v[72:73]
  v_lshlrev_b32 v96, 16, v148
  v_and_b32 v97, 0xffff0000, v148
  v_pk_add_f32 v[66:67], v[66:67], v[96:97]
  v_pk_fma_f32 v[74:75], v[96:97], v[96:97], v[74:75]
  v_lshlrev_b32 v98, 16, v149
  v_and_b32 v99, 0xffff0000, v149
  v_pk_add_f32 v[66:67], v[66:67], v[98:99]
  v_pk_fma_f32 v[74:75], v[98:99], v[98:99], v[74:75]
  v_lshlrev_b32 v96, 16, v150
  v_and_b32 v97, 0xffff0000, v150
  v_pk_add_f32 v[66:67], v[66:67], v[96:97]
  v_pk_fma_f32 v[74:75], v[96:97], v[96:97], v[74:75]
  v_lshlrev_b32 v98, 16, v151
  v_and_b32 v99, 0xffff0000, v151
  v_pk_add_f32 v[66:67], v[66:67], v[98:99]
  v_pk_fma_f32 v[74:75], v[98:99], v[98:99], v[74:75]
  v_lshlrev_b32 v96, 16, v152
  v_and_b32 v97, 0xffff0000, v152
  v_pk_add_f32 v[68:69], v[68:69], v[96:97]
  v_pk_fma_f32 v[76:77], v[96:97], v[96:97], v[76:77]
  v_lshlrev_b32 v98, 16, v153
  v_and_b32 v99, 0xffff0000, v153
  v_pk_add_f32 v[68:69], v[68:69], v[98:99]
  v_pk_fma_f32 v[76:77], v[98:99], v[98:99], v[76:77]
  v_lshlrev_b32 v96, 16, v154
  v_and_b32 v97, 0xffff0000, v154
  v_pk_add_f32 v[68:69], v[68:69], v[96:97]
  v_pk_fma_f32 v[76:77], v[96:97], v[96:97], v[76:77]
  v_lshlrev_b32 v98, 16, v155
  v_and_b32 v99, 0xffff0000, v155
  v_pk_add_f32 v[68:69], v[68:69], v[98:99]
  v_pk_fma_f32 v[76:77], v[98:99], v[98:99], v[76:77]
  v_lshlrev_b32 v96, 16, v156
  v_and_b32 v97, 0xffff0000, v156
  v_pk_add_f32 v[70:71], v[70:71], v[96:97]
  v_pk_fma_f32 v[78:79], v[96:97], v[96:97], v[78:79]
  v_lshlrev_b32 v98, 16, v157
  v_and_b32 v99, 0xffff0000, v157
  v_pk_add_f32 v[70:71], v[70:71], v[98:99]
  v_pk_fma_f32 v[78:79], v[98:99], v[98:99], v[78:79]
  v_lshlrev_b32 v96, 16, v158
  v_and_b32 v97, 0xffff0000, v158
  v_pk_add_f32 v[70:71], v[70:71], v[96:97]
  v_pk_fma_f32 v[78:79], v[96:97], v[96:97], v[78:79]
  v_lshlrev_b32 v98, 16, v159
  v_and_b32 v99, 0xffff0000, v159
  v_pk_add_f32 v[70:71], v[70:71], v[98:99]
  v_pk_fma_f32 v[78:79], v[98:99], v[98:99], v[78:79]
  s_waitcnt lgkmcnt(0)
  s_waitcnt vmcnt(20)
  s_barrier
  s_add_u32 m0, s33, 114688
  s_nop 0
  buffer_load_dwordx4 v8, s[12:15], s35 offen offset:0 lds
  buffer_load_dwordx4 v9, s[12:15], s35 offen offset:1024 lds
  buffer_load_dwordx4 v10, s[12:15], s35 offen offset:2048 lds
  buffer_load_dwordx4 v11, s[12:15], s35 offen offset:3072 lds
  s_add_u32 s35, s35, 245760
  buffer_load_dwordx4 v[144:147], v12, s[48:51], s34 offen
  buffer_load_dwordx4 v[148:151], v13, s[48:51], s34 offen
  buffer_load_dwordx4 v[152:155], v14, s[48:51], s34 offen
  buffer_load_dwordx4 v[156:159], v15, s[48:51], s34 offen
  s_add_u32 s34, s34, 128
  s_waitcnt vmcnt(24)
  ds_write_b128 v20, v[160:163] offset:32768
  ds_write_b128 v20, v[164:167] offset:32896
  ds_write_b128 v20, v[168:171] offset:33024
  ds_write_b128 v20, v[172:175] offset:33152
  v_lshlrev_b32 v96, 16, v160
  v_and_b32 v97, 0xffff0000, v160
  v_pk_add_f32 v[64:65], v[64:65], v[96:97]
  v_pk_fma_f32 v[72:73], v[96:97], v[96:97], v[72:73]
  v_lshlrev_b32 v98, 16, v161
  v_and_b32 v99, 0xffff0000, v161
  v_pk_add_f32 v[64:65], v[64:65], v[98:99]
  v_pk_fma_f32 v[72:73], v[98:99], v[98:99], v[72:73]
  v_lshlrev_b32 v96, 16, v162
  v_and_b32 v97, 0xffff0000, v162
  v_pk_add_f32 v[64:65], v[64:65], v[96:97]
  v_pk_fma_f32 v[72:73], v[96:97], v[96:97], v[72:73]
  v_lshlrev_b32 v98, 16, v163
  v_and_b32 v99, 0xffff0000, v163
  v_pk_add_f32 v[64:65], v[64:65], v[98:99]
  v_pk_fma_f32 v[72:73], v[98:99], v[98:99], v[72:73]
  v_lshlrev_b32 v96, 16, v164
  v_and_b32 v97, 0xffff0000, v164
  v_pk_add_f32 v[66:67], v[66:67], v[96:97]
  v_pk_fma_f32 v[74:75], v[96:97], v[96:97], v[74:75]
  v_lshlrev_b32 v98, 16, v165
  v_and_b32 v99, 0xffff0000, v165
  v_pk_add_f32 v[66:67], v[66:67], v[98:99]
  v_pk_fma_f32 v[74:75], v[98:99], v[98:99], v[74:75]
  v_lshlrev_b32 v96, 16, v166
  v_and_b32 v97, 0xffff0000, v166
  v_pk_add_f32 v[66:67], v[66:67], v[96:97]
  v_pk_fma_f32 v[74:75], v[96:97], v[96:97], v[74:75]
  v_lshlrev_b32 v98, 16, v167
  v_and_b32 v99, 0xffff0000, v167
  v_pk_add_f32 v[66:67], v[66:67], v[98:99]
  v_pk_fma_f32 v[74:75], v[98:99], v[98:99], v[74:75]
  v_lshlrev_b32 v96, 16, v168
  v_and_b32 v97, 0xffff0000, v168
  v_pk_add_f32 v[68:69], v[68:69], v[96:97]
  v_pk_fma_f32 v[76:77], v[96:97], v[96:97], v[76:77]
  v_lshlrev_b32 v98, 16, v169
  v_and_b32 v99, 0xffff0000, v169
  v_pk_add_f32 v[68:69], v[68:69], v[98:99]
  v_pk_fma_f32 v[76:77], v[98:99], v[98:99], v[76:77]
  v_lshlrev_b32 v96, 16, v170
  v_and_b32 v97, 0xffff0000, v170
  v_pk_add_f32 v[68:69], v[68:69], v[96:97]
  v_pk_fma_f32 v[76:77], v[96:97], v[96:97], v[76:77]
  v_lshlrev_b32 v98, 16, v171
  v_and_b32 v99, 0xffff0000, v171
  v_pk_add_f32 v[68:69], v[68:69], v[98:99]
  v_pk_fma_f32 v[76:77], v[98:99], v[98:99], v[76:77]
  v_lshlrev_b32 v96, 16, v172
  v_and_b32 v97, 0xffff0000, v172
  v_pk_add_f32 v[70:71], v[70:71], v[96:97]
  v_pk_fma_f32 v[78:79], v[96:97], v[96:97], v[78:79]
  v_lshlrev_b32 v98, 16, v173
  v_and_b32 v99, 0xffff0000, v173
  v_pk_add_f32 v[70:71], v[70:71], v[98:99]
  v_pk_fma_f32 v[78:79], v[98:99], v[98:99], v[78:79]
  v_lshlrev_b32 v96, 16, v174
  v_and_b32 v97, 0xffff0000, v174
  v_pk_add_f32 v[70:71], v[70:71], v[96:97]
  v_pk_fma_f32 v[78:79], v[96:97], v[96:97], v[78:79]
  v_lshlrev_b32 v98, 16, v175
  v_and_b32 v99, 0xffff0000, v175
  v_pk_add_f32 v[70:71], v[70:71], v[98:99]
  v_pk_fma_f32 v[78:79], v[98:99], v[98:99], v[78:79]
  s_waitcnt lgkmcnt(0)
  s_waitcnt vmcnt(20)
  s_barrier
  s_add_u32 m0, s33, 147456
  s_nop 0
  buffer_load_dwordx4 v8, s[12:15], s35 offen offset:0 lds
  buffer_load_dwordx4 v9, s[12:15], s35 offen offset:1024 lds
  buffer_load_dwordx4 v10, s[12:15], s35 offen offset:2048 lds
  buffer_load_dwordx4 v11, s[12:15], s35 offen offset:3072 lds
  s_add_u32 s35, s35, 245760
  s_waitcnt vmcnt(20)
  ds_write_b128 v21, v[176:179] offset:0
  ds_write_b128 v21, v[180:183] offset:128
  ds_write_b128 v21, v[184:187] offset:256
  ds_write_b128 v21, v[188:191] offset:384
  v_lshlrev_b32 v96, 16, v176
  v_and_b32 v97, 0xffff0000, v176
  v_pk_add_f32 v[64:65], v[64:65], v[96:97]
  v_pk_fma_f32 v[72:73], v[96:97], v[96:97], v[72:73]
  v_lshlrev_b32 v98, 16, v177
  v_and_b32 v99, 0xffff0000, v177
  v_pk_add_f32 v[64:65], v[64:65], v[98:99]
  v_pk_fma_f32 v[72:73], v[98:99], v[98:99], v[72:73]
  v_lshlrev_b32 v96, 16, v178
  v_and_b32 v97, 0xffff0000, v178
  v_pk_add_f32 v[64:65], v[64:65], v[96:97]
  v_pk_fma_f32 v[72:73], v[96:97], v[96:97], v[72:73]
  v_lshlrev_b32 v98, 16, v179
  v_and_b32 v99, 0xffff0000, v179
  v_pk_add_f32 v[64:65], v[64:65], v[98:99]
  v_pk_fma_f32 v[72:73], v[98:99], v[98:99], v[72:73]
  v_lshlrev_b32 v96, 16, v180
  v_and_b32 v97, 0xffff0000, v180
  v_pk_add_f32 v[66:67], v[66:67], v[96:97]
  v_pk_fma_f32 v[74:75], v[96:97], v[96:97], v[74:75]
  v_lshlrev_b32 v98, 16, v181
  v_and_b32 v99, 0xffff0000, v181
  v_pk_add_f32 v[66:67], v[66:67], v[98:99]
  v_pk_fma_f32 v[74:75], v[98:99], v[98:99], v[74:75]
  v_lshlrev_b32 v96, 16, v182
  v_and_b32 v97, 0xffff0000, v182
  v_pk_add_f32 v[66:67], v[66:67], v[96:97]
  v_pk_fma_f32 v[74:75], v[96:97], v[96:97], v[74:75]
  v_lshlrev_b32 v98, 16, v183
  v_and_b32 v99, 0xffff0000, v183
  v_pk_add_f32 v[66:67], v[66:67], v[98:99]
  v_pk_fma_f32 v[74:75], v[98:99], v[98:99], v[74:75]
  v_lshlrev_b32 v96, 16, v184
  v_and_b32 v97, 0xffff0000, v184
  v_pk_add_f32 v[68:69], v[68:69], v[96:97]
  v_pk_fma_f32 v[76:77], v[96:97], v[96:97], v[76:77]
  v_lshlrev_b32 v98, 16, v185
  v_and_b32 v99, 0xffff0000, v185
  v_pk_add_f32 v[68:69], v[68:69], v[98:99]
  v_pk_fma_f32 v[76:77], v[98:99], v[98:99], v[76:77]
  v_lshlrev_b32 v96, 16, v186
  v_and_b32 v97, 0xffff0000, v186
  v_pk_add_f32 v[68:69], v[68:69], v[96:97]
  v_pk_fma_f32 v[76:77], v[96:97], v[96:97], v[76:77]
  v_lshlrev_b32 v98, 16, v187
  v_and_b32 v99, 0xffff0000, v187
  v_pk_add_f32 v[68:69], v[68:69], v[98:99]
  v_pk_fma_f32 v[76:77], v[98:99], v[98:99], v[76:77]
  v_lshlrev_b32 v96, 16, v188
  v_and_b32 v97, 0xffff0000, v188
  v_pk_add_f32 v[70:71], v[70:71], v[96:97]
  v_pk_fma_f32 v[78:79], v[96:97], v[96:97], v[78:79]
  v_lshlrev_b32 v98, 16, v189
  v_and_b32 v99, 0xffff0000, v189
  v_pk_add_f32 v[70:71], v[70:71], v[98:99]
  v_pk_fma_f32 v[78:79], v[98:99], v[98:99], v[78:79]
  v_lshlrev_b32 v96, 16, v190
  v_and_b32 v97, 0xffff0000, v190
  v_pk_add_f32 v[70:71], v[70:71], v[96:97]
  v_pk_fma_f32 v[78:79], v[96:97], v[96:97], v[78:79]
  v_lshlrev_b32 v98, 16, v191
  v_and_b32 v99, 0xffff0000, v191
  v_pk_add_f32 v[70:71], v[70:71], v[98:99]
  v_pk_fma_f32 v[78:79], v[98:99], v[98:99], v[78:79]
  s_waitcnt lgkmcnt(0)
  s_waitcnt vmcnt(16)
  s_barrier
  s_waitcnt vmcnt(12)
  ds_write_b128 v21, v[128:131] offset:32768
  ds_write_b128 v21, v[132:135] offset:32896
  ds_write_b128 v21, v[136:139] offset:33024
  ds_write_b128 v21, v[140:143] offset:33152
  v_lshlrev_b32 v96, 16, v128
  v_and_b32 v97, 0xffff0000, v128
  v_pk_add_f32 v[64:65], v[64:65], v[96:97]
  v_pk_fma_f32 v[72:73], v[96:97], v[96:97], v[72:73]
  v_lshlrev_b32 v98, 16, v129
  v_and_b32 v99, 0xffff0000, v129
  v_pk_add_f32 v[64:65], v[64:65], v[98:99]
  v_pk_fma_f32 v[72:73], v[98:99], v[98:99], v[72:73]
  v_lshlrev_b32 v96, 16, v130
  v_and_b32 v97, 0xffff0000, v130
  v_pk_add_f32 v[64:65], v[64:65], v[96:97]
  v_pk_fma_f32 v[72:73], v[96:97], v[96:97], v[72:73]
  v_lshlrev_b32 v98, 16, v131
  v_and_b32 v99, 0xffff0000, v131
  v_pk_add_f32 v[64:65], v[64:65], v[98:99]
  v_pk_fma_f32 v[72:73], v[98:99], v[98:99], v[72:73]
  v_lshlrev_b32 v96, 16, v132
  v_and_b32 v97, 0xffff0000, v132
  v_pk_add_f32 v[66:67], v[66:67], v[96:97]
  v_pk_fma_f32 v[74:75], v[96:97], v[96:97], v[74:75]
  v_lshlrev_b32 v98, 16, v133
  v_and_b32 v99, 0xffff0000, v133
  v_pk_add_f32 v[66:67], v[66:67], v[98:99]
  v_pk_fma_f32 v[74:75], v[98:99], v[98:99], v[74:75]
  v_lshlrev_b32 v96, 16, v134
  v_and_b32 v97, 0xffff0000, v134
  v_pk_add_f32 v[66:67], v[66:67], v[96:97]
  v_pk_fma_f32 v[74:75], v[96:97], v[96:97], v[74:75]
  v_lshlrev_b32 v98, 16, v135
  v_and_b32 v99, 0xffff0000, v135
  v_pk_add_f32 v[66:67], v[66:67], v[98:99]
  v_pk_fma_f32 v[74:75], v[98:99], v[98:99], v[74:75]
  v_lshlrev_b32 v96, 16, v136
  v_and_b32 v97, 0xffff0000, v136
  v_pk_add_f32 v[68:69], v[68:69], v[96:97]
  v_pk_fma_f32 v[76:77], v[96:97], v[96:97], v[76:77]
  v_lshlrev_b32 v98, 16, v137
  v_and_b32 v99, 0xffff0000, v137
  v_pk_add_f32 v[68:69], v[68:69], v[98:99]
  v_pk_fma_f32 v[76:77], v[98:99], v[98:99], v[76:77]
  v_lshlrev_b32 v96, 16, v138
  v_and_b32 v97, 0xffff0000, v138
  v_pk_add_f32 v[68:69], v[68:69], v[96:97]
  v_pk_fma_f32 v[76:77], v[96:97], v[96:97], v[76:77]
  v_lshlrev_b32 v98, 16, v139
  v_and_b32 v99, 0xffff0000, v139
  v_pk_add_f32 v[68:69], v[68:69], v[98:99]
  v_pk_fma_f32 v[76:77], v[98:99], v[98:99], v[76:77]
  v_lshlrev_b32 v96, 16, v140
  v_and_b32 v97, 0xffff0000, v140
  v_pk_add_f32 v[70:71], v[70:71], v[96:97]
  v_pk_fma_f32 v[78:79], v[96:97], v[96:97], v[78:79]
  v_lshlrev_b32 v98, 16, v141
  v_and_b32 v99, 0xffff0000, v141
  v_pk_add_f32 v[70:71], v[70:71], v[98:99]
  v_pk_fma_f32 v[78:79], v[98:99], v[98:99], v[78:79]
  v_lshlrev_b32 v96, 16, v142
  v_and_b32 v97, 0xffff0000, v142
  v_pk_add_f32 v[70:71], v[70:71], v[96:97]
  v_pk_fma_f32 v[78:79], v[96:97], v[96:97], v[78:79]
  v_lshlrev_b32 v98, 16, v143
  v_and_b32 v99, 0xffff0000, v143
  v_pk_add_f32 v[70:71], v[70:71], v[98:99]
  v_pk_fma_f32 v[78:79], v[98:99], v[98:99], v[78:79]
  s_waitcnt lgkmcnt(0)
  s_waitcnt vmcnt(8)
  s_barrier
  s_waitcnt vmcnt(4)
  ds_write_b128 v23, v[144:147] offset:0
  ds_write_b128 v23, v[148:151] offset:128
  ds_write_b128 v23, v[152:155] offset:256
  ds_write_b128 v23, v[156:159] offset:384
  v_lshlrev_b32 v96, 16, v144
  v_and_b32 v97, 0xffff0000, v144
  v_pk_add_f32 v[64:65], v[64:65], v[96:97]
  v_pk_fma_f32 v[72:73], v[96:97], v[96:97], v[72:73]
  v_lshlrev_b32 v98, 16, v145
  v_and_b32 v99, 0xffff0000, v145
  v_pk_add_f32 v[64:65], v[64:65], v[98:99]
  v_pk_fma_f32 v[72:73], v[98:99], v[98:99], v[72:73]
  v_lshlrev_b32 v96, 16, v146
  v_and_b32 v97, 0xffff0000, v146
  v_pk_add_f32 v[64:65], v[64:65], v[96:97]
  v_pk_fma_f32 v[72:73], v[96:97], v[96:97], v[72:73]
  v_lshlrev_b32 v98, 16, v147
  v_and_b32 v99, 0xffff0000, v147
  v_pk_add_f32 v[64:65], v[64:65], v[98:99]
  v_pk_fma_f32 v[72:73], v[98:99], v[98:99], v[72:73]
  v_lshlrev_b32 v96, 16, v148
  v_and_b32 v97, 0xffff0000, v148
  v_pk_add_f32 v[66:67], v[66:67], v[96:97]
  v_pk_fma_f32 v[74:75], v[96:97], v[96:97], v[74:75]
  v_lshlrev_b32 v98, 16, v149
  v_and_b32 v99, 0xffff0000, v149
  v_pk_add_f32 v[66:67], v[66:67], v[98:99]
  v_pk_fma_f32 v[74:75], v[98:99], v[98:99], v[74:75]
  v_lshlrev_b32 v96, 16, v150
  v_and_b32 v97, 0xffff0000, v150
  v_pk_add_f32 v[66:67], v[66:67], v[96:97]
  v_pk_fma_f32 v[74:75], v[96:97], v[96:97], v[74:75]
  v_lshlrev_b32 v98, 16, v151
  v_and_b32 v99, 0xffff0000, v151
  v_pk_add_f32 v[66:67], v[66:67], v[98:99]
  v_pk_fma_f32 v[74:75], v[98:99], v[98:99], v[74:75]
  v_lshlrev_b32 v96, 16, v152
  v_and_b32 v97, 0xffff0000, v152
  v_pk_add_f32 v[68:69], v[68:69], v[96:97]
  v_pk_fma_f32 v[76:77], v[96:97], v[96:97], v[76:77]
  v_lshlrev_b32 v98, 16, v153
  v_and_b32 v99, 0xffff0000, v153
  v_pk_add_f32 v[68:69], v[68:69], v[98:99]
  v_pk_fma_f32 v[76:77], v[98:99], v[98:99], v[76:77]
  v_lshlrev_b32 v96, 16, v154
  v_and_b32 v97, 0xffff0000, v154
  v_pk_add_f32 v[68:69], v[68:69], v[96:97]
  v_pk_fma_f32 v[76:77], v[96:97], v[96:97], v[76:77]
  v_lshlrev_b32 v98, 16, v155
  v_and_b32 v99, 0xffff0000, v155
  v_pk_add_f32 v[68:69], v[68:69], v[98:99]
  v_pk_fma_f32 v[76:77], v[98:99], v[98:99], v[76:77]
  v_lshlrev_b32 v96, 16, v156
  v_and_b32 v97, 0xffff0000, v156
  v_pk_add_f32 v[70:71], v[70:71], v[96:97]
  v_pk_fma_f32 v[78:79], v[96:97], v[96:97], v[78:79]
  v_lshlrev_b32 v98, 16, v157
  v_and_b32 v99, 0xffff0000, v157
  v_pk_add_f32 v[70:71], v[70:71], v[98:99]
  v_pk_fma_f32 v[78:79], v[98:99], v[98:99], v[78:79]
  v_lshlrev_b32 v96, 16, v158
  v_and_b32 v97, 0xffff0000, v158
  v_pk_add_f32 v[70:71], v[70:71], v[96:97]
  v_pk_fma_f32 v[78:79], v[96:97], v[96:97], v[78:79]
  v_lshlrev_b32 v98, 16, v159
  v_and_b32 v99, 0xffff0000, v159
  v_pk_add_f32 v[70:71], v[70:71], v[98:99]
  v_pk_fma_f32 v[78:79], v[98:99], v[98:99], v[78:79]
  s_waitcnt lgkmcnt(0)
  s_waitcnt vmcnt(0)
  s_barrier
  v_add_f32 v80, v64, v65
  v_add_f32 v81, v72, v73
  v_add_f32 v82, v66, v67
  v_add_f32 v83, v74, v75
  v_add_f32 v84, v68, v69
  v_add_f32 v85, v76, v77
  v_add_f32 v86, v70, v71
  v_add_f32 v87, v78, v79
  v_xor_b32 v22, 1, v1
  v_lshlrev_b32 v22, 2, v22
  ds_bpermute_b32 v88, v22, v80
  ds_bpermute_b32 v89, v22, v81
  ds_bpermute_b32 v90, v22, v82
  ds_bpermute_b32 v91, v22, v83
  ds_bpermute_b32 v92, v22, v84
  ds_bpermute_b32 v93, v22, v85
  ds_bpermute_b32 v94, v22, v86
  ds_bpermute_b32 v95, v22, v87
  s_waitcnt lgkmcnt(0)
  v_add_f32 v80, v80, v88
  v_add_f32 v81, v81, v89
  v_add_f32 v82, v82, v90
  v_add_f32 v83, v83, v91
  v_add_f32 v84, v84, v92
  v_add_f32 v85, v85, v93
  v_add_f32 v86, v86, v94
  v_add_f32 v87, v87, v95
  v_xor_b32 v22, 2, v1
  v_lshlrev_b32 v22, 2, v22
  ds_bpermute_b32 v88, v22, v80
  ds_bpermute_b32 v89, v22, v81
  ds_bpermute_b32 v90, v22, v82
  ds_bpermute_b32 v91, v22, v83
  ds_bpermute_b32 v92, v22, v84
  ds_bpermute_b32 v93, v22, v85
  ds_bpermute_b32 v94, v22, v86
  ds_bpermute_b32 v95, v22, v87
  s_waitcnt lgkmcnt(0)
  v_add_f32 v80, v80, v88
  v_add_f32 v81, v81, v89
  v_add_f32 v82, v82, v90
  v_add_f32 v83, v83, v91
  v_add_f32 v84, v84, v92
  v_add_f32 v85, v85, v93
  v_add_f32 v86, v86, v94
  v_add_f32 v87, v87, v95
  v_xor_b32 v22, 4, v1
  v_lshlrev_b32 v22, 2, v22
  ds_bpermute_b32 v88, v22, v80
  ds_bpermute_b32 v89, v22, v81
  ds_bpermute_b32 v90, v22, v82
  ds_bpermute_b32 v91, v22, v83
  ds_bpermute_b32 v92, v22, v84
  ds_bpermute_b32 v93, v22, v85
  ds_bpermute_b32 v94, v22, v86
  ds_bpermute_b32 v95, v22, v87
  s_waitcnt lgkmcnt(0)
  v_add_f32 v80, v80, v88
  v_add_f32 v81, v81, v89
  v_add_f32 v82, v82, v90
  v_add_f32 v83, v83, v91
  v_add_f32 v84, v84, v92
  v_add_f32 v85, v85, v93
  v_add_f32 v86, v86, v94
  v_add_f32 v87, v87, v95
  v_mul_f32 v80, 0.5, v80
  v_mul_f32 v81, 0.5, v81
  v_mul_f32 v82, 0.5, v82
  v_mul_f32 v83, 0.5, v83
  v_mul_f32 v84, 0.5, v84
  v_mul_f32 v85, 0.5, v85
  v_mul_f32 v86, 0.5, v86
  v_mul_f32 v87, 0.5, v87
  v_lshrrev_b32 v22, 3, v1
  s_lshl_b32 s29, s28, 5
  v_add_u32 v22, s29, v22
  v_lshlrev_b32 v22, 3, v22
  v_add_u32 v22, 0, v22
  ds_write_b64 v22, v[80:81] offset:0
  ds_write_b64 v22, v[82:83] offset:64
  ds_write_b64 v22, v[84:85] offset:128
  ds_write_b64 v22, v[86:87] offset:192
  s_waitcnt lgkmcnt(0)
  s_barrier
  s_branch main_qkv1_fin2
main_l1x4:
  s_cmp_eq_u32 s5, 0
  s_cbranch_scc1 main_nq5
  s_cmp_eq_u32 s3, 0
  s_cbranch_scc0 main_pw6
  v_and_b32 v60, 63, v0
  v_add_u32 v60, s26, v60
  v_min_u32 v60, s27, v60
  v_mul_u32_u24 v60, 128, v60
  s_add_u32 s46, s5, 24195072
  s_mov_b32 s47, 0
  s_and_b32 s45, s2, 7
  s_lshl_b32 s45, s45, 14
  s_add_u32 s46, s46, s45
  buffer_load_dword v252, v60, s[8:11], s46 offen sc1
main_pl7:
  s_waitcnt vmcnt(0)
  v_cmp_gt_u32 vcc, 10, v252
  s_cbranch_vccz main_pw6
  s_sleep 2
  buffer_load_dword v252, v60, s[8:11], s46 offen sc1
  s_add_u32 s47, s47, 1
  s_cmp_ge_u32 s47, 131072
  s_cbranch_scc0 main_pl7
main_pw6:
  s_barrier
main_nq5:
  s_add_u32 m0, s33, 0
  s_nop 0
  buffer_load_dwordx4 v12, s[48:51], s34 offen offset:0 lds
  buffer_load_dwordx4 v13, s[48:51], s34 offen offset:1024 lds
  buffer_load_dwordx4 v14, s[48:51], s34 offen offset:2048 lds
  buffer_load_dwordx4 v15, s[48:51], s34 offen offset:3072 lds
  s_add_u32 s34, s34, s39
  s_add_u32 m0, s33, 32768
  s_nop 0
  buffer_load_dwordx4 v12, s[48:51], s34 offen offset:0 lds
  buffer_load_dwordx4 v13, s[48:51], s34 offen offset:1024 lds
  buffer_load_dwordx4 v14, s[48:51], s34 offen offset:2048 lds
  buffer_load_dwordx4 v15, s[48:51], s34 offen offset:3072 lds
  s_add_u32 s34, s34, s39
  s_add_u32 m0, s33, 65536
  s_nop 0
  buffer_load_dwordx4 v12, s[48:51], s34 offen offset:0 lds
  buffer_load_dwordx4 v13, s[48:51], s34 offen offset:1024 lds
  buffer_load_dwordx4 v14, s[48:51], s34 offen offset:2048 lds
  buffer_load_dwordx4 v15, s[48:51], s34 offen offset:3072 lds
  s_add_u32 s34, s34, s39
  s_waitcnt vmcnt(8)
  s_barrier
  s_add_u32 m0, s33, 98304
  s_nop 0
  buffer_load_dwordx4 v12, s[48:51], s34 offen offset:0 lds
  buffer_load_dwordx4 v13, s[48:51], s34 offen offset:1024 lds
  buffer_load_dwordx4 v14, s[48:51], s34 offen offset:2048 lds
  buffer_load_dwordx4 v15, s[48:51], s34 offen offset:3072 lds
  s_add_u32 s34, s34, s39
  s_add_u32 m0, s33, 114688
  s_nop 0
  buffer_load_dwordx4 v8, s[12:15], s35 offen offset:0 lds
  buffer_load_dwordx4 v9, s[12:15], s35 offen offset:1024 lds
  buffer_load_dwordx4 v10, s[12:15], s35 offen offset:2048 lds
  buffer_load_dwordx4 v11, s[12:15], s35 offen offset:3072 lds
  s_add_u32 s35, s35, 245760
  s_waitcnt vmcnt(12)
  s_barrier
  s_add_u32 m0, s33, 131072
  s_nop 0
  buffer_load_dwordx4 v12, s[48:51], s34 offen offset:0 lds
  buffer_load_dwordx4 v13, s[48:51], s34 offen offset:1024 lds
  buffer_load_dwordx4 v14, s[48:51], s34 offen offset:2048 lds
  buffer_load_dwordx4 v15, s[48:51], s34 offen offset:3072 lds
  s_add_u32 s34, s34, s39
  s_add_u32 m0, s33, 147456
  s_nop 0
  buffer_load_dwordx4 v8, s[12:15], s35 offen offset:0 lds
  buffer_load_dwordx4 v9, s[12:15], s35 offen offset:1024 lds
  buffer_load_dwordx4 v10, s[12:15], s35 offen offset:2048 lds
  buffer_load_dwordx4 v11, s[12:15], s35 offen offset:3072 lds
  s_add_u32 s35, s35, 245760
  s_waitcnt vmcnt(16)
  s_barrier
  s_add_u32 m0, s33, 0
  s_nop 0
  buffer_load_dwordx4 v12, s[48:51], s34 offen offset:0 lds
  buffer_load_dwordx4 v13, s[48:51], s34 offen offset:1024 lds
  buffer_load_dwordx4 v14, s[48:51], s34 offen offset:2048 lds
  buffer_load_dwordx4 v15, s[48:51], s34 offen offset:3072 lds
  s_add_u32 s34, s34, s39
  s_add_u32 m0, s33, 16384
  s_nop 0
  buffer_load_dwordx4 v8, s[12:15], s35 offen offset:0 lds
  buffer_load_dwordx4 v9, s[12:15], s35 offen offset:1024 lds
  buffer_load_dwordx4 v10, s[12:15], s35 offen offset:2048 lds
  buffer_load_dwordx4 v11, s[12:15], s35 offen offset:3072 lds
  s_add_u32 s35, s35, 245760
  s_waitcnt vmcnt(16)
  s_barrier
  s_add_u32 m0, s33, 32768
  s_nop 0
  buffer_load_dwordx4 v12, s[48:51], s34 offen offset:0 lds
  buffer_load_dwordx4 v13, s[48:51], s34 offen offset:1024 lds
  buffer_load_dwordx4 v14, s[48:51], s34 offen offset:2048 lds
  buffer_load_dwordx4 v15, s[48:51], s34 offen offset:3072 lds
  s_add_u32 s34, s34, s39
  s_add_u32 m0, s33, 49152
  s_nop 0
  buffer_load_dwordx4 v8, s[12:15], s35 offen offset:0 lds
  buffer_load_dwordx4 v9, s[12:15], s35 offen offset:1024 lds
  buffer_load_dwordx4 v10, s[12:15], s35 offen offset:2048 lds
  buffer_load_dwordx4 v11, s[12:15], s35 offen offset:3072 lds
  s_add_u32 s35, s35, 245760
  s_waitcnt vmcnt(16)
  s_barrier
  s_add_u32 m0, s33, 65536
  s_nop 0
  buffer_load_dwordx4 v12, s[48:51], s34 offen offset:0 lds
  buffer_load_dwordx4 v13, s[48:51], s34 offen offset:1024 lds
  buffer_load_dwordx4 v14, s[48:51], s34 offen offset:2048 lds
  buffer_load_dwordx4 v15, s[48:51], s34 offen offset:3072 lds
  s_add_u32 s34, s34, s39
  s_add_u32 m0, s33, 81920
  s_nop 0
  buffer_load_dwordx4 v8, s[12:15], s35 offen offset:0 lds
  buffer_load_dwordx4 v9, s[12:15], s35 offen offset:1024 lds
  buffer_load_dwordx4 v10, s[12:15], s35 offen offset:2048 lds
  buffer_load_dwordx4 v11, s[12:15], s35 offen offset:3072 lds
  s_add_u32 s35, s35, 245760
  s_waitcnt vmcnt(16)
  s_barrier
  s_add_u32 m0, s33, 98304
  s_nop 0
  buffer_load_dwordx4 v12, s[48:51], s34 offen offset:0 lds
  buffer_load_dwordx4 v13, s[48:51], s34 offen offset:1024 lds
  buffer_load_dwordx4 v14, s[48:51], s34 offen offset:2048 lds
  buffer_load_dwordx4 v15, s[48:51], s34 offen offset:3072 lds
  s_add_u32 s34, s34, s39
  s_add_u32 m0, s33, 114688
  s_nop 0
  buffer_load_dwordx4 v8, s[12:15], s35 offen offset:0 lds
  buffer_load_dwordx4 v9, s[12:15], s35 offen offset:1024 lds
  buffer_load_dwordx4 v10, s[12:15], s35 offen offset:2048 lds
  buffer_load_dwordx4 v11, s[12:15], s35 offen offset:3072 lds
  s_add_u32 s35, s35, 245760
  s_waitcnt vmcnt(16)
  s_barrier
  s_add_u32 m0, s33, 131072
  s_nop 0
  buffer_load_dwordx4 v12, s[48:51], s34 offen offset:0 lds
  buffer_load_dwordx4 v13, s[48:51], s34 offen offset:1024 lds
  buffer_load_dwordx4 v14, s[48:51], s34 offen offset:2048 lds
  buffer_load_dwordx4 v15, s[48:51], s34 offen offset:3072 lds
  s_add_u32 s34, s34, s39
  s_add_u32 m0, s33, 147456
  s_nop 0
  buffer_load_dwordx4 v8, s[12:15], s35 offen offset:0 lds
  buffer_load_dwordx4 v9, s[12:15], s35 offen offset:1024 lds
  buffer_load_dwordx4 v10, s[12:15], s35 offen offset:2048 lds
  buffer_load_dwordx4 v11, s[12:15], s35 offen offset:3072 lds
  s_add_u32 s35, s35, 245760
  s_waitcnt vmcnt(16)
  s_barrier
  s_waitcnt vmcnt(8)
  s_barrier
  s_waitcnt vmcnt(0)
  s_barrier
  s_branch main_qkv1_fin2
main_qkv1_cons:
  s_and_b32 s29, s28, 1
  s_lshr_b32 s30, s28, 1
  v_lshrrev_b32 v3, 5, v1
  v_and_b32 v4, 31, v1
  s_lshl_b32 s31, s24, 7
  s_lshl_b32 s32, s29, 6
  s_add_u32 s31, s31, s32
  v_add_u32 v5, s31, v4
  v_lshlrev_b32 v6, 3, v5
  v_mul_u32_u24 v7, 81920, v3
  v_add_u32 v6, v6, v7
  s_lshl_b32 s33, s25, 7
  s_lshl_b32 s34, s30, 6
  s_add_u32 s33, s33, s34
  v_lshlrev_b32 v7, 2, v3
  v_add_u32 v7, s33, v7
  v_lshlrev_b32 v8, 2, v7
  v_lshlrev_b32 v9, 1, v7
  s_mov_b32 s34, 24117248
  v_lshlrev_b32 v10, 11, v3
  s_lshl_b32 s34, s29, 6
  v_add_u32 v11, s34, v4
  v_lshlrev_b32 v11, 4, v11
  v_add_u32 v10, v10, v11
  v_lshrrev_b32 v16, 2, v1
  v_and_b32 v16, 3, v16
  v_lshlrev_b32 v17, 3, v3
  v_add_u32 v17, v17, v16
  v_lshlrev_b32 v17, 8, v17
  s_lshl_b32 s34, s30, 3
  v_lshlrev_b32 v18, 2, v16
  v_xor_b32 v18, s34, v18
  v_lshrrev_b32 v19, 4, v1
  v_and_b32 v19, 1, v19
  v_lshlrev_b32 v19, 1, v19
  v_add_u32 v18, v18, v19
  v_lshrrev_b32 v19, 1, v1
  v_and_b32 v19, 1, v19
  v_add_u32 v18, v18, v19
  v_lshlrev_b32 v18, 4, v18
  v_and_b32 v19, 1, v1
  v_lshlrev_b32 v19, 3, v19
  v_add_u32 v18, v18, v19
  v_add_u32 v11, v17, v18
  v_add_u32 v11, 16384, v11
  v_xor_b32 v12, 64, v11
  v_add_u32 v13, 65536, v10
  v_add_u32 v14, 65536, v11
  v_add_u32 v15, 65536, v12
  v_add_u32 v56, 131072, v10
  v_add_u32 v57, 131072, v11
  v_add_u32 v62, 131072, v12
  s_cmp_eq_u32 s5, 0
  s_cbranch_scc1 main_xp8
  v_add_u32 v32, 0, v10
  v_add_u32 v33, 512, v10
  v_add_u32 v34, 4096, v10
  v_add_u32 v35, 4608, v10
  v_add_u32 v36, 8192, v10
  v_add_u32 v37, 8704, v10
  v_add_u32 v38, 12288, v10
  v_add_u32 v39, 12800, v10
  v_add_u32 v40, 65536, v10
  v_add_u32 v41, 66048, v10
  v_add_u32 v42, 69632, v10
  v_add_u32 v43, 70144, v10
  v_add_u32 v44, 73728, v10
  v_add_u32 v45, 74240, v10
  v_add_u32 v46, 77824, v10
  v_add_u32 v47, 78336, v10
  v_add_u32 v48, 131072, v10
  v_add_u32 v49, 131584, v10
  v_add_u32 v50, 135168, v10
  v_add_u32 v51, 135680, v10
  v_add_u32 v52, 139264, v10
  v_add_u32 v53, 139776, v10
  v_add_u32 v54, 143360, v10
  v_add_u32 v55, 143872, v10
  s_branch main_xq9
main_xp8:
  s_lshl_b32 s38, s29, 6
  v_add_u32 v16, s38, v4
  v_add_u32 v18, 0, v3
  v_xor_b32 v17, v16, v18
  v_lshlrev_b32 v17, 4, v17
  v_lshlrev_b32 v18, 11, v18
  v_add_u32 v18, v18, v17
  v_add_u32 v32, 0, v18
  v_add_u32 v33, 512, v18
  v_add_u32 v40, 65536, v18
  v_add_u32 v41, 66048, v18
  v_add_u32 v48, 131072, v18
  v_add_u32 v49, 131584, v18
  v_add_u32 v18, 2, v3
  v_xor_b32 v17, v16, v18
  v_lshlrev_b32 v17, 4, v17
  v_lshlrev_b32 v18, 11, v18
  v_add_u32 v18, v18, v17
  v_add_u32 v34, 0, v18
  v_add_u32 v35, 512, v18
  v_add_u32 v42, 65536, v18
  v_add_u32 v43, 66048, v18
  v_add_u32 v50, 131072, v18
  v_add_u32 v51, 131584, v18
  v_add_u32 v18, 4, v3
  v_xor_b32 v17, v16, v18
  v_lshlrev_b32 v17, 4, v17
  v_lshlrev_b32 v18, 11, v18
  v_add_u32 v18, v18, v17
  v_add_u32 v36, 0, v18
  v_add_u32 v37, 512, v18
  v_add_u32 v44, 65536, v18
  v_add_u32 v45, 66048, v18
  v_add_u32 v52, 131072, v18
  v_add_u32 v53, 131584, v18
  v_add_u32 v18, 6, v3
  v_xor_b32 v17, v16, v18
  v_lshlrev_b32 v17, 4, v17
  v_lshlrev_b32 v18, 11, v18
  v_add_u32 v18, v18, v17
  v_add_u32 v38, 0, v18
  v_add_u32 v39, 512, v18
  v_add_u32 v46, 65536, v18
  v_add_u32 v47, 66048, v18
  v_add_u32 v54, 131072, v18
  v_add_u32 v55, 131584, v18
main_xq9:
  s_cmp_eq_u32 s5, 0
  s_cbranch_scc1 main_nq10
  s_cmp_eq_u32 s3, 0
  s_cbranch_scc0 main_pw11
  v_and_b32 v60, 63, v0
  v_add_u32 v60, s26, v60
  v_min_u32 v60, s27, v60
  v_mul_u32_u24 v60, 128, v60
  s_add_u32 s46, s5, 24195072
  s_mov_b32 s47, 0
  s_and_b32 s45, s2, 7
  s_lshl_b32 s45, s45, 14
  s_add_u32 s46, s46, s45
  buffer_load_dword v252, v60, s[8:11], s46 offen sc1
main_pl12:
  s_waitcnt vmcnt(0)
  v_cmp_gt_u32 vcc, 10, v252
  s_cbranch_vccz main_pw11
  s_sleep 2
  buffer_load_dword v252, v60, s[8:11], s46 offen sc1
  s_add_u32 s47, s47, 1
  s_cmp_ge_u32 s47, 131072
  s_cbranch_scc0 main_pl12
main_pw11:
  s_barrier
main_nq10:
  s_cmp_eq_u32 s5, 0
  s_cbranch_scc1 main_st13
  s_add_u32 s38, s5, 22970368
  buffer_load_dwordx2 v[208:209], v6, s[8:11], s38 offen offset:0
  buffer_load_dwordx2 v[210:211], v6, s[8:11], s38 offen offset:256
  s_add_u32 s38, s5, 22986752
  buffer_load_dwordx2 v[212:213], v6, s[8:11], s38 offen offset:0
  buffer_load_dwordx2 v[214:215], v6, s[8:11], s38 offen offset:256
  s_add_u32 s38, s5, 23003136
  buffer_load_dwordx2 v[216:217], v6, s[8:11], s38 offen offset:0
  buffer_load_dwordx2 v[218:219], v6, s[8:11], s38 offen offset:256
  s_add_u32 s38, s5, 23019520
  buffer_load_dwordx2 v[220:221], v6, s[8:11], s38 offen offset:0
  buffer_load_dwordx2 v[222:223], v6, s[8:11], s38 offen offset:256
  s_add_u32 s38, s5, 23035904
  buffer_load_dwordx2 v[224:225], v6, s[8:11], s38 offen offset:0
  buffer_load_dwordx2 v[226:227], v6, s[8:11], s38 offen offset:256
main_st13:
  s_barrier
  ds_read_b64_tr_b16 v[128:129], v11 offset:0
  ds_read_b64_tr_b16 v[130:131], v11 offset:1024
  ds_read_b128 v[136:139], v32 offset:0
  ds_read_b64_tr_b16 v[132:133], v12 offset:0
  ds_read_b64_tr_b16 v[134:135], v12 offset:1024
  ds_read_b128 v[140:143], v33 offset:0
  s_waitcnt lgkmcnt(3)
  v_mfma_f32_32x32x16_bf16 v[64:79], v[128:131], v[136:139], 0
  ds_read_b64_tr_b16 v[144:145], v11 offset:4096
  ds_read_b64_tr_b16 v[146:147], v11 offset:5120
  s_waitcnt lgkmcnt(3)
  v_mfma_f32_32x32x16_bf16 v[96:111], v[132:135], v[136:139], 0
  ds_read_b128 v[152:155], v34 offset:0
  ds_read_b64_tr_b16 v[148:149], v12 offset:4096
  s_waitcnt lgkmcnt(4)
  v_mfma_f32_32x32x16_bf16 v[80:95], v[128:131], v[140:143], 0
  ds_read_b64_tr_b16 v[150:151], v12 offset:5120
  ds_read_b128 v[156:159], v35 offset:0
  v_mfma_f32_32x32x16_bf16 v[112:127], v[132:135], v[140:143], 0
  s_waitcnt lgkmcnt(3)
  v_mfma_f32_32x32x16_bf16 v[64:79], v[144:147], v[152:155], v[64:79]
  ds_read_b64_tr_b16 v[128:129], v11 offset:8192
  ds_read_b64_tr_b16 v[130:131], v11 offset:9216
  s_waitcnt lgkmcnt(3)
  v_mfma_f32_32x32x16_bf16 v[96:111], v[148:151], v[152:155], v[96:111]
  ds_read_b128 v[136:139], v36 offset:0
  ds_read_b64_tr_b16 v[132:133], v12 offset:8192
  s_waitcnt lgkmcnt(4)
  v_mfma_f32_32x32x16_bf16 v[80:95], v[144:147], v[156:159], v[80:95]
  ds_read_b64_tr_b16 v[134:135], v12 offset:9216
  ds_read_b128 v[140:143], v37 offset:0
  v_mfma_f32_32x32x16_bf16 v[112:127], v[148:151], v[156:159], v[112:127]
  s_waitcnt lgkmcnt(3)
  v_mfma_f32_32x32x16_bf16 v[64:79], v[128:131], v[136:139], v[64:79]
  ds_read_b64_tr_b16 v[144:145], v11 offset:12288
  ds_read_b64_tr_b16 v[146:147], v11 offset:13312
  s_waitcnt lgkmcnt(3)
  v_mfma_f32_32x32x16_bf16 v[96:111], v[132:135], v[136:139], v[96:111]
  ds_read_b128 v[152:155], v38 offset:0
  ds_read_b64_tr_b16 v[148:149], v12 offset:12288
  s_waitcnt lgkmcnt(4)
  v_mfma_f32_32x32x16_bf16 v[80:95], v[128:131], v[140:143], v[80:95]
  ds_read_b64_tr_b16 v[150:151], v12 offset:13312
  ds_read_b128 v[156:159], v39 offset:0
  v_mfma_f32_32x32x16_bf16 v[112:127], v[132:135], v[140:143], v[112:127]
  s_barrier
  s_waitcnt lgkmcnt(3)
  v_mfma_f32_32x32x16_bf16 v[64:79], v[144:147], v[152:155], v[64:79]
  ds_read_b64_tr_b16 v[128:129], v11 offset:32768
  ds_read_b64_tr_b16 v[130:131], v11 offset:33792
  s_waitcnt lgkmcnt(3)
  v_mfma_f32_32x32x16_bf16 v[96:111], v[148:151], v[152:155], v[96:111]
  ds_read_b128 v[136:139], v32 offset:32768
  ds_read_b64_tr_b16 v[132:133], v12 offset:32768
  s_waitcnt lgkmcnt(4)
  v_mfma_f32_32x32x16_bf16 v[80:95], v[144:147], v[156:159], v[80:95]
  ds_read_b64_tr_b16 v[134:135], v12 offset:33792
  ds_read_b128 v[140:143], v33 offset:32768
  v_mfma_f32_32x32x16_bf16 v[112:127], v[148:151], v[156:159], v[112:127]
  s_waitcnt lgkmcnt(3)
  v_mfma_f32_32x32x16_bf16 v[64:79], v[128:131], v[136:139], v[64:79]
  ds_read_b64_tr_b16 v[144:145], v11 offset:36864
  ds_read_b64_tr_b16 v[146:147], v11 offset:37888
  s_waitcnt lgkmcnt(3)
  v_mfma_f32_32x32x16_bf16 v[96:111], v[132:135], v[136:139], v[96:111]
  ds_read_b128 v[152:155], v34 offset:32768
  ds_read_b64_tr_b16 v[148:149], v12 offset:36864
  s_waitcnt lgkmcnt(4)
  v_mfma_f32_32x32x16_bf16 v[80:95], v[128:131], v[140:143], v[80:95]
  ds_read_b64_tr_b16 v[150:151], v12 offset:37888
  ds_read_b128 v[156:159], v35 offset:32768
  v_mfma_f32_32x32x16_bf16 v[112:127], v[132:135], v[140:143], v[112:127]
  s_waitcnt lgkmcnt(3)
  v_mfma_f32_32x32x16_bf16 v[64:79], v[144:147], v[152:155], v[64:79]
  ds_read_b64_tr_b16 v[128:129], v11 offset:40960
  ds_read_b64_tr_b16 v[130:131], v11 offset:41984
  s_waitcnt lgkmcnt(3)
  v_mfma_f32_32x32x16_bf16 v[96:111], v[148:151], v[152:155], v[96:111]
  ds_read_b128 v[136:139], v36 offset:32768
  ds_read_b64_tr_b16 v[132:133], v12 offset:40960
  s_waitcnt lgkmcnt(4)
  v_mfma_f32_32x32x16_bf16 v[80:95], v[144:147], v[156:159], v[80:95]
  ds_read_b64_tr_b16 v[134:135], v12 offset:41984
  ds_read_b128 v[140:143], v37 offset:32768
  v_mfma_f32_32x32x16_bf16 v[112:127], v[148:151], v[156:159], v[112:127]
  s_waitcnt lgkmcnt(3)
  v_mfma_f32_32x32x16_bf16 v[64:79], v[128:131], v[136:139], v[64:79]
  ds_read_b64_tr_b16 v[144:145], v11 offset:45056
  ds_read_b64_tr_b16 v[146:147], v11 offset:46080
  s_waitcnt lgkmcnt(3)
  v_mfma_f32_32x32x16_bf16 v[96:111], v[132:135], v[136:139], v[96:111]
  ds_read_b128 v[152:155], v38 offset:32768
  ds_read_b64_tr_b16 v[148:149], v12 offset:45056
  s_waitcnt lgkmcnt(4)
  v_mfma_f32_32x32x16_bf16 v[80:95], v[128:131], v[140:143], v[80:95]
  ds_read_b64_tr_b16 v[150:151], v12 offset:46080
  ds_read_b128 v[156:159], v39 offset:32768
  v_mfma_f32_32x32x16_bf16 v[112:127], v[132:135], v[140:143], v[112:127]
  s_barrier
  s_waitcnt lgkmcnt(3)
  v_mfma_f32_32x32x16_bf16 v[64:79], v[144:147], v[152:155], v[64:79]
  ds_read_b64_tr_b16 v[128:129], v14 offset:0
  ds_read_b64_tr_b16 v[130:131], v14 offset:1024
  s_waitcnt lgkmcnt(3)
  v_mfma_f32_32x32x16_bf16 v[96:111], v[148:151], v[152:155], v[96:111]
  ds_read_b128 v[136:139], v40 offset:0
  ds_read_b64_tr_b16 v[132:133], v15 offset:0
  s_waitcnt lgkmcnt(4)
  v_mfma_f32_32x32x16_bf16 v[80:95], v[144:147], v[156:159], v[80:95]
  ds_read_b64_tr_b16 v[134:135], v15 offset:1024
  ds_read_b128 v[140:143], v41 offset:0
  v_mfma_f32_32x32x16_bf16 v[112:127], v[148:151], v[156:159], v[112:127]
  s_waitcnt lgkmcnt(3)
  v_mfma_f32_32x32x16_bf16 v[64:79], v[128:131], v[136:139], v[64:79]
  ds_read_b64_tr_b16 v[144:145], v14 offset:4096
  ds_read_b64_tr_b16 v[146:147], v14 offset:5120
  s_waitcnt lgkmcnt(3)
  v_mfma_f32_32x32x16_bf16 v[96:111], v[132:135], v[136:139], v[96:111]
  ds_read_b128 v[152:155], v42 offset:0
  ds_read_b64_tr_b16 v[148:149], v15 offset:4096
  s_waitcnt lgkmcnt(4)
  v_mfma_f32_32x32x16_bf16 v[80:95], v[128:131], v[140:143], v[80:95]
  ds_read_b64_tr_b16 v[150:151], v15 offset:5120
  ds_read_b128 v[156:159], v43 offset:0
  v_mfma_f32_32x32x16_bf16 v[112:127], v[132:135], v[140:143], v[112:127]
  s_waitcnt lgkmcnt(3)
  v_mfma_f32_32x32x16_bf16 v[64:79], v[144:147], v[152:155], v[64:79]
  ds_read_b64_tr_b16 v[128:129], v14 offset:8192
  ds_read_b64_tr_b16 v[130:131], v14 offset:9216
  s_waitcnt lgkmcnt(3)
  v_mfma_f32_32x32x16_bf16 v[96:111], v[148:151], v[152:155], v[96:111]
  ds_read_b128 v[136:139], v44 offset:0
  ds_read_b64_tr_b16 v[132:133], v15 offset:8192
  s_waitcnt lgkmcnt(4)
  v_mfma_f32_32x32x16_bf16 v[80:95], v[144:147], v[156:159], v[80:95]
  ds_read_b64_tr_b16 v[134:135], v15 offset:9216
  ds_read_b128 v[140:143], v45 offset:0
  v_mfma_f32_32x32x16_bf16 v[112:127], v[148:151], v[156:159], v[112:127]
  s_waitcnt lgkmcnt(3)
  v_mfma_f32_32x32x16_bf16 v[64:79], v[128:131], v[136:139], v[64:79]
  ds_read_b64_tr_b16 v[144:145], v14 offset:12288
  ds_read_b64_tr_b16 v[146:147], v14 offset:13312
  s_waitcnt lgkmcnt(3)
  v_mfma_f32_32x32x16_bf16 v[96:111], v[132:135], v[136:139], v[96:111]
  ds_read_b128 v[152:155], v46 offset:0
  ds_read_b64_tr_b16 v[148:149], v15 offset:12288
  s_waitcnt lgkmcnt(4)
  v_mfma_f32_32x32x16_bf16 v[80:95], v[128:131], v[140:143], v[80:95]
  ds_read_b64_tr_b16 v[150:151], v15 offset:13312
  ds_read_b128 v[156:159], v47 offset:0
  v_mfma_f32_32x32x16_bf16 v[112:127], v[132:135], v[140:143], v[112:127]
  s_barrier
  s_waitcnt lgkmcnt(3)
  v_mfma_f32_32x32x16_bf16 v[64:79], v[144:147], v[152:155], v[64:79]
  ds_read_b64_tr_b16 v[128:129], v14 offset:32768
  ds_read_b64_tr_b16 v[130:131], v14 offset:33792
  s_waitcnt lgkmcnt(3)
  v_mfma_f32_32x32x16_bf16 v[96:111], v[148:151], v[152:155], v[96:111]
  ds_read_b128 v[136:139], v40 offset:32768
  ds_read_b64_tr_b16 v[132:133], v15 offset:32768
  s_waitcnt lgkmcnt(4)
  v_mfma_f32_32x32x16_bf16 v[80:95], v[144:147], v[156:159], v[80:95]
  ds_read_b64_tr_b16 v[134:135], v15 offset:33792
  ds_read_b128 v[140:143], v41 offset:32768
  v_mfma_f32_32x32x16_bf16 v[112:127], v[148:151], v[156:159], v[112:127]
  s_waitcnt lgkmcnt(3)
  v_mfma_f32_32x32x16_bf16 v[64:79], v[128:131], v[136:139], v[64:79]
  ds_read_b64_tr_b16 v[144:145], v14 offset:36864
  ds_read_b64_tr_b16 v[146:147], v14 offset:37888
  s_waitcnt lgkmcnt(3)
  v_mfma_f32_32x32x16_bf16 v[96:111], v[132:135], v[136:139], v[96:111]
  ds_read_b128 v[152:155], v42 offset:32768
  ds_read_b64_tr_b16 v[148:149], v15 offset:36864
  s_waitcnt lgkmcnt(4)
  v_mfma_f32_32x32x16_bf16 v[80:95], v[128:131], v[140:143], v[80:95]
  ds_read_b64_tr_b16 v[150:151], v15 offset:37888
  ds_read_b128 v[156:159], v43 offset:32768
  v_mfma_f32_32x32x16_bf16 v[112:127], v[132:135], v[140:143], v[112:127]
  s_waitcnt lgkmcnt(3)
  v_mfma_f32_32x32x16_bf16 v[64:79], v[144:147], v[152:155], v[64:79]
  ds_read_b64_tr_b16 v[128:129], v14 offset:40960
  ds_read_b64_tr_b16 v[130:131], v14 offset:41984
  s_waitcnt lgkmcnt(3)
  v_mfma_f32_32x32x16_bf16 v[96:111], v[148:151], v[152:155], v[96:111]
  ds_read_b128 v[136:139], v44 offset:32768
  ds_read_b64_tr_b16 v[132:133], v15 offset:40960
  s_waitcnt lgkmcnt(4)
  v_mfma_f32_32x32x16_bf16 v[80:95], v[144:147], v[156:159], v[80:95]
  ds_read_b64_tr_b16 v[134:135], v15 offset:41984
  ds_read_b128 v[140:143], v45 offset:32768
  v_mfma_f32_32x32x16_bf16 v[112:127], v[148:151], v[156:159], v[112:127]
  s_waitcnt lgkmcnt(3)
  v_mfma_f32_32x32x16_bf16 v[64:79], v[128:131], v[136:139], v[64:79]
  ds_read_b64_tr_b16 v[144:145], v14 offset:45056
  ds_read_b64_tr_b16 v[146:147], v14 offset:46080
  s_waitcnt lgkmcnt(3)
  v_mfma_f32_32x32x16_bf16 v[96:111], v[132:135], v[136:139], v[96:111]
  ds_read_b128 v[152:155], v46 offset:32768
  ds_read_b64_tr_b16 v[148:149], v15 offset:45056
  s_waitcnt lgkmcnt(4)
  v_mfma_f32_32x32x16_bf16 v[80:95], v[128:131], v[140:143], v[80:95]
  ds_read_b64_tr_b16 v[150:151], v15 offset:46080
  ds_read_b128 v[156:159], v47 offset:32768
  v_mfma_f32_32x32x16_bf16 v[112:127], v[132:135], v[140:143], v[112:127]
  s_barrier
  s_waitcnt lgkmcnt(3)
  v_mfma_f32_32x32x16_bf16 v[64:79], v[144:147], v[152:155], v[64:79]
  ds_read_b64_tr_b16 v[128:129], v57 offset:0
  ds_read_b64_tr_b16 v[130:131], v57 offset:1024
  s_waitcnt lgkmcnt(3)
  v_mfma_f32_32x32x16_bf16 v[96:111], v[148:151], v[152:155], v[96:111]
  ds_read_b128 v[136:139], v48 offset:0
  ds_read_b64_tr_b16 v[132:133], v62 offset:0
  s_waitcnt lgkmcnt(4)
  v_mfma_f32_32x32x16_bf16 v[80:95], v[144:147], v[156:159], v[80:95]
  ds_read_b64_tr_b16 v[134:135], v62 offset:1024
  ds_read_b128 v[140:143], v49 offset:0
  v_mfma_f32_32x32x16_bf16 v[112:127], v[148:151], v[156:159], v[112:127]
  s_waitcnt lgkmcnt(3)
  v_mfma_f32_32x32x16_bf16 v[64:79], v[128:131], v[136:139], v[64:79]
  ds_read_b64_tr_b16 v[144:145], v57 offset:4096
  ds_read_b64_tr_b16 v[146:147], v57 offset:5120
  s_waitcnt lgkmcnt(3)
  v_mfma_f32_32x32x16_bf16 v[96:111], v[132:135], v[136:139], v[96:111]
  ds_read_b128 v[152:155], v50 offset:0
  ds_read_b64_tr_b16 v[148:149], v62 offset:4096
  s_waitcnt lgkmcnt(4)
  v_mfma_f32_32x32x16_bf16 v[80:95], v[128:131], v[140:143], v[80:95]
  ds_read_b64_tr_b16 v[150:151], v62 offset:5120
  ds_read_b128 v[156:159], v51 offset:0
  v_mfma_f32_32x32x16_bf16 v[112:127], v[132:135], v[140:143], v[112:127]
  s_waitcnt lgkmcnt(3)
  v_mfma_f32_32x32x16_bf16 v[64:79], v[144:147], v[152:155], v[64:79]
  ds_read_b64_tr_b16 v[128:129], v57 offset:8192
  ds_read_b64_tr_b16 v[130:131], v57 offset:9216
  s_waitcnt lgkmcnt(3)
  v_mfma_f32_32x32x16_bf16 v[96:111], v[148:151], v[152:155], v[96:111]
  ds_read_b128 v[136:139], v52 offset:0
  ds_read_b64_tr_b16 v[132:133], v62 offset:8192
  s_waitcnt lgkmcnt(4)
  v_mfma_f32_32x32x16_bf16 v[80:95], v[144:147], v[156:159], v[80:95]
  ds_read_b64_tr_b16 v[134:135], v62 offset:9216
  ds_read_b128 v[140:143], v53 offset:0
  v_mfma_f32_32x32x16_bf16 v[112:127], v[148:151], v[156:159], v[112:127]
  s_waitcnt lgkmcnt(3)
  v_mfma_f32_32x32x16_bf16 v[64:79], v[128:131], v[136:139], v[64:79]
  ds_read_b64_tr_b16 v[144:145], v57 offset:12288
  ds_read_b64_tr_b16 v[146:147], v57 offset:13312
  s_waitcnt lgkmcnt(3)
  v_mfma_f32_32x32x16_bf16 v[96:111], v[132:135], v[136:139], v[96:111]
  ds_read_b128 v[152:155], v54 offset:0
  ds_read_b64_tr_b16 v[148:149], v62 offset:12288
  s_waitcnt lgkmcnt(4)
  v_mfma_f32_32x32x16_bf16 v[80:95], v[128:131], v[140:143], v[80:95]
  ds_read_b64_tr_b16 v[150:151], v62 offset:13312
  ds_read_b128 v[156:159], v55 offset:0
  v_mfma_f32_32x32x16_bf16 v[112:127], v[132:135], v[140:143], v[112:127]
  s_barrier
  s_waitcnt lgkmcnt(3)
  v_mfma_f32_32x32x16_bf16 v[64:79], v[144:147], v[152:155], v[64:79]
  ds_read_b64_tr_b16 v[128:129], v11 offset:0
  ds_read_b64_tr_b16 v[130:131], v11 offset:1024
  s_waitcnt lgkmcnt(3)
  v_mfma_f32_32x32x16_bf16 v[96:111], v[148:151], v[152:155], v[96:111]
  ds_read_b128 v[136:139], v32 offset:0
  ds_read_b64_tr_b16 v[132:133], v12 offset:0
  s_waitcnt lgkmcnt(4)
  v_mfma_f32_32x32x16_bf16 v[80:95], v[144:147], v[156:159], v[80:95]
  ds_read_b64_tr_b16 v[134:135], v12 offset:1024
  ds_read_b128 v[140:143], v33 offset:0
  v_mfma_f32_32x32x16_bf16 v[112:127], v[148:151], v[156:159], v[112:127]
  s_waitcnt lgkmcnt(3)
  v_mfma_f32_32x32x16_bf16 v[64:79], v[128:131], v[136:139], v[64:79]
  ds_read_b64_tr_b16 v[144:145], v11 offset:4096
  ds_read_b64_tr_b16 v[146:147], v11 offset:5120
  s_waitcnt lgkmcnt(3)
  v_mfma_f32_32x32x16_bf16 v[96:111], v[132:135], v[136:139], v[96:111]
  ds_read_b128 v[152:155], v34 offset:0
  ds_read_b64_tr_b16 v[148:149], v12 offset:4096
  s_waitcnt lgkmcnt(4)
  v_mfma_f32_32x32x16_bf16 v[80:95], v[128:131], v[140:143], v[80:95]
  ds_read_b64_tr_b16 v[150:151], v12 offset:5120
  ds_read_b128 v[156:159], v35 offset:0
  v_mfma_f32_32x32x16_bf16 v[112:127], v[132:135], v[140:143], v[112:127]
  s_cmp_eq_u32 s5, 0
  s_cbranch_scc0 main_pfb14
  s_lshl_b32 s38, s2, 12
  v_and_b32 v63, 255, v0
  v_lshlrev_b32 v63, 4, v63
  v_add_u32 v63, s38, v63
  s_mov_b32 s38, 0
  buffer_load_dwordx4 v[240:243], v63, s[16:19], s38 offen
  s_mov_b32 s38, 0
  buffer_load_dwordx4 v[240:243], v63, s[20:23], s38 offen
  s_mov_b32 s38, 983040
  buffer_load_dwordx4 v[240:243], v63, s[20:23], s38 offen
  s_mov_b32 s38, 1966080
  buffer_load_dwordx4 v[240:243], v63, s[20:23], s38 offen
  s_mov_b32 s38, 0
  buffer_load_dwordx4 v[240:243], v63, s[84:87], s38 offen
  s_mov_b32 s38, 983040
  buffer_load_dwordx4 v[240:243], v63, s[84:87], s38 offen
  s_mov_b32 s38, 1966080
  buffer_load_dwordx4 v[240:243], v63, s[84:87], s38 offen
main_pfb14:
  s_waitcnt lgkmcnt(3)
  v_mfma_f32_32x32x16_bf16 v[64:79], v[144:147], v[152:155], v[64:79]
  ds_read_b64_tr_b16 v[128:129], v11 offset:8192
  ds_read_b64_tr_b16 v[130:131], v11 offset:9216
  s_waitcnt lgkmcnt(3)
  v_mfma_f32_32x32x16_bf16 v[96:111], v[148:151], v[152:155], v[96:111]
  ds_read_b128 v[136:139], v36 offset:0
  ds_read_b64_tr_b16 v[132:133], v12 offset:8192
  s_waitcnt lgkmcnt(4)
  v_mfma_f32_32x32x16_bf16 v[80:95], v[144:147], v[156:159], v[80:95]
  ds_read_b64_tr_b16 v[134:135], v12 offset:9216
  ds_read_b128 v[140:143], v37 offset:0
  v_mfma_f32_32x32x16_bf16 v[112:127], v[148:151], v[156:159], v[112:127]
  s_waitcnt lgkmcnt(3)
  v_mfma_f32_32x32x16_bf16 v[64:79], v[128:131], v[136:139], v[64:79]
  ds_read_b64_tr_b16 v[144:145], v11 offset:12288
  ds_read_b64_tr_b16 v[146:147], v11 offset:13312
  s_waitcnt lgkmcnt(3)
  v_mfma_f32_32x32x16_bf16 v[96:111], v[132:135], v[136:139], v[96:111]
  ds_read_b128 v[152:155], v38 offset:0
  ds_read_b64_tr_b16 v[148:149], v12 offset:12288
  s_waitcnt lgkmcnt(4)
  v_mfma_f32_32x32x16_bf16 v[80:95], v[128:131], v[140:143], v[80:95]
  ds_read_b64_tr_b16 v[150:151], v12 offset:13312
  ds_read_b128 v[156:159], v39 offset:0
  v_mfma_f32_32x32x16_bf16 v[112:127], v[132:135], v[140:143], v[112:127]
  s_barrier
  s_waitcnt lgkmcnt(3)
  v_mfma_f32_32x32x16_bf16 v[64:79], v[144:147], v[152:155], v[64:79]
  ds_read_b64_tr_b16 v[128:129], v11 offset:32768
  ds_read_b64_tr_b16 v[130:131], v11 offset:33792
  s_waitcnt lgkmcnt(3)
  v_mfma_f32_32x32x16_bf16 v[96:111], v[148:151], v[152:155], v[96:111]
  ds_read_b128 v[136:139], v32 offset:32768
  ds_read_b64_tr_b16 v[132:133], v12 offset:32768
  s_waitcnt lgkmcnt(4)
  v_mfma_f32_32x32x16_bf16 v[80:95], v[144:147], v[156:159], v[80:95]
  ds_read_b64_tr_b16 v[134:135], v12 offset:33792
  ds_read_b128 v[140:143], v33 offset:32768
  v_mfma_f32_32x32x16_bf16 v[112:127], v[148:151], v[156:159], v[112:127]
  s_waitcnt lgkmcnt(3)
  v_mfma_f32_32x32x16_bf16 v[64:79], v[128:131], v[136:139], v[64:79]
  ds_read_b64_tr_b16 v[144:145], v11 offset:36864
  ds_read_b64_tr_b16 v[146:147], v11 offset:37888
  s_waitcnt lgkmcnt(3)
  v_mfma_f32_32x32x16_bf16 v[96:111], v[132:135], v[136:139], v[96:111]
  ds_read_b128 v[152:155], v34 offset:32768
  ds_read_b64_tr_b16 v[148:149], v12 offset:36864
  s_waitcnt lgkmcnt(4)
  v_mfma_f32_32x32x16_bf16 v[80:95], v[128:131], v[140:143], v[80:95]
  ds_read_b64_tr_b16 v[150:151], v12 offset:37888
  ds_read_b128 v[156:159], v35 offset:32768
  v_mfma_f32_32x32x16_bf16 v[112:127], v[132:135], v[140:143], v[112:127]
  s_waitcnt lgkmcnt(3)
  v_mfma_f32_32x32x16_bf16 v[64:79], v[144:147], v[152:155], v[64:79]
  ds_read_b64_tr_b16 v[128:129], v11 offset:40960
  ds_read_b64_tr_b16 v[130:131], v11 offset:41984
  s_waitcnt lgkmcnt(3)
  v_mfma_f32_32x32x16_bf16 v[96:111], v[148:151], v[152:155], v[96:111]
  ds_read_b128 v[136:139], v36 offset:32768
  ds_read_b64_tr_b16 v[132:133], v12 offset:40960
  s_waitcnt lgkmcnt(4)
  v_mfma_f32_32x32x16_bf16 v[80:95], v[144:147], v[156:159], v[80:95]
  ds_read_b64_tr_b16 v[134:135], v12 offset:41984
  ds_read_b128 v[140:143], v37 offset:32768
  v_mfma_f32_32x32x16_bf16 v[112:127], v[148:151], v[156:159], v[112:127]
  s_waitcnt lgkmcnt(3)
  v_mfma_f32_32x32x16_bf16 v[64:79], v[128:131], v[136:139], v[64:79]
  ds_read_b64_tr_b16 v[144:145], v11 offset:45056
  ds_read_b64_tr_b16 v[146:147], v11 offset:46080
  s_waitcnt lgkmcnt(3)
  v_mfma_f32_32x32x16_bf16 v[96:111], v[132:135], v[136:139], v[96:111]
  ds_read_b128 v[152:155], v38 offset:32768
  ds_read_b64_tr_b16 v[148:149], v12 offset:45056
  s_waitcnt lgkmcnt(4)
  v_mfma_f32_32x32x16_bf16 v[80:95], v[128:131], v[140:143], v[80:95]
  ds_read_b64_tr_b16 v[150:151], v12 offset:46080
  ds_read_b128 v[156:159], v39 offset:32768
  v_mfma_f32_32x32x16_bf16 v[112:127], v[132:135], v[140:143], v[112:127]
  s_barrier
  s_waitcnt lgkmcnt(3)
  v_mfma_f32_32x32x16_bf16 v[64:79], v[144:147], v[152:155], v[64:79]
  ds_read_b64_tr_b16 v[128:129], v14 offset:0
  ds_read_b64_tr_b16 v[130:131], v14 offset:1024
  s_waitcnt lgkmcnt(3)
  v_mfma_f32_32x32x16_bf16 v[96:111], v[148:151], v[152:155], v[96:111]
  ds_read_b128 v[136:139], v40 offset:0
  ds_read_b64_tr_b16 v[132:133], v15 offset:0
  s_waitcnt lgkmcnt(4)
  v_mfma_f32_32x32x16_bf16 v[80:95], v[144:147], v[156:159], v[80:95]
  ds_read_b64_tr_b16 v[134:135], v15 offset:1024
  ds_read_b128 v[140:143], v41 offset:0
  v_mfma_f32_32x32x16_bf16 v[112:127], v[148:151], v[156:159], v[112:127]
  s_waitcnt lgkmcnt(3)
  v_mfma_f32_32x32x16_bf16 v[64:79], v[128:131], v[136:139], v[64:79]
  ds_read_b64_tr_b16 v[144:145], v14 offset:4096
  ds_read_b64_tr_b16 v[146:147], v14 offset:5120
  s_waitcnt lgkmcnt(3)
  v_mfma_f32_32x32x16_bf16 v[96:111], v[132:135], v[136:139], v[96:111]
  ds_read_b128 v[152:155], v42 offset:0
  ds_read_b64_tr_b16 v[148:149], v15 offset:4096
  s_waitcnt lgkmcnt(4)
  v_mfma_f32_32x32x16_bf16 v[80:95], v[128:131], v[140:143], v[80:95]
  ds_read_b64_tr_b16 v[150:151], v15 offset:5120
  ds_read_b128 v[156:159], v43 offset:0
  v_mfma_f32_32x32x16_bf16 v[112:127], v[132:135], v[140:143], v[112:127]
  s_waitcnt lgkmcnt(3)
  v_mfma_f32_32x32x16_bf16 v[64:79], v[144:147], v[152:155], v[64:79]
  ds_read_b64_tr_b16 v[128:129], v14 offset:8192
  ds_read_b64_tr_b16 v[130:131], v14 offset:9216
  s_waitcnt lgkmcnt(3)
  v_mfma_f32_32x32x16_bf16 v[96:111], v[148:151], v[152:155], v[96:111]
  ds_read_b128 v[136:139], v44 offset:0
  ds_read_b64_tr_b16 v[132:133], v15 offset:8192
  s_waitcnt lgkmcnt(4)
  v_mfma_f32_32x32x16_bf16 v[80:95], v[144:147], v[156:159], v[80:95]
  ds_read_b64_tr_b16 v[134:135], v15 offset:9216
  ds_read_b128 v[140:143], v45 offset:0
  v_mfma_f32_32x32x16_bf16 v[112:127], v[148:151], v[156:159], v[112:127]
  s_waitcnt lgkmcnt(3)
  v_mfma_f32_32x32x16_bf16 v[64:79], v[128:131], v[136:139], v[64:79]
  ds_read_b64_tr_b16 v[144:145], v14 offset:12288
  ds_read_b64_tr_b16 v[146:147], v14 offset:13312
  s_waitcnt lgkmcnt(3)
  v_mfma_f32_32x32x16_bf16 v[96:111], v[132:135], v[136:139], v[96:111]
  ds_read_b128 v[152:155], v46 offset:0
  ds_read_b64_tr_b16 v[148:149], v15 offset:12288
  s_waitcnt lgkmcnt(4)
  v_mfma_f32_32x32x16_bf16 v[80:95], v[128:131], v[140:143], v[80:95]
  ds_read_b64_tr_b16 v[150:151], v15 offset:13312
  ds_read_b128 v[156:159], v47 offset:0
  v_mfma_f32_32x32x16_bf16 v[112:127], v[132:135], v[140:143], v[112:127]
  s_cmp_eq_u32 s5, 0
  s_cbranch_scc0 main_ck15
  v_and_b32 v60, 0, v0
  v_lshlrev_b32 v60, 7, v60
  s_mov_b32 s47, 0
main_dw16:
  buffer_load_dword v253, v60, s[80:83], 0 offen sc1
  s_add_u32 s47, s47, 1
  s_waitcnt vmcnt(0)
  v_cmp_gt_u32 vcc, 16, v253
  s_cmp_ge_u32 s47, 0x20000
  s_cbranch_scc1 main_de17
  s_cbranch_vccz main_de17
  s_sleep 2
  s_branch main_dw16
main_de17:
main_ck15:
  s_mov_b32 s34, 24117248
  buffer_load_dwordx4 v[160:163], v8, s[8:11], s34 offen offset:0
  buffer_load_dwordx4 v[164:167], v8, s[8:11], s34 offen offset:32
  buffer_load_dwordx4 v[168:171], v8, s[8:11], s34 offen offset:64
  buffer_load_dwordx4 v[172:175], v8, s[8:11], s34 offen offset:96
  buffer_load_dwordx4 v[176:179], v8, s[8:11], s34 offen offset:128
  buffer_load_dwordx4 v[180:183], v8, s[8:11], s34 offen offset:160
  buffer_load_dwordx4 v[184:187], v8, s[8:11], s34 offen offset:192
  buffer_load_dwordx4 v[188:191], v8, s[8:11], s34 offen offset:224
  s_barrier
  s_waitcnt lgkmcnt(3)
  v_mfma_f32_32x32x16_bf16 v[64:79], v[144:147], v[152:155], v[64:79]
  ds_read_b64_tr_b16 v[128:129], v14 offset:32768
  ds_read_b64_tr_b16 v[130:131], v14 offset:33792
  s_waitcnt lgkmcnt(3)
  v_mfma_f32_32x32x16_bf16 v[96:111], v[148:151], v[152:155], v[96:111]
  ds_read_b128 v[136:139], v40 offset:32768
  ds_read_b64_tr_b16 v[132:133], v15 offset:32768
  s_waitcnt lgkmcnt(4)
  v_mfma_f32_32x32x16_bf16 v[80:95], v[144:147], v[156:159], v[80:95]
  ds_read_b64_tr_b16 v[134:135], v15 offset:33792
  ds_read_b128 v[140:143], v41 offset:32768
  v_mfma_f32_32x32x16_bf16 v[112:127], v[148:151], v[156:159], v[112:127]
  s_waitcnt lgkmcnt(3)
  v_mfma_f32_32x32x16_bf16 v[64:79], v[128:131], v[136:139], v[64:79]
  ds_read_b64_tr_b16 v[144:145], v14 offset:36864
  ds_read_b64_tr_b16 v[146:147], v14 offset:37888
  s_waitcnt lgkmcnt(3)
  v_mfma_f32_32x32x16_bf16 v[96:111], v[132:135], v[136:139], v[96:111]
  ds_read_b128 v[152:155], v42 offset:32768
  ds_read_b64_tr_b16 v[148:149], v15 offset:36864
  s_waitcnt lgkmcnt(4)
  v_mfma_f32_32x32x16_bf16 v[80:95], v[128:131], v[140:143], v[80:95]
  ds_read_b64_tr_b16 v[150:151], v15 offset:37888
  ds_read_b128 v[156:159], v43 offset:32768
  v_mfma_f32_32x32x16_bf16 v[112:127], v[132:135], v[140:143], v[112:127]
  s_waitcnt lgkmcnt(3)
  v_mfma_f32_32x32x16_bf16 v[64:79], v[144:147], v[152:155], v[64:79]
  ds_read_b64_tr_b16 v[128:129], v14 offset:40960
  ds_read_b64_tr_b16 v[130:131], v14 offset:41984
  s_waitcnt lgkmcnt(3)
  v_mfma_f32_32x32x16_bf16 v[96:111], v[148:151], v[152:155], v[96:111]
  ds_read_b128 v[136:139], v44 offset:32768
  ds_read_b64_tr_b16 v[132:133], v15 offset:40960
  s_waitcnt lgkmcnt(4)
  v_mfma_f32_32x32x16_bf16 v[80:95], v[144:147], v[156:159], v[80:95]
  ds_read_b64_tr_b16 v[134:135], v15 offset:41984
  ds_read_b128 v[140:143], v45 offset:32768
  v_mfma_f32_32x32x16_bf16 v[112:127], v[148:151], v[156:159], v[112:127]
  s_waitcnt lgkmcnt(3)
  v_mfma_f32_32x32x16_bf16 v[64:79], v[128:131], v[136:139], v[64:79]
  ds_read_b64_tr_b16 v[144:145], v14 offset:45056
  ds_read_b64_tr_b16 v[146:147], v14 offset:46080
  s_waitcnt lgkmcnt(3)
  v_mfma_f32_32x32x16_bf16 v[96:111], v[132:135], v[136:139], v[96:111]
  ds_read_b128 v[152:155], v46 offset:32768
  ds_read_b64_tr_b16 v[148:149], v15 offset:45056
  s_waitcnt lgkmcnt(4)
  v_mfma_f32_32x32x16_bf16 v[80:95], v[128:131], v[140:143], v[80:95]
  ds_read_b64_tr_b16 v[150:151], v15 offset:46080
  ds_read_b128 v[156:159], v47 offset:32768
  v_mfma_f32_32x32x16_bf16 v[112:127], v[132:135], v[140:143], v[112:127]
  s_barrier
  s_waitcnt lgkmcnt(3)
  v_mfma_f32_32x32x16_bf16 v[64:79], v[144:147], v[152:155], v[64:79]
  ds_read_b64_tr_b16 v[128:129], v57 offset:0
  ds_read_b64_tr_b16 v[130:131], v57 offset:1024
  s_waitcnt lgkmcnt(3)
  v_mfma_f32_32x32x16_bf16 v[96:111], v[148:151], v[152:155], v[96:111]
  ds_read_b128 v[136:139], v48 offset:0
  ds_read_b64_tr_b16 v[132:133], v62 offset:0
  s_waitcnt lgkmcnt(4)
  v_mfma_f32_32x32x16_bf16 v[80:95], v[144:147], v[156:159], v[80:95]
  ds_read_b64_tr_b16 v[134:135], v62 offset:1024
  ds_read_b128 v[140:143], v49 offset:0
  v_mfma_f32_32x32x16_bf16 v[112:127], v[148:151], v[156:159], v[112:127]
  s_waitcnt lgkmcnt(3)
  v_mfma_f32_32x32x16_bf16 v[64:79], v[128:131], v[136:139], v[64:79]
  ds_read_b64_tr_b16 v[144:145], v57 offset:4096
  ds_read_b64_tr_b16 v[146:147], v57 offset:5120
  s_waitcnt lgkmcnt(3)
  v_mfma_f32_32x32x16_bf16 v[96:111], v[132:135], v[136:139], v[96:111]
  ds_read_b128 v[152:155], v50 offset:0
  ds_read_b64_tr_b16 v[148:149], v62 offset:4096
  s_waitcnt lgkmcnt(4)
  v_mfma_f32_32x32x16_bf16 v[80:95], v[128:131], v[140:143], v[80:95]
  ds_read_b64_tr_b16 v[150:151], v62 offset:5120
  ds_read_b128 v[156:159], v51 offset:0
  v_mfma_f32_32x32x16_bf16 v[112:127], v[132:135], v[140:143], v[112:127]
  s_waitcnt lgkmcnt(3)
  v_mfma_f32_32x32x16_bf16 v[64:79], v[144:147], v[152:155], v[64:79]
  ds_read_b64_tr_b16 v[128:129], v57 offset:8192
  ds_read_b64_tr_b16 v[130:131], v57 offset:9216
  s_waitcnt lgkmcnt(3)
  v_mfma_f32_32x32x16_bf16 v[96:111], v[148:151], v[152:155], v[96:111]
  ds_read_b128 v[136:139], v52 offset:0
  ds_read_b64_tr_b16 v[132:133], v62 offset:8192
  s_waitcnt lgkmcnt(4)
  v_mfma_f32_32x32x16_bf16 v[80:95], v[144:147], v[156:159], v[80:95]
  ds_read_b64_tr_b16 v[134:135], v62 offset:9216
  ds_read_b128 v[140:143], v53 offset:0
  v_mfma_f32_32x32x16_bf16 v[112:127], v[148:151], v[156:159], v[112:127]
  s_waitcnt lgkmcnt(3)
  v_mfma_f32_32x32x16_bf16 v[64:79], v[128:131], v[136:139], v[64:79]
  ds_read_b64_tr_b16 v[144:145], v57 offset:12288
  ds_read_b64_tr_b16 v[146:147], v57 offset:13312
  s_waitcnt lgkmcnt(3)
  v_mfma_f32_32x32x16_bf16 v[96:111], v[132:135], v[136:139], v[96:111]
  ds_read_b128 v[152:155], v54 offset:0
  ds_read_b64_tr_b16 v[148:149], v62 offset:12288
  s_waitcnt lgkmcnt(4)
  v_mfma_f32_32x32x16_bf16 v[80:95], v[128:131], v[140:143], v[80:95]
  ds_read_b64_tr_b16 v[150:151], v62 offset:13312
  ds_read_b128 v[156:159], v55 offset:0
  v_mfma_f32_32x32x16_bf16 v[112:127], v[132:135], v[140:143], v[112:127]
  s_waitcnt lgkmcnt(3)
  v_mfma_f32_32x32x16_bf16 v[64:79], v[144:147], v[152:155], v[64:79]
  s_waitcnt lgkmcnt(1)
  v_mfma_f32_32x32x16_bf16 v[96:111], v[148:151], v[152:155], v[96:111]
  s_waitcnt lgkmcnt(0)
  v_mfma_f32_32x32x16_bf16 v[80:95], v[144:147], v[156:159], v[80:95]
  v_mfma_f32_32x32x16_bf16 v[112:127], v[148:151], v[156:159], v[112:127]
  s_waitcnt vmcnt(0)
  v_pk_add_f32 v[208:209], v[208:209], v[212:213]
  v_pk_add_f32 v[210:211], v[210:211], v[214:215]
  v_pk_add_f32 v[208:209], v[208:209], v[216:217]
  v_pk_add_f32 v[210:211], v[210:211], v[218:219]
  v_pk_add_f32 v[208:209], v[208:209], v[220:221]
  v_pk_add_f32 v[210:211], v[210:211], v[222:223]
  v_pk_add_f32 v[208:209], v[208:209], v[224:225]
  v_pk_add_f32 v[210:211], v[210:211], v[226:227]
  s_cmp_eq_u32 s5, 0
  s_cbranch_scc0 main_lz18
  s_lshl_b32 s38, s29, 6
  v_add_u32 v20, s38, v4
  v_lshlrev_b32 v20, 3, v20
  v_add_u32 v20, 0, v20
  s_barrier
  ds_read_b64 v[208:209], v20
  ds_read_b64 v[210:211], v20 offset:256
  s_waitcnt lgkmcnt(0)
main_lz18:
  v_mov_b32 v20, v208
  s_nop 1
  v_permlane32_swap_b32 v208, v20
  s_nop 1
  v_add_f32 v208, v208, v20
  v_mov_b32 v20, v209
  s_nop 1
  v_permlane32_swap_b32 v209, v20
  s_nop 1
  v_add_f32 v209, v209, v20
  v_mov_b32 v20, v210
  s_nop 1
  v_permlane32_swap_b32 v210, v20
  s_nop 1
  v_add_f32 v210, v210, v20
  v_mov_b32 v20, v211
  s_nop 1
  v_permlane32_swap_b32 v211, v20
  s_nop 1
  v_add_f32 v211, v211, v20
  s_cmp_lt_u32 s25, 5
  s_cselect_b32 s34, 0x3ea52b5c, 1.0
  s_mov_b32 s35, 0x3acccccd
  s_mov_b32 s36, 0x3727c5ac
  v_mul_f32 v22, s35, v208
  v_mul_f32 v20, s35, v209
  v_fma_f32 v20, -v22, v22, v20
  v_add_f32 v20, s36, v20
  v_rsq_f32 v24, v20
  s_nop 0
  v_mul_f32 v24, s34, v24
  v_mul_f32 v26, s35, v210
  v_mul_f32 v20, s35, v211
  v_fma_f32 v20, -v26, v26, v20
  v_add_f32 v20, s36, v20
  v_rsq_f32 v28, v20
  s_nop 0
  v_mul_f32 v28, s34, v28
  v_lshlrev_b32 v30, 15, v3
  v_lshlrev_b32 v31, 4, v5
  v_add_u32 v30, v30, v31
  s_lshr_b32 s37, s33, 3
  s_lshl_b32 s37, s37, 15
  s_add_u32 s37, s37, s5
  s_add_u32 s37, s37, 0
  v_pk_fma_f32 v[64:65], v[22:23], v[160:161], v[64:65] op_sel_hi:[0,1,1] neg_lo:[1,0,0] neg_hi:[1,0,0]
  v_pk_fma_f32 v[66:67], v[22:23], v[162:163], v[66:67] op_sel_hi:[0,1,1] neg_lo:[1,0,0] neg_hi:[1,0,0]
  v_pk_fma_f32 v[68:69], v[22:23], v[164:165], v[68:69] op_sel_hi:[0,1,1] neg_lo:[1,0,0] neg_hi:[1,0,0]
  v_pk_fma_f32 v[70:71], v[22:23], v[166:167], v[70:71] op_sel_hi:[0,1,1] neg_lo:[1,0,0] neg_hi:[1,0,0]
  v_pk_mul_f32 v[64:65], v[24:25], v[64:65] op_sel_hi:[0,1]
  v_pk_mul_f32 v[66:67], v[24:25], v[66:67] op_sel_hi:[0,1]
  v_pk_mul_f32 v[68:69], v[24:25], v[68:69] op_sel_hi:[0,1]
  v_pk_mul_f32 v[70:71], v[24:25], v[70:71] op_sel_hi:[0,1]
  v_cvt_pk_bf16_f32 v32, v64, v65
  v_cvt_pk_bf16_f32 v33, v66, v67
  v_cvt_pk_bf16_f32 v34, v68, v69
  v_cvt_pk_bf16_f32 v35, v70, v71
  s_nop 1
  v_permlane32_swap_b32 v32, v34
  v_permlane32_swap_b32 v33, v35
  s_nop 0
  buffer_store_dwordx4 v[32:35], v30, s[8:11], s37 offen offset:0 sc1
  v_pk_fma_f32 v[80:81], v[26:27], v[160:161], v[80:81] op_sel_hi:[0,1,1] neg_lo:[1,0,0] neg_hi:[1,0,0]
  v_pk_fma_f32 v[82:83], v[26:27], v[162:163], v[82:83] op_sel_hi:[0,1,1] neg_lo:[1,0,0] neg_hi:[1,0,0]
  v_pk_fma_f32 v[84:85], v[26:27], v[164:165], v[84:85] op_sel_hi:[0,1,1] neg_lo:[1,0,0] neg_hi:[1,0,0]
  v_pk_fma_f32 v[86:87], v[26:27], v[166:167], v[86:87] op_sel_hi:[0,1,1] neg_lo:[1,0,0] neg_hi:[1,0,0]
  v_pk_mul_f32 v[80:81], v[28:29], v[80:81] op_sel_hi:[0,1]
  v_pk_mul_f32 v[82:83], v[28:29], v[82:83] op_sel_hi:[0,1]
  v_pk_mul_f32 v[84:85], v[28:29], v[84:85] op_sel_hi:[0,1]
  v_pk_mul_f32 v[86:87], v[28:29], v[86:87] op_sel_hi:[0,1]
  v_cvt_pk_bf16_f32 v36, v80, v81
  v_cvt_pk_bf16_f32 v37, v82, v83
  v_cvt_pk_bf16_f32 v38, v84, v85
  v_cvt_pk_bf16_f32 v39, v86, v87
  s_nop 1
  v_permlane32_swap_b32 v36, v38
  v_permlane32_swap_b32 v37, v39
  s_nop 0
  buffer_store_dwordx4 v[36:39], v30, s[8:11], s37 offen offset:512 sc1
  s_add_u32 s37, s37, 65536
  v_pk_fma_f32 v[72:73], v[22:23], v[168:169], v[72:73] op_sel_hi:[0,1,1] neg_lo:[1,0,0] neg_hi:[1,0,0]
  v_pk_fma_f32 v[74:75], v[22:23], v[170:171], v[74:75] op_sel_hi:[0,1,1] neg_lo:[1,0,0] neg_hi:[1,0,0]
  v_pk_fma_f32 v[76:77], v[22:23], v[172:173], v[76:77] op_sel_hi:[0,1,1] neg_lo:[1,0,0] neg_hi:[1,0,0]
  v_pk_fma_f32 v[78:79], v[22:23], v[174:175], v[78:79] op_sel_hi:[0,1,1] neg_lo:[1,0,0] neg_hi:[1,0,0]
  v_pk_mul_f32 v[72:73], v[24:25], v[72:73] op_sel_hi:[0,1]
  v_pk_mul_f32 v[74:75], v[24:25], v[74:75] op_sel_hi:[0,1]
  v_pk_mul_f32 v[76:77], v[24:25], v[76:77] op_sel_hi:[0,1]
  v_pk_mul_f32 v[78:79], v[24:25], v[78:79] op_sel_hi:[0,1]
  v_cvt_pk_bf16_f32 v40, v72, v73
  v_cvt_pk_bf16_f32 v41, v74, v75
  v_cvt_pk_bf16_f32 v42, v76, v77
  v_cvt_pk_bf16_f32 v43, v78, v79
  s_nop 1
  v_permlane32_swap_b32 v40, v42
  v_permlane32_swap_b32 v41, v43
  s_nop 0
  buffer_store_dwordx4 v[40:43], v30, s[8:11], s37 offen offset:0 sc1
  v_pk_fma_f32 v[88:89], v[26:27], v[168:169], v[88:89] op_sel_hi:[0,1,1] neg_lo:[1,0,0] neg_hi:[1,0,0]
  v_pk_fma_f32 v[90:91], v[26:27], v[170:171], v[90:91] op_sel_hi:[0,1,1] neg_lo:[1,0,0] neg_hi:[1,0,0]
  v_pk_fma_f32 v[92:93], v[26:27], v[172:173], v[92:93] op_sel_hi:[0,1,1] neg_lo:[1,0,0] neg_hi:[1,0,0]
  v_pk_fma_f32 v[94:95], v[26:27], v[174:175], v[94:95] op_sel_hi:[0,1,1] neg_lo:[1,0,0] neg_hi:[1,0,0]
  v_pk_mul_f32 v[88:89], v[28:29], v[88:89] op_sel_hi:[0,1]
  v_pk_mul_f32 v[90:91], v[28:29], v[90:91] op_sel_hi:[0,1]
  v_pk_mul_f32 v[92:93], v[28:29], v[92:93] op_sel_hi:[0,1]
  v_pk_mul_f32 v[94:95], v[28:29], v[94:95] op_sel_hi:[0,1]
  v_cvt_pk_bf16_f32 v44, v88, v89
  v_cvt_pk_bf16_f32 v45, v90, v91
  v_cvt_pk_bf16_f32 v46, v92, v93
  v_cvt_pk_bf16_f32 v47, v94, v95
  s_nop 1
  v_permlane32_swap_b32 v44, v46
  v_permlane32_swap_b32 v45, v47
  s_nop 0
  buffer_store_dwordx4 v[44:47], v30, s[8:11], s37 offen offset:512 sc1
  s_add_u32 s37, s37, 65536
  v_pk_fma_f32 v[96:97], v[22:23], v[176:177], v[96:97] op_sel_hi:[0,1,1] neg_lo:[1,0,0] neg_hi:[1,0,0]
  v_pk_fma_f32 v[98:99], v[22:23], v[178:179], v[98:99] op_sel_hi:[0,1,1] neg_lo:[1,0,0] neg_hi:[1,0,0]
  v_pk_fma_f32 v[100:101], v[22:23], v[180:181], v[100:101] op_sel_hi:[0,1,1] neg_lo:[1,0,0] neg_hi:[1,0,0]
  v_pk_fma_f32 v[102:103], v[22:23], v[182:183], v[102:103] op_sel_hi:[0,1,1] neg_lo:[1,0,0] neg_hi:[1,0,0]
  v_pk_mul_f32 v[96:97], v[24:25], v[96:97] op_sel_hi:[0,1]
  v_pk_mul_f32 v[98:99], v[24:25], v[98:99] op_sel_hi:[0,1]
  v_pk_mul_f32 v[100:101], v[24:25], v[100:101] op_sel_hi:[0,1]
  v_pk_mul_f32 v[102:103], v[24:25], v[102:103] op_sel_hi:[0,1]
  v_cvt_pk_bf16_f32 v32, v96, v97
  v_cvt_pk_bf16_f32 v33, v98, v99
  v_cvt_pk_bf16_f32 v34, v100, v101
  v_cvt_pk_bf16_f32 v35, v102, v103
  s_nop 1
  v_permlane32_swap_b32 v32, v34
  v_permlane32_swap_b32 v33, v35
  s_nop 0
  buffer_store_dwordx4 v[32:35], v30, s[8:11], s37 offen offset:0 sc1
  v_pk_fma_f32 v[112:113], v[26:27], v[176:177], v[112:113] op_sel_hi:[0,1,1] neg_lo:[1,0,0] neg_hi:[1,0,0]
  v_pk_fma_f32 v[114:115], v[26:27], v[178:179], v[114:115] op_sel_hi:[0,1,1] neg_lo:[1,0,0] neg_hi:[1,0,0]
  v_pk_fma_f32 v[116:117], v[26:27], v[180:181], v[116:117] op_sel_hi:[0,1,1] neg_lo:[1,0,0] neg_hi:[1,0,0]
  v_pk_fma_f32 v[118:119], v[26:27], v[182:183], v[118:119] op_sel_hi:[0,1,1] neg_lo:[1,0,0] neg_hi:[1,0,0]
  v_pk_mul_f32 v[112:113], v[28:29], v[112:113] op_sel_hi:[0,1]
  v_pk_mul_f32 v[114:115], v[28:29], v[114:115] op_sel_hi:[0,1]
  v_pk_mul_f32 v[116:117], v[28:29], v[116:117] op_sel_hi:[0,1]
  v_pk_mul_f32 v[118:119], v[28:29], v[118:119] op_sel_hi:[0,1]
  v_cvt_pk_bf16_f32 v36, v112, v113
  v_cvt_pk_bf16_f32 v37, v114, v115
  v_cvt_pk_bf16_f32 v38, v116, v117
  v_cvt_pk_bf16_f32 v39, v118, v119
  s_nop 1
  v_permlane32_swap_b32 v36, v38
  v_permlane32_swap_b32 v37, v39
  s_nop 0
  buffer_store_dwordx4 v[36:39], v30, s[8:11], s37 offen offset:512 sc1
  s_add_u32 s37, s37, 65536
  v_pk_fma_f32 v[104:105], v[22:23], v[184:185], v[104:105] op_sel_hi:[0,1,1] neg_lo:[1,0,0] neg_hi:[1,0,0]
  v_pk_fma_f32 v[106:107], v[22:23], v[186:187], v[106:107] op_sel_hi:[0,1,1] neg_lo:[1,0,0] neg_hi:[1,0,0]
  v_pk_fma_f32 v[108:109], v[22:23], v[188:189], v[108:109] op_sel_hi:[0,1,1] neg_lo:[1,0,0] neg_hi:[1,0,0]
  v_pk_fma_f32 v[110:111], v[22:23], v[190:191], v[110:111] op_sel_hi:[0,1,1] neg_lo:[1,0,0] neg_hi:[1,0,0]
  v_pk_mul_f32 v[104:105], v[24:25], v[104:105] op_sel_hi:[0,1]
  v_pk_mul_f32 v[106:107], v[24:25], v[106:107] op_sel_hi:[0,1]
  v_pk_mul_f32 v[108:109], v[24:25], v[108:109] op_sel_hi:[0,1]
  v_pk_mul_f32 v[110:111], v[24:25], v[110:111] op_sel_hi:[0,1]
  v_cvt_pk_bf16_f32 v40, v104, v105
  v_cvt_pk_bf16_f32 v41, v106, v107
  v_cvt_pk_bf16_f32 v42, v108, v109
  v_cvt_pk_bf16_f32 v43, v110, v111
  s_nop 1
  v_permlane32_swap_b32 v40, v42
  v_permlane32_swap_b32 v41, v43
  s_nop 0
  buffer_store_dwordx4 v[40:43], v30, s[8:11], s37 offen offset:0 sc1
  v_pk_fma_f32 v[120:121], v[26:27], v[184:185], v[120:121] op_sel_hi:[0,1,1] neg_lo:[1,0,0] neg_hi:[1,0,0]
  v_pk_fma_f32 v[122:123], v[26:27], v[186:187], v[122:123] op_sel_hi:[0,1,1] neg_lo:[1,0,0] neg_hi:[1,0,0]
  v_pk_fma_f32 v[124:125], v[26:27], v[188:189], v[124:125] op_sel_hi:[0,1,1] neg_lo:[1,0,0] neg_hi:[1,0,0]
  v_pk_fma_f32 v[126:127], v[26:27], v[190:191], v[126:127] op_sel_hi:[0,1,1] neg_lo:[1,0,0] neg_hi:[1,0,0]
  v_pk_mul_f32 v[120:121], v[28:29], v[120:121] op_sel_hi:[0,1]
  v_pk_mul_f32 v[122:123], v[28:29], v[122:123] op_sel_hi:[0,1]
  v_pk_mul_f32 v[124:125], v[28:29], v[124:125] op_sel_hi:[0,1]
  v_pk_mul_f32 v[126:127], v[28:29], v[126:127] op_sel_hi:[0,1]
  v_cvt_pk_bf16_f32 v44, v120, v121
  v_cvt_pk_bf16_f32 v45, v122, v123
  v_cvt_pk_bf16_f32 v46, v124, v125
  v_cvt_pk_bf16_f32 v47, v126, v127
  s_nop 1
  v_permlane32_swap_b32 v44, v46
  v_permlane32_swap_b32 v45, v47
  s_nop 0
  buffer_store_dwordx4 v[44:47], v30, s[8:11], s37 offen offset:512 sc1
  s_add_u32 s37, s37, 65536
main_qkv1_fin:
  s_waitcnt vmcnt(0)
main_qkv1_fin2:
  s_barrier
  s_cmp_eq_u32 s3, 0
  s_cbranch_scc0 main_ar19
  s_mul_i32 s46, s24, 128
  s_add_u32 s46, s46, s5
  s_add_u32 s46, s46, 24182784
  v_and_b32 v60, 63, v0
  v_lshlrev_b32 v60, 14, v60
  v_mov_b32 v61, 1
  s_mov_b64 s[44:45], exec
  s_mov_b64 exec, 255
  buffer_atomic_add v61, v60, s[8:11], s46 offen sc1
  s_mov_b64 exec, s[44:45]
main_ar19:
main_qkv1_end:
  v_and_b32 v1, 63, v0
  s_and_b32 s24, s2, 7
  s_lshr_b32 s25, s2, 3
  s_lshl_b32 s24, s24, 1
  s_and_b32 s26, s25, 1
  s_add_u32 s24, s24, s26
  s_lshr_b32 s25, s25, 1
  s_sub_u32 s26, s25, 2
  s_max_i32 s26, s26, 0
  s_mov_b32 s27, s25
  s_mov_b32 s42, s26
  s_mov_b32 s43, s27
  s_lshr_b32 s26, s3, 2
  s_and_b32 s28, s3, 3
  s_mul_i32 s29, s24, 5
  s_lshl_b32 s27, s29, 1
  s_mul_i32 s30, s26, 5
  s_add_u32 s27, s27, s30
  s_lshl_b32 s30, s25, 7
  s_lshl_b32 s31, s3, 6
  s_add_u32 s30, s30, s31
  s_sub_u32 s30, s30, 256
  s_max_i32 s30, s30, 0
  s_lshl_b32 s30, s30, 4
  s_add_u32 s31, s29, 80
  s_lshl_b32 s31, s31, 15
  s_add_u32 s30, s30, s31
  v_lshlrev_b32 v3, 4, v1
  v_add_u32 v3, s30, v3
  v_lshrrev_b32 v4, 5, v1
  v_and_b32 v5, 31, v1
  s_lshl_b32 s33, s25, 7
  s_lshl_b32 s34, s28, 5
  s_add_u32 s33, s33, s34
  v_add_u32 v6, s33, v5
  v_lshlrev_b32 v7, 4, v6
  s_mul_i32 s34, s26, 3
  s_add_u32 s36, s34, s29
  v_add_u32 v16, s36, v4
  v_lshlrev_b32 v16, 15, v16
  v_add_u32 v16, v16, v7
  v_mov_b32 v20, 0x3f803f80
  v_mov_b32 v21, 0x3f803f80
  v_mov_b32 v22, 0x3f803f80
  v_mov_b32 v23, 0x3f803f80
  v_lshlrev_b32 v17, 4, v0
  v_min_u32 v17, 6128, v17
  ds_write_b128 v17, v[20:23] offset:61760
  s_lshl_b32 s38, s28, 9
  v_add_u32 v18, s34, v4
  v_mul_u32_u24 v18, 6144, v18
  v_lshlrev_b32 v19, 4, v5
  v_add_u32 v19, s38, v19
  v_add_u32 v24, v18, v19
  v_add_u32 v25, 12288, v19
  v_lshrrev_b32 v18, 2, v1
  v_and_b32 v18, 3, v18
  v_lshlrev_b32 v19, 2, v4
  v_add_u32 v18, v18, v19
  v_lshlrev_b32 v18, 4, v18
  v_add_u32 v18, s38, v18
  v_lshrrev_b32 v19, 4, v1
  v_and_b32 v19, 1, v19
  v_lshlrev_b32 v19, 2, v19
  v_and_b32 v27, 3, v1
  v_add_u32 v19, v19, v27
  v_cmp_lt_u32 vcc, 4, v19
  v_cmp_eq_u32 s[44:45], 4, v19
  v_and_b32 v27, 1, v19
  v_lshlrev_b32 v27, 1, v27
  v_lshrrev_b32 v19, 1, v19
  v_and_b32 v19, 1, v19
  v_or_b32 v19, v19, v27
  s_mul_i32 s39, s26, 6
  v_add_u32 v19, s39, v19
  s_add_u32 s39, s26, 4
  v_mov_b32 v27, s39
  v_cndmask_b32 v19, v19, v27, s[44:45]
  v_and_b32 v27, 1, v19
  v_lshrrev_b32 v19, 1, v19
  v_cndmask_b32 v19, v19, 5, vcc
  v_mul_u32_u24 v19, 6208, v19
  v_lshlrev_b32 v27, 3, v27
  v_add_u32 v18, v18, v19
  v_add_u32 v18, v18, v27
  v_add_u32 v26, 30720, v18
  v_lshlrev_b32 v18, 2, v4
  v_sub_u32 v18, v5, v18
  v_cmp_gt_i32 s[48:49], 0, v18
  v_cmp_gt_i32 s[50:51], 1, v18
  v_cmp_gt_i32 s[52:53], 2, v18
  v_cmp_gt_i32 s[54:55], 3, v18
  v_cmp_gt_i32 s[56:57], 8, v18
  v_cmp_gt_i32 s[58:59], 9, v18
  v_cmp_gt_i32 s[60:61], 10, v18
  v_cmp_gt_i32 s[62:63], 11, v18
  v_cmp_gt_i32 s[64:65], 16, v18
  v_cmp_gt_i32 s[66:67], 17, v18
  v_cmp_gt_i32 s[68:69], 18, v18
  v_cmp_gt_i32 s[70:71], 19, v18
  v_cmp_gt_i32 s[72:73], 24, v18
  v_cmp_gt_i32 s[74:75], 25, v18
  v_cmp_gt_i32 s[76:77], 26, v18
  v_cmp_gt_i32 s[78:79], 27, v18
  v_mov_b32 v19, 0xffff
  v_mov_b32 v27, 0xffff0000
  v_cndmask_b32 v36, 0, v19, s[48:49]
  v_cndmask_b32 v37, 0, v27, s[50:51]
  v_or_b32 v28, v36, v37
  v_cndmask_b32 v36, 0, v19, s[52:53]
  v_cndmask_b32 v37, 0, v27, s[54:55]
  v_or_b32 v29, v36, v37
  v_cndmask_b32 v36, 0, v19, s[56:57]
  v_cndmask_b32 v37, 0, v27, s[58:59]
  v_or_b32 v30, v36, v37
  v_cndmask_b32 v36, 0, v19, s[60:61]
  v_cndmask_b32 v37, 0, v27, s[62:63]
  v_or_b32 v31, v36, v37
  v_cndmask_b32 v36, 0, v19, s[64:65]
  v_cndmask_b32 v37, 0, v27, s[66:67]
  v_or_b32 v32, v36, v37
  v_cndmask_b32 v36, 0, v19, s[68:69]
  v_cndmask_b32 v37, 0, v27, s[70:71]
  v_or_b32 v33, v36, v37
  v_cndmask_b32 v36, 0, v19, s[72:73]
  v_cndmask_b32 v37, 0, v27, s[74:75]
  v_or_b32 v34, v36, v37
  v_cndmask_b32 v36, 0, v19, s[76:77]
  v_cndmask_b32 v37, 0, v27, s[78:79]
  v_or_b32 v35, v36, v37
  s_cmp_eq_u32 s5, 0
  s_cbranch_scc0 main_adw21
  s_cmp_eq_u32 s3, 0
  s_cbranch_scc0 main_adw21
  v_and_b32 v60, 1, v0
  v_lshlrev_b32 v60, 7, v60
  s_mov_b32 s47, 0
main_dw22:
  buffer_load_dword v253, v60, s[80:83], 0 offen sc1
  s_add_u32 s47, s47, 1
  s_waitcnt vmcnt(0)
  v_cmp_gt_u32 vcc, 16, v253
  s_cmp_ge_u32 s47, 0x20000
  s_cbranch_scc1 main_de23
  s_cbranch_vccz main_de23
  s_sleep 2
  s_branch main_dw22
main_de23:
main_adw21:
  s_cmp_eq_u32 s3, 0
  s_cbranch_scc0 main_pw24
  v_and_b32 v60, 63, v0
  v_add_u32 v60, s42, v60
  v_min_u32 v60, s43, v60
  v_mul_u32_u24 v60, 128, v60
  s_add_u32 s46, s5, 24182784
  s_mov_b32 s47, 0
  s_and_b32 s45, s2, 7
  s_lshl_b32 s45, s45, 14
  s_add_u32 s46, s46, s45
  buffer_load_dword v252, v60, s[8:11], s46 offen sc1
main_pl25:
  s_waitcnt vmcnt(0)
  v_cmp_gt_u32 vcc, 15, v252
  s_cbranch_vccz main_pw24
  s_sleep 2
  buffer_load_dword v252, v60, s[8:11], s46 offen sc1
  s_add_u32 s47, s47, 1
  s_cmp_ge_u32 s47, 131072
  s_cbranch_scc0 main_pl25
main_pw24:
  s_barrier
  s_add_u32 s36, s29, 2
  s_lshl_b32 s36, s36, 15
  s_add_u32 s37, s5, 0
  s_add_u32 s36, s36, s37
  s_cmp_ge_u32 s3, 6
  s_cbranch_scc1 main_ld26
  s_lshl_b32 s31, s3, 10
  s_add_u32 s32, s5, 0
  s_add_u32 m0, s31, 0
  s_nop 0
  buffer_load_dwordx4 v3, s[8:11], s32 offen lds
  s_add_u32 s32, s32, 32768
  s_add_u32 m0, s31, 6144
  s_nop 0
  buffer_load_dwordx4 v3, s[8:11], s32 offen lds
  s_add_u32 s32, s32, 32768
  s_add_u32 m0, s31, 12288
  s_nop 0
  buffer_load_dwordx4 v3, s[8:11], s32 offen lds
  s_add_u32 s32, s32, 32768
  s_add_u32 m0, s31, 18432
  s_nop 0
  buffer_load_dwordx4 v3, s[8:11], s32 offen lds
  s_add_u32 s32, s32, 32768
  s_add_u32 m0, s31, 24576
  s_nop 0
  buffer_load_dwordx4 v3, s[8:11], s32 offen lds
  s_add_u32 s32, s32, 32768
  s_add_u32 s32, s32, 2457600
  s_add_u32 m0, s31, 30720
  s_nop 0
  buffer_load_dwordx4 v3, s[8:11], s32 offen lds
  s_add_u32 s32, s32, 32768
  s_add_u32 m0, s31, 36928
  s_nop 0
  buffer_load_dwordx4 v3, s[8:11], s32 offen lds
  s_add_u32 s32, s32, 32768
  s_add_u32 m0, s31, 43136
  s_nop 0
  buffer_load_dwordx4 v3, s[8:11], s32 offen lds
  s_add_u32 s32, s32, 32768
  s_add_u32 m0, s31, 49344
  s_nop 0
  buffer_load_dwordx4 v3, s[8:11], s32 offen lds
  s_add_u32 s32, s32, 32768
  s_add_u32 m0, s31, 55552
  s_nop 0
  buffer_load_dwordx4 v3, s[8:11], s32 offen lds
  s_add_u32 s32, s32, 32768
main_ld26:
  buffer_load_dwordx4 v[8:11], v16, s[8:11], s37 offen
  buffer_load_dwordx4 v[12:15], v7, s[8:11], s36 offen
  s_lshl_b32 s40, s25, 2
  s_add_u32 s40, s40, s28
  s_sub_u32 s40, 8, s40
  s_max_i32 s40, s40, 0
  s_waitcnt vmcnt(0) lgkmcnt(0)
  v_cmp_eq_u32 vcc, 0, v4
  s_cmp_eq_u32 s26, 1
  s_cselect_b64 s[42:43], 0, vcc
  s_cselect_b64 s[44:45], vcc, 0
  v_cndmask_b32 v12, 0, v12, s[42:43]
  v_cndmask_b32 v13, 0, v13, s[42:43]
  v_cndmask_b32 v14, 0, v14, s[44:45]
  v_cndmask_b32 v15, 0, v15, s[44:45]
  s_barrier
  ds_read_b128 v[112:115], v24 offset:0
  ds_read_b128 v[116:119], v25 offset:0
  ds_read_b128 v[120:123], v24 offset:4096
  ds_read_b128 v[124:127], v25 offset:4096
  ds_read_b128 v[128:131], v24 offset:512
  ds_read_b128 v[132:135], v25 offset:512
  s_waitcnt lgkmcnt(4)
  v_mfma_f32_32x32x16_bf16 v[64:79], v[112:115], v[8:11], 0
  v_mfma_f32_32x32x16_bf16 v[64:79], v[116:119], v[12:15], v[64:79]
  s_waitcnt lgkmcnt(2)
  v_mfma_f32_32x32x16_bf16 v[80:95], v[120:123], v[8:11], 0
  v_mfma_f32_32x32x16_bf16 v[80:95], v[124:127], v[12:15], v[80:95]
  ds_read_b128 v[112:115], v24 offset:1024
  ds_read_b128 v[116:119], v25 offset:1024
  s_waitcnt lgkmcnt(2)
  v_mfma_f32_32x32x16_bf16 v[96:111], v[128:131], v[8:11], 0
  v_mfma_f32_32x32x16_bf16 v[96:111], v[132:135], v[12:15], v[96:111]
  s_nop 7
  s_nop 3
  s_cmp_eq_u32 s40, 0
  s_cbranch_scc1 main_mg27
  v_mov_b32 v64, 0xff61b1e6
  v_mov_b32 v65, 0xff61b1e6
  v_mov_b32 v66, 0xff61b1e6
  v_mov_b32 v67, 0xff61b1e6
  v_mov_b32 v68, 0xff61b1e6
  v_mov_b32 v69, 0xff61b1e6
  v_mov_b32 v70, 0xff61b1e6
  v_mov_b32 v71, 0xff61b1e6
  v_mov_b32 v72, 0xff61b1e6
  v_mov_b32 v73, 0xff61b1e6
  v_mov_b32 v74, 0xff61b1e6
  v_mov_b32 v75, 0xff61b1e6
  v_mov_b32 v76, 0xff61b1e6
  v_mov_b32 v77, 0xff61b1e6
  v_mov_b32 v78, 0xff61b1e6
  v_mov_b32 v79, 0xff61b1e6
main_mg27:
  v_cndmask_b32 v64, v80, v64, s[48:49]
  v_cndmask_b32 v65, v81, v65, s[50:51]
  v_cndmask_b32 v66, v82, v66, s[52:53]
  v_cndmask_b32 v67, v83, v67, s[54:55]
  v_cndmask_b32 v68, v84, v68, s[56:57]
  v_cndmask_b32 v69, v85, v69, s[58:59]
  v_cndmask_b32 v70, v86, v70, s[60:61]
  v_cndmask_b32 v71, v87, v71, s[62:63]
  v_cndmask_b32 v72, v88, v72, s[64:65]
  v_cndmask_b32 v73, v89, v73, s[66:67]
  v_cndmask_b32 v74, v90, v74, s[68:69]
  v_cndmask_b32 v75, v91, v75, s[70:71]
  v_cndmask_b32 v76, v92, v76, s[72:73]
  v_cndmask_b32 v77, v93, v77, s[74:75]
  v_cndmask_b32 v78, v94, v78, s[76:77]
  v_cndmask_b32 v79, v95, v79, s[78:79]
  v_max3_f32 v38, v64, v65, v66
  v_max3_f32 v39, v67, v68, v69
  v_max3_f32 v39, v39, v70, v71
  v_max3_f32 v38, v38, v72, v73
  v_max3_f32 v39, v39, v74, v75
  v_max3_f32 v38, v38, v76, v77
  v_max3_f32 v39, v39, v78, v79
  ds_read_b128 v[120:123], v24 offset:1536
  ds_read_b128 v[124:127], v25 offset:1536
  s_waitcnt lgkmcnt(2)
  v_mfma_f32_32x32x16_bf16 v[64:79], v[112:115], v[8:11], 0
  v_mfma_f32_32x32x16_bf16 v[64:79], v[116:119], v[12:15], v[64:79]
  s_cmp_gt_u32 s40, 1
  s_cbranch_scc1 main_sk28
  v_max3_f32 v38, v38, v96, v97
  v_max3_f32 v39, v39, v98, v99
  v_max3_f32 v38, v38, v100, v101
  v_max3_f32 v39, v39, v102, v103
  v_max3_f32 v38, v38, v104, v105
  v_max3_f32 v39, v39, v106, v107
  v_max3_f32 v38, v38, v108, v109
  v_max3_f32 v39, v39, v110, v111
main_nx29:
  ds_read_b128 v[128:131], v24 offset:2048
  ds_read_b128 v[132:135], v25 offset:2048
  s_waitcnt lgkmcnt(2)
  v_mfma_f32_32x32x16_bf16 v[80:95], v[120:123], v[8:11], 0
  v_mfma_f32_32x32x16_bf16 v[80:95], v[124:127], v[12:15], v[80:95]
  s_cmp_gt_u32 s40, 2
  s_cbranch_scc1 main_sk30
  v_max3_f32 v38, v38, v64, v65
  v_max3_f32 v39, v39, v66, v67
  v_max3_f32 v38, v38, v68, v69
  v_max3_f32 v39, v39, v70, v71
  v_max3_f32 v38, v38, v72, v73
  v_max3_f32 v39, v39, v74, v75
  v_max3_f32 v38, v38, v76, v77
  v_max3_f32 v39, v39, v78, v79
main_nx31:
  ds_read_b128 v[112:115], v24 offset:2560
  ds_read_b128 v[116:119], v25 offset:2560
  s_waitcnt lgkmcnt(2)
  v_mfma_f32_32x32x16_bf16 v[64:79], v[128:131], v[8:11], 0
  v_mfma_f32_32x32x16_bf16 v[64:79], v[132:135], v[12:15], v[64:79]
  s_cmp_gt_u32 s40, 3
  s_cbranch_scc1 main_sk32
  v_max3_f32 v38, v38, v80, v81
  v_max3_f32 v39, v39, v82, v83
  v_max3_f32 v38, v38, v84, v85
  v_max3_f32 v39, v39, v86, v87
  v_max3_f32 v38, v38, v88, v89
  v_max3_f32 v39, v39, v90, v91
  v_max3_f32 v38, v38, v92, v93
  v_max3_f32 v39, v39, v94, v95
main_nx33:
  ds_read_b128 v[120:123], v24 offset:3072
  ds_read_b128 v[124:127], v25 offset:3072
  s_waitcnt lgkmcnt(2)
  v_mfma_f32_32x32x16_bf16 v[80:95], v[112:115], v[8:11], 0
  v_mfma_f32_32x32x16_bf16 v[80:95], v[116:119], v[12:15], v[80:95]
  s_cmp_gt_u32 s40, 4
  s_cbranch_scc1 main_sk34
  v_max3_f32 v38, v38, v64, v65
  v_max3_f32 v39, v39, v66, v67
  v_max3_f32 v38, v38, v68, v69
  v_max3_f32 v39, v39, v70, v71
  v_max3_f32 v38, v38, v72, v73
  v_max3_f32 v39, v39, v74, v75
  v_max3_f32 v38, v38, v76, v77
  v_max3_f32 v39, v39, v78, v79
main_nx35:
  ds_read_b128 v[128:131], v24 offset:3584
  ds_read_b128 v[132:135], v25 offset:3584
  s_waitcnt lgkmcnt(2)
  v_mfma_f32_32x32x16_bf16 v[64:79], v[120:123], v[8:11], 0
  v_mfma_f32_32x32x16_bf16 v[64:79], v[124:127], v[12:15], v[64:79]
  s_cmp_gt_u32 s40, 5
  s_cbranch_scc1 main_sk36
  v_max3_f32 v38, v38, v80, v81
  v_max3_f32 v39, v39, v82, v83
  v_max3_f32 v38, v38, v84, v85
  v_max3_f32 v39, v39, v86, v87
  v_max3_f32 v38, v38, v88, v89
  v_max3_f32 v39, v39, v90, v91
  v_max3_f32 v38, v38, v92, v93
  v_max3_f32 v39, v39, v94, v95
main_nx37:
  s_waitcnt lgkmcnt(0)
  v_mfma_f32_32x32x16_bf16 v[80:95], v[128:131], v[8:11], 0
  v_mfma_f32_32x32x16_bf16 v[80:95], v[132:135], v[12:15], v[80:95]
  s_cmp_gt_u32 s40, 6
  s_cbranch_scc1 main_sk38
  v_max3_f32 v38, v38, v64, v65
  v_max3_f32 v39, v39, v66, v67
  v_max3_f32 v38, v38, v68, v69
  v_max3_f32 v39, v39, v70, v71
  v_max3_f32 v38, v38, v72, v73
  v_max3_f32 v39, v39, v74, v75
  v_max3_f32 v38, v38, v76, v77
  v_max3_f32 v39, v39, v78, v79
main_nx39:
  ds_read_b128 v[112:115], v24 offset:0
  ds_read_b128 v[116:119], v25 offset:0
  ds_read_b128 v[120:123], v24 offset:4096
  ds_read_b128 v[124:127], v25 offset:4096
  s_nop 7
  s_cmp_gt_u32 s40, 7
  s_cbranch_scc1 main_sk40
  v_max3_f32 v38, v38, v80, v81
  v_max3_f32 v39, v39, v82, v83
  v_max3_f32 v38, v38, v84, v85
  v_max3_f32 v39, v39, v86, v87
  v_max3_f32 v38, v38, v88, v89
  v_max3_f32 v39, v39, v90, v91
  v_max3_f32 v38, v38, v92, v93
  v_max3_f32 v39, v39, v94, v95
main_nx41:
  v_max_f32 v38, v38, v39
  v_mov_b32 v39, v38
  s_nop 1
  v_permlane32_swap_b32 v38, v39
  s_nop 1
  v_max_f32 v38, v38, v39
  v_sub_f32 v160, 0, v38
  v_sub_f32 v161, 0, v38
  v_sub_f32 v162, 0, v38
  v_sub_f32 v163, 0, v38
  v_sub_f32 v164, 0, v38
  v_sub_f32 v165, 0, v38
  v_sub_f32 v166, 0, v38
  v_sub_f32 v167, 0, v38
  v_sub_f32 v168, 0, v38
  v_sub_f32 v169, 0, v38
  v_sub_f32 v170, 0, v38
  v_sub_f32 v171, 0, v38
  v_sub_f32 v172, 0, v38
  v_sub_f32 v173, 0, v38
  v_sub_f32 v174, 0, v38
  v_sub_f32 v175, 0, v38
  ds_read_b128 v[128:131], v24 offset:512
  ds_read_b128 v[132:135], v25 offset:512
  ds_read_b64_tr_b16 v[136:137], v26 offset:0
  ds_read_b64_tr_b16 v[138:139], v26 offset:128
  ds_read_b64_tr_b16 v[140:141], v26 offset:256
  ds_read_b64_tr_b16 v[142:143], v26 offset:384
  ds_read_b64_tr_b16 v[144:145], v26 offset:4096
  ds_read_b64_tr_b16 v[146:147], v26 offset:4224
  ds_read_b64_tr_b16 v[148:149], v26 offset:4352
  ds_read_b64_tr_b16 v[150:151], v26 offset:4480
  s_nop 1
  s_waitcnt lgkmcnt(12)
  v_mfma_f32_32x32x16_bf16 v[64:79], v[112:115], v[8:11], v[160:175]
  v_mfma_f32_32x32x16_bf16 v[64:79], v[116:119], v[12:15], v[64:79]
  s_waitcnt lgkmcnt(10)
  v_mfma_f32_32x32x16_bf16 v[80:95], v[120:123], v[8:11], v[160:175]
  v_mfma_f32_32x32x16_bf16 v[80:95], v[124:127], v[12:15], v[80:95]
  s_waitcnt lgkmcnt(8)
  v_mfma_f32_32x32x16_bf16 v[96:111], v[128:131], v[8:11], v[160:175]
  v_mfma_f32_32x32x16_bf16 v[96:111], v[132:135], v[12:15], v[96:111]
  ds_read_b128 v[112:115], v24 offset:1024
  ds_read_b128 v[116:119], v25 offset:1024
  ds_read_b64_tr_b16 v[152:153], v26 offset:512
  ds_read_b64_tr_b16 v[154:155], v26 offset:640
  ds_read_b64_tr_b16 v[156:157], v26 offset:768
  ds_read_b64_tr_b16 v[158:159], v26 offset:896
  s_nop 7
  s_nop 3
  s_cmp_eq_u32 s40, 0
  s_cbranch_scc1 main_mg42
  v_mov_b32 v64, 0xff61b1e6
  v_mov_b32 v65, 0xff61b1e6
  v_mov_b32 v66, 0xff61b1e6
  v_mov_b32 v67, 0xff61b1e6
  v_mov_b32 v68, 0xff61b1e6
  v_mov_b32 v69, 0xff61b1e6
  v_mov_b32 v70, 0xff61b1e6
  v_mov_b32 v71, 0xff61b1e6
  v_mov_b32 v72, 0xff61b1e6
  v_mov_b32 v73, 0xff61b1e6
  v_mov_b32 v74, 0xff61b1e6
  v_mov_b32 v75, 0xff61b1e6
  v_mov_b32 v76, 0xff61b1e6
  v_mov_b32 v77, 0xff61b1e6
  v_mov_b32 v78, 0xff61b1e6
  v_mov_b32 v79, 0xff61b1e6
main_mg42:
  v_cndmask_b32 v64, v80, v64, s[48:49]
  v_cndmask_b32 v65, v81, v65, s[50:51]
  v_cndmask_b32 v66, v82, v66, s[52:53]
  v_cndmask_b32 v67, v83, v67, s[54:55]
  v_cndmask_b32 v68, v84, v68, s[56:57]
  v_cndmask_b32 v69, v85, v69, s[58:59]
  v_cndmask_b32 v70, v86, v70, s[60:61]
  v_cndmask_b32 v71, v87, v71, s[62:63]
  v_cndmask_b32 v72, v88, v72, s[64:65]
  v_cndmask_b32 v73, v89, v73, s[66:67]
  v_cndmask_b32 v74, v90, v74, s[68:69]
  v_cndmask_b32 v75, v91, v75, s[70:71]
  v_cndmask_b32 v76, v92, v76, s[72:73]
  v_cndmask_b32 v77, v93, v77, s[74:75]
  v_cndmask_b32 v78, v94, v78, s[76:77]
  v_cndmask_b32 v79, v95, v79, s[78:79]
  v_exp_f32 v64, v64
  v_exp_f32 v65, v65
  v_exp_f32 v66, v66
  v_exp_f32 v67, v67
  v_exp_f32 v68, v68
  v_exp_f32 v69, v69
  v_exp_f32 v70, v70
  v_exp_f32 v71, v71
  v_exp_f32 v72, v72
  v_exp_f32 v73, v73
  v_exp_f32 v74, v74
  v_exp_f32 v75, v75
  v_exp_f32 v76, v76
  v_exp_f32 v77, v77
  v_exp_f32 v78, v78
  v_exp_f32 v79, v79
  v_cvt_pk_bf16_f32 v40, v64, v65
  v_cvt_pk_bf16_f32 v41, v66, v67
  v_cvt_pk_bf16_f32 v42, v68, v69
  v_cvt_pk_bf16_f32 v43, v70, v71
  v_cvt_pk_bf16_f32 v44, v72, v73
  v_cvt_pk_bf16_f32 v45, v74, v75
  v_cvt_pk_bf16_f32 v46, v76, v77
  v_cvt_pk_bf16_f32 v47, v78, v79
  v_and_b32 v48, v40, v28
  v_and_b32 v49, v41, v29
  v_and_b32 v50, v42, v30
  v_and_b32 v51, v43, v31
  v_and_b32 v52, v44, v32
  v_and_b32 v53, v45, v33
  v_and_b32 v54, v46, v34
  v_and_b32 v55, v47, v35
  v_xor_b32 v40, v40, v48
  v_xor_b32 v41, v41, v49
  v_xor_b32 v42, v42, v50
  v_xor_b32 v43, v43, v51
  v_xor_b32 v44, v44, v52
  v_xor_b32 v45, v45, v53
  v_xor_b32 v46, v46, v54
  v_xor_b32 v47, v47, v55
  s_nop 1
  s_waitcnt lgkmcnt(10)
  v_mfma_f32_32x32x16_bf16 v[176:191], v[136:139], v[48:51], 0
  v_mfma_f32_32x32x16_bf16 v[176:191], v[140:143], v[52:55], v[176:191]
  s_waitcnt lgkmcnt(6)
  v_mfma_f32_32x32x16_bf16 v[176:191], v[144:147], v[40:43], v[176:191]
  v_mfma_f32_32x32x16_bf16 v[176:191], v[148:151], v[44:47], v[176:191]
  s_waitcnt lgkmcnt(4)
  v_mfma_f32_32x32x16_bf16 v[64:79], v[112:115], v[8:11], v[160:175]
  v_mfma_f32_32x32x16_bf16 v[64:79], v[116:119], v[12:15], v[64:79]
  ds_read_b64_tr_b16 v[136:137], v26 offset:1024
  ds_read_b64_tr_b16 v[138:139], v26 offset:1152
  ds_read_b64_tr_b16 v[140:141], v26 offset:1280
  ds_read_b64_tr_b16 v[142:143], v26 offset:1408
  ds_read_b128 v[120:123], v24 offset:1536
  ds_read_b128 v[124:127], v25 offset:1536
  s_cmp_gt_u32 s40, 1
  s_cbranch_scc1 main_sk43
  v_exp_f32 v96, v96
  v_exp_f32 v97, v97
  v_exp_f32 v98, v98
  v_exp_f32 v99, v99
  v_exp_f32 v100, v100
  v_exp_f32 v101, v101
  v_exp_f32 v102, v102
  v_exp_f32 v103, v103
  v_exp_f32 v104, v104
  v_exp_f32 v105, v105
  v_exp_f32 v106, v106
  v_exp_f32 v107, v107
  v_exp_f32 v108, v108
  v_exp_f32 v109, v109
  v_exp_f32 v110, v110
  v_exp_f32 v111, v111
  v_cvt_pk_bf16_f32 v40, v96, v97
  v_cvt_pk_bf16_f32 v41, v98, v99
  v_cvt_pk_bf16_f32 v42, v100, v101
  v_cvt_pk_bf16_f32 v43, v102, v103
  v_cvt_pk_bf16_f32 v44, v104, v105
  v_cvt_pk_bf16_f32 v45, v106, v107
  v_cvt_pk_bf16_f32 v46, v108, v109
  v_cvt_pk_bf16_f32 v47, v110, v111
  s_nop 1
  s_waitcnt lgkmcnt(6)
  v_mfma_f32_32x32x16_bf16 v[176:191], v[152:155], v[40:43], v[176:191]
  v_mfma_f32_32x32x16_bf16 v[176:191], v[156:159], v[44:47], v[176:191]
main_nx44:
  s_waitcnt lgkmcnt(0)
  v_mfma_f32_32x32x16_bf16 v[80:95], v[120:123], v[8:11], v[160:175]
  v_mfma_f32_32x32x16_bf16 v[80:95], v[124:127], v[12:15], v[80:95]
  ds_read_b64_tr_b16 v[144:145], v26 offset:1536
  ds_read_b64_tr_b16 v[146:147], v26 offset:1664
  ds_read_b64_tr_b16 v[148:149], v26 offset:1792
  ds_read_b64_tr_b16 v[150:151], v26 offset:1920
  ds_read_b128 v[128:131], v24 offset:2048
  ds_read_b128 v[132:135], v25 offset:2048
  s_cmp_gt_u32 s40, 2
  s_cbranch_scc1 main_sk45
  v_exp_f32 v64, v64
  v_exp_f32 v65, v65
  v_exp_f32 v66, v66
  v_exp_f32 v67, v67
  v_exp_f32 v68, v68
  v_exp_f32 v69, v69
  v_exp_f32 v70, v70
  v_exp_f32 v71, v71
  v_exp_f32 v72, v72
  v_exp_f32 v73, v73
  v_exp_f32 v74, v74
  v_exp_f32 v75, v75
  v_exp_f32 v76, v76
  v_exp_f32 v77, v77
  v_exp_f32 v78, v78
  v_exp_f32 v79, v79
  v_cvt_pk_bf16_f32 v40, v64, v65
  v_cvt_pk_bf16_f32 v41, v66, v67
  v_cvt_pk_bf16_f32 v42, v68, v69
  v_cvt_pk_bf16_f32 v43, v70, v71
  v_cvt_pk_bf16_f32 v44, v72, v73
  v_cvt_pk_bf16_f32 v45, v74, v75
  v_cvt_pk_bf16_f32 v46, v76, v77
  v_cvt_pk_bf16_f32 v47, v78, v79
  s_nop 1
  s_waitcnt lgkmcnt(8)
  v_mfma_f32_32x32x16_bf16 v[176:191], v[136:139], v[40:43], v[176:191]
  v_mfma_f32_32x32x16_bf16 v[176:191], v[140:143], v[44:47], v[176:191]
main_nx46:
  s_waitcnt lgkmcnt(0)
  v_mfma_f32_32x32x16_bf16 v[64:79], v[128:131], v[8:11], v[160:175]
  v_mfma_f32_32x32x16_bf16 v[64:79], v[132:135], v[12:15], v[64:79]
  ds_read_b64_tr_b16 v[152:153], v26 offset:2048
  ds_read_b64_tr_b16 v[154:155], v26 offset:2176
  ds_read_b64_tr_b16 v[156:157], v26 offset:2304
  ds_read_b64_tr_b16 v[158:159], v26 offset:2432
  ds_read_b128 v[112:115], v24 offset:2560
  ds_read_b128 v[116:119], v25 offset:2560
  s_cmp_gt_u32 s40, 3
  s_cbranch_scc1 main_sk47
  v_exp_f32 v80, v80
  v_exp_f32 v81, v81
  v_exp_f32 v82, v82
  v_exp_f32 v83, v83
  v_exp_f32 v84, v84
  v_exp_f32 v85, v85
  v_exp_f32 v86, v86
  v_exp_f32 v87, v87
  v_exp_f32 v88, v88
  v_exp_f32 v89, v89
  v_exp_f32 v90, v90
  v_exp_f32 v91, v91
  v_exp_f32 v92, v92
  v_exp_f32 v93, v93
  v_exp_f32 v94, v94
  v_exp_f32 v95, v95
  v_cvt_pk_bf16_f32 v40, v80, v81
  v_cvt_pk_bf16_f32 v41, v82, v83
  v_cvt_pk_bf16_f32 v42, v84, v85
  v_cvt_pk_bf16_f32 v43, v86, v87
  v_cvt_pk_bf16_f32 v44, v88, v89
  v_cvt_pk_bf16_f32 v45, v90, v91
  v_cvt_pk_bf16_f32 v46, v92, v93
  v_cvt_pk_bf16_f32 v47, v94, v95
  s_nop 1
  s_waitcnt lgkmcnt(8)
  v_mfma_f32_32x32x16_bf16 v[176:191], v[144:147], v[40:43], v[176:191]
  v_mfma_f32_32x32x16_bf16 v[176:191], v[148:151], v[44:47], v[176:191]
main_nx48:
  s_waitcnt lgkmcnt(0)
  v_mfma_f32_32x32x16_bf16 v[80:95], v[112:115], v[8:11], v[160:175]
  v_mfma_f32_32x32x16_bf16 v[80:95], v[116:119], v[12:15], v[80:95]
  ds_read_b64_tr_b16 v[136:137], v26 offset:2560
  ds_read_b64_tr_b16 v[138:139], v26 offset:2688
  ds_read_b64_tr_b16 v[140:141], v26 offset:2816
  ds_read_b64_tr_b16 v[142:143], v26 offset:2944
  ds_read_b128 v[120:123], v24 offset:3072
  ds_read_b128 v[124:127], v25 offset:3072
  s_cmp_gt_u32 s40, 4
  s_cbranch_scc1 main_sk49
  v_exp_f32 v64, v64
  v_exp_f32 v65, v65
  v_exp_f32 v66, v66
  v_exp_f32 v67, v67
  v_exp_f32 v68, v68
  v_exp_f32 v69, v69
  v_exp_f32 v70, v70
  v_exp_f32 v71, v71
  v_exp_f32 v72, v72
  v_exp_f32 v73, v73
  v_exp_f32 v74, v74
  v_exp_f32 v75, v75
  v_exp_f32 v76, v76
  v_exp_f32 v77, v77
  v_exp_f32 v78, v78
  v_exp_f32 v79, v79
  v_cvt_pk_bf16_f32 v40, v64, v65
  v_cvt_pk_bf16_f32 v41, v66, v67
  v_cvt_pk_bf16_f32 v42, v68, v69
  v_cvt_pk_bf16_f32 v43, v70, v71
  v_cvt_pk_bf16_f32 v44, v72, v73
  v_cvt_pk_bf16_f32 v45, v74, v75
  v_cvt_pk_bf16_f32 v46, v76, v77
  v_cvt_pk_bf16_f32 v47, v78, v79
  s_nop 1
  s_waitcnt lgkmcnt(8)
  v_mfma_f32_32x32x16_bf16 v[176:191], v[152:155], v[40:43], v[176:191]
  v_mfma_f32_32x32x16_bf16 v[176:191], v[156:159], v[44:47], v[176:191]
main_nx50:
  s_waitcnt lgkmcnt(0)
  v_mfma_f32_32x32x16_bf16 v[64:79], v[120:123], v[8:11], v[160:175]
  v_mfma_f32_32x32x16_bf16 v[64:79], v[124:127], v[12:15], v[64:79]
  ds_read_b64_tr_b16 v[144:145], v26 offset:3072
  ds_read_b64_tr_b16 v[146:147], v26 offset:3200
  ds_read_b64_tr_b16 v[148:149], v26 offset:3328
  ds_read_b64_tr_b16 v[150:151], v26 offset:3456
  ds_read_b128 v[128:131], v24 offset:3584
  ds_read_b128 v[132:135], v25 offset:3584
  s_cmp_gt_u32 s40, 5
  s_cbranch_scc1 main_sk51
  v_exp_f32 v80, v80
  v_exp_f32 v81, v81
  v_exp_f32 v82, v82
  v_exp_f32 v83, v83
  v_exp_f32 v84, v84
  v_exp_f32 v85, v85
  v_exp_f32 v86, v86
  v_exp_f32 v87, v87
  v_exp_f32 v88, v88
  v_exp_f32 v89, v89
  v_exp_f32 v90, v90
  v_exp_f32 v91, v91
  v_exp_f32 v92, v92
  v_exp_f32 v93, v93
  v_exp_f32 v94, v94
  v_exp_f32 v95, v95
  v_cvt_pk_bf16_f32 v40, v80, v81
  v_cvt_pk_bf16_f32 v41, v82, v83
  v_cvt_pk_bf16_f32 v42, v84, v85
  v_cvt_pk_bf16_f32 v43, v86, v87
  v_cvt_pk_bf16_f32 v44, v88, v89
  v_cvt_pk_bf16_f32 v45, v90, v91
  v_cvt_pk_bf16_f32 v46, v92, v93
  v_cvt_pk_bf16_f32 v47, v94, v95
  s_nop 1
  s_waitcnt lgkmcnt(8)
  v_mfma_f32_32x32x16_bf16 v[176:191], v[136:139], v[40:43], v[176:191]
  v_mfma_f32_32x32x16_bf16 v[176:191], v[140:143], v[44:47], v[176:191]
main_nx52:
  s_waitcnt lgkmcnt(0)
  v_mfma_f32_32x32x16_bf16 v[80:95], v[128:131], v[8:11], v[160:175]
  v_mfma_f32_32x32x16_bf16 v[80:95], v[132:135], v[12:15], v[80:95]
  ds_read_b64_tr_b16 v[152:153], v26 offset:3584
  ds_read_b64_tr_b16 v[154:155], v26 offset:3712
  ds_read_b64_tr_b16 v[156:157], v26 offset:3840
  ds_read_b64_tr_b16 v[158:159], v26 offset:3968
  s_cmp_gt_u32 s40, 6
  s_cbranch_scc1 main_sk53
  v_exp_f32 v64, v64
  v_exp_f32 v65, v65
  v_exp_f32 v66, v66
  v_exp_f32 v67, v67
  v_exp_f32 v68, v68
  v_exp_f32 v69, v69
  v_exp_f32 v70, v70
  v_exp_f32 v71, v71
  v_exp_f32 v72, v72
  v_exp_f32 v73, v73
  v_exp_f32 v74, v74
  v_exp_f32 v75, v75
  v_exp_f32 v76, v76
  v_exp_f32 v77, v77
  v_exp_f32 v78, v78
  v_exp_f32 v79, v79
  v_cvt_pk_bf16_f32 v40, v64, v65
  v_cvt_pk_bf16_f32 v41, v66, v67
  v_cvt_pk_bf16_f32 v42, v68, v69
  v_cvt_pk_bf16_f32 v43, v70, v71
  v_cvt_pk_bf16_f32 v44, v72, v73
  v_cvt_pk_bf16_f32 v45, v74, v75
  v_cvt_pk_bf16_f32 v46, v76, v77
  v_cvt_pk_bf16_f32 v47, v78, v79
  s_nop 1
  s_waitcnt lgkmcnt(6)
  v_mfma_f32_32x32x16_bf16 v[176:191], v[144:147], v[40:43], v[176:191]
  v_mfma_f32_32x32x16_bf16 v[176:191], v[148:151], v[44:47], v[176:191]
main_nx54:
  s_cmp_gt_u32 s40, 7
  s_cbranch_scc1 main_sk55
  v_exp_f32 v80, v80
  v_exp_f32 v81, v81
  v_exp_f32 v82, v82
  v_exp_f32 v83, v83
  v_exp_f32 v84, v84
  v_exp_f32 v85, v85
  v_exp_f32 v86, v86
  v_exp_f32 v87, v87
  v_exp_f32 v88, v88
  v_exp_f32 v89, v89
  v_exp_f32 v90, v90
  v_exp_f32 v91, v91
  v_exp_f32 v92, v92
  v_exp_f32 v93, v93
  v_exp_f32 v94, v94
  v_exp_f32 v95, v95
  v_cvt_pk_bf16_f32 v40, v80, v81
  v_cvt_pk_bf16_f32 v41, v82, v83
  v_cvt_pk_bf16_f32 v42, v84, v85
  v_cvt_pk_bf16_f32 v43, v86, v87
  v_cvt_pk_bf16_f32 v44, v88, v89
  v_cvt_pk_bf16_f32 v45, v90, v91
  v_cvt_pk_bf16_f32 v46, v92, v93
  v_cvt_pk_bf16_f32 v47, v94, v95
  s_nop 1
  s_waitcnt lgkmcnt(0)
  v_mfma_f32_32x32x16_bf16 v[176:191], v[152:155], v[40:43], v[176:191]
  v_mfma_f32_32x32x16_bf16 v[176:191], v[156:159], v[44:47], v[176:191]
main_nx56:
  s_nop 7
  s_nop 7
  v_rcp_f32 v38, v188
  s_mul_i32 s34, s26, 3
  s_add_u32 s34, s34, s29
  v_add_u32 v18, s34, v4
  v_lshlrev_b32 v18, 15, v18
  v_add_u32 v18, v18, v7
  s_add_u32 s36, s5, 7864320
  s_add_u32 s37, s29, 2
  s_lshl_b32 s37, s37, 15
  s_add_u32 s37, s37, s36
  s_lshl_b32 s38, s28, 9
  v_lshlrev_b32 v19, 3, v1
  v_add_u32 v19, s38, v19
  v_add_u32 v19, 98304, v19
  v_mul_f32 v176, v176, v38
  v_mul_f32 v177, v177, v38
  v_mul_f32 v178, v178, v38
  v_mul_f32 v179, v179, v38
  v_mul_f32 v180, v180, v38
  v_mul_f32 v181, v181, v38
  v_mul_f32 v182, v182, v38
  v_mul_f32 v183, v183, v38
  v_mul_f32 v184, v184, v38
  v_mul_f32 v185, v185, v38
  v_mul_f32 v186, v186, v38
  v_mul_f32 v187, v187, v38
  v_cvt_pk_bf16_f32 v40, v176, v177
  v_cvt_pk_bf16_f32 v41, v178, v179
  v_cvt_pk_bf16_f32 v42, v180, v181
  v_cvt_pk_bf16_f32 v43, v182, v183
  v_cvt_pk_bf16_f32 v44, v184, v185
  v_cvt_pk_bf16_f32 v45, v186, v187
  buffer_store_dwordx4 v[40:43], v18, s[8:11], s36 offen sc1
  s_cmp_eq_u32 s26, 1
  s_cbranch_scc0 main_ae58
  ds_write_b64 v19, v[44:45] offset:0
  s_waitcnt lgkmcnt(0)
  s_barrier
  s_branch main_ao57
main_ae58:
  s_barrier
  ds_read_b64 v[46:47], v19
  v_cmp_gt_u32 vcc, 32, v1
  s_and_saveexec_b64 s[42:43], vcc
  s_waitcnt lgkmcnt(0)
  buffer_store_dwordx4 v[44:47], v7, s[8:11], s37 offen sc1
  s_mov_b64 exec, s[42:43]
main_ao57:
  s_waitcnt vmcnt(0)
  s_barrier
  s_cmp_eq_u32 s3, 0
  s_cbranch_scc0 main_ar59
  s_mul_i32 s46, s25, 128
  s_add_u32 s46, s46, s5
  s_add_u32 s46, s46, 24184832
  v_and_b32 v60, 63, v0
  v_lshlrev_b32 v60, 14, v60
  v_mov_b32 v61, 1
  s_mov_b64 s[44:45], exec
  s_mov_b64 exec, 255
  buffer_atomic_add v61, v60, s[8:11], s46 offen sc1
  s_mov_b64 exec, s[44:45]
main_ar59:
  s_and_b32 s24, s2, 7
  s_lshr_b32 s25, s2, 3
  s_cmp_ge_u32 s25, 28
  s_cbranch_scc1 main_wo60_end
  v_and_b32 v1, 63, v0
  s_mov_b32 s28, s3
  s_mul_i32 s26, s24, 28
  s_add_u32 s26, s26, s25
  s_cmp_ge_u32 s26, 220
  s_cbranch_scc1 main_wo60_end
  s_mul_i32 s24, s26, 6554
  s_lshr_b32 s24, s24, 16
  s_mul_i32 s25, s24, 10
  s_sub_u32 s25, s26, s25
  s_mul_i32 s42, s24, 3
  s_add_u32 s43, s42, 2
  s_lshr_b32 s42, s42, 2
  s_lshr_b32 s43, s43, 2
  s_min_u32 s43, s43, 15
  s_cmp_ge_u32 s28, 4
  s_cbranch_scc0 main_wo60_cons
  s_sub_u32 s28, s28, 4
  s_mul_i32 s29, s28, 192
  s_mul_i32 s30, s24, 96
  s_mov_b32 s31, 683
  s_mov_b32 s32, 96
  s_cmp_eq_u32 s24, 21
  s_cselect_b32 s38, 31, 127
  v_add_u32 v3, s29, v1
  v_add_u32 v3, 0, v3
  v_mul_lo_u32 v4, v3, s31
  v_lshrrev_b32 v4, 16, v4
  v_mul_lo_u32 v5, v4, s32
  v_sub_u32 v5, v3, v5
  v_and_b32 v5, s38, v5
  v_add_u32 v5, s30, v5
  v_lshlrev_b32 v5, 4, v5
  v_lshlrev_b32 v4, 15, v4
  v_add_u32 v5, v5, v4
  v_subrev_u32 v8, 0, v5
  v_add_u32 v3, s29, v1
  v_add_u32 v3, 64, v3
  v_mul_lo_u32 v4, v3, s31
  v_lshrrev_b32 v4, 16, v4
  v_mul_lo_u32 v5, v4, s32
  v_sub_u32 v5, v3, v5
  v_and_b32 v5, s38, v5
  v_add_u32 v5, s30, v5
  v_lshlrev_b32 v5, 4, v5
  v_lshlrev_b32 v4, 15, v4
  v_add_u32 v5, v5, v4
  v_subrev_u32 v9, 1024, v5
  v_add_u32 v3, s29, v1
  v_add_u32 v3, 128, v3
  v_mul_lo_u32 v4, v3, s31
  v_lshrrev_b32 v4, 16, v4
  v_mul_lo_u32 v5, v4, s32
  v_sub_u32 v5, v3, v5
  v_and_b32 v5, s38, v5
  v_add_u32 v5, s30, v5
  v_lshlrev_b32 v5, 4, v5
  v_lshlrev_b32 v4, 15, v4
  v_add_u32 v5, v5, v4
  v_subrev_u32 v10, 2048, v5
  v_lshrrev_b32 v3, 3, v1
  s_lshl_b32 s31, s28, 4
  v_add_u32 v3, s31, v3
  s_mov_b32 s32, 1280
  v_mul_lo_u32 v3, v3, s32
  v_and_b32 v4, 7, v1
  v_lshrrev_b32 v5, 4, v1
  v_and_b32 v5, 1, v5
  v_lshlrev_b32 v5, 2, v5
  v_xor_b32 v4, v4, v5
  v_lshlrev_b32 v4, 4, v4
  v_add_u32 v3, v3, v4
  s_lshl_b32 s31, s25, 7
  v_add_u32 v11, s31, v3
  v_add_u32 v12, 9216, v11
  s_mul_i32 s33, s28, 3072
  s_lshl_b32 s36, s28, 11
  s_add_u32 s36, s36, 12288
  s_add_u32 s34, s5, 7864320
  s_mov_b32 s35, 0
  s_add_u32 m0, s36, 0
  s_nop 0
  buffer_load_dwordx4 v11, s[16:19], s35 offen offset:0 lds
  buffer_load_dwordx4 v12, s[16:19], s35 offen offset:1024 lds
  s_add_u32 s35, s35, 81920
  s_add_u32 m0, s36, 20480
  s_nop 0
  buffer_load_dwordx4 v11, s[16:19], s35 offen offset:0 lds
  buffer_load_dwordx4 v12, s[16:19], s35 offen offset:1024 lds
  s_add_u32 s35, s35, 81920
  s_add_u32 m0, s36, 40960
  s_nop 0
  buffer_load_dwordx4 v11, s[16:19], s35 offen offset:0 lds
  buffer_load_dwordx4 v12, s[16:19], s35 offen offset:1024 lds
  s_add_u32 s35, s35, 81920
  s_add_u32 m0, s36, 61440
  s_nop 0
  buffer_load_dwordx4 v11, s[16:19], s35 offen offset:0 lds
  buffer_load_dwordx4 v12, s[16:19], s35 offen offset:1024 lds
  s_add_u32 s35, s35, 81920
  s_add_u32 m0, s36, 81920
  s_nop 0
  buffer_load_dwordx4 v11, s[16:19], s35 offen offset:0 lds
  buffer_load_dwordx4 v12, s[16:19], s35 offen offset:1024 lds
  s_add_u32 s35, s35, 81920
  s_cmp_eq_u32 s3, 0
  s_cbranch_scc0 main_pw61
  v_and_b32 v60, 63, v0
  v_add_u32 v60, s42, v60
  v_min_u32 v60, s43, v60
  v_mul_u32_u24 v60, 128, v60
  s_add_u32 s46, s5, 24184832
  s_mov_b32 s47, 0
  s_and_b32 s45, s2, 7
  s_lshl_b32 s45, s45, 14
  s_add_u32 s46, s46, s45
  buffer_load_dword v252, v60, s[8:11], s46 offen sc1
main_pl62:
  s_waitcnt vmcnt(0)
  v_cmp_gt_u32 vcc, 16, v252
  s_cbranch_vccz main_pw61
  s_sleep 2
  buffer_load_dword v252, v60, s[8:11], s46 offen sc1
  s_add_u32 s47, s47, 1
  s_cmp_ge_u32 s47, 131072
  s_cbranch_scc0 main_pl62
main_pw61:
  s_barrier
  s_add_u32 m0, s33, 0
  s_nop 0
  buffer_load_dwordx4 v8, s[8:11], s34 offen offset:0 lds
  buffer_load_dwordx4 v9, s[8:11], s34 offen offset:1024 lds
  buffer_load_dwordx4 v10, s[8:11], s34 offen offset:2048 lds
  s_add_u32 s34, s34, 262144
  s_add_u32 m0, s33, 20480
  s_nop 0
  buffer_load_dwordx4 v8, s[8:11], s34 offen offset:0 lds
  buffer_load_dwordx4 v9, s[8:11], s34 offen offset:1024 lds
  buffer_load_dwordx4 v10, s[8:11], s34 offen offset:2048 lds
  s_add_u32 s34, s34, 262144
  s_add_u32 m0, s33, 40960
  s_nop 0
  buffer_load_dwordx4 v8, s[8:11], s34 offen offset:0 lds
  buffer_load_dwordx4 v9, s[8:11], s34 offen offset:1024 lds
  buffer_load_dwordx4 v10, s[8:11], s34 offen offset:2048 lds
  s_add_u32 s34, s34, 262144
  s_add_u32 m0, s33, 61440
  s_nop 0
  buffer_load_dwordx4 v8, s[8:11], s34 offen offset:0 lds
  buffer_load_dwordx4 v9, s[8:11], s34 offen offset:1024 lds
  buffer_load_dwordx4 v10, s[8:11], s34 offen offset:2048 lds
  s_add_u32 s34, s34, 262144
  s_add_u32 m0, s33, 81920
  s_nop 0
  buffer_load_dwordx4 v8, s[8:11], s34 offen offset:0 lds
  buffer_load_dwordx4 v9, s[8:11], s34 offen offset:1024 lds
  buffer_load_dwordx4 v10, s[8:11], s34 offen offset:2048 lds
  s_add_u32 s34, s34, 262144
  s_waitcnt vmcnt(12)
  s_barrier
  s_add_u32 m0, s33, 102400
  s_nop 0
  buffer_load_dwordx4 v8, s[8:11], s34 offen offset:0 lds
  buffer_load_dwordx4 v9, s[8:11], s34 offen offset:1024 lds
  buffer_load_dwordx4 v10, s[8:11], s34 offen offset:2048 lds
  s_add_u32 s34, s34, 262144
  s_add_u32 m0, s36, 102400
  s_nop 0
  buffer_load_dwordx4 v11, s[16:19], s35 offen offset:0 lds
  buffer_load_dwordx4 v12, s[16:19], s35 offen offset:1024 lds
  s_add_u32 s35, s35, 81920
  s_waitcnt vmcnt(14)
  s_barrier
  s_add_u32 m0, s33, 122880
  s_nop 0
  buffer_load_dwordx4 v8, s[8:11], s34 offen offset:0 lds
  buffer_load_dwordx4 v9, s[8:11], s34 offen offset:1024 lds
  buffer_load_dwordx4 v10, s[8:11], s34 offen offset:2048 lds
  s_add_u32 s34, s34, 262144
  s_add_u32 m0, s36, 122880
  s_nop 0
  buffer_load_dwordx4 v11, s[16:19], s35 offen offset:0 lds
  buffer_load_dwordx4 v12, s[16:19], s35 offen offset:1024 lds
  s_add_u32 s35, s35, 81920
  s_waitcnt vmcnt(16)
  s_barrier
  s_add_u32 m0, s33, 0
  s_nop 0
  buffer_load_dwordx4 v8, s[8:11], s34 offen offset:0 lds
  buffer_load_dwordx4 v9, s[8:11], s34 offen offset:1024 lds
  buffer_load_dwordx4 v10, s[8:11], s34 offen offset:2048 lds
  s_add_u32 s34, s34, 262144
  s_add_u32 m0, s36, 0
  s_nop 0
  buffer_load_dwordx4 v11, s[16:19], s35 offen offset:0 lds
  buffer_load_dwordx4 v12, s[16:19], s35 offen offset:1024 lds
  s_add_u32 s35, s35, 81920
  s_waitcnt vmcnt(18)
  s_barrier
  s_add_u32 m0, s33, 20480
  s_nop 0
  buffer_load_dwordx4 v8, s[8:11], s34 offen offset:0 lds
  buffer_load_dwordx4 v9, s[8:11], s34 offen offset:1024 lds
  buffer_load_dwordx4 v10, s[8:11], s34 offen offset:2048 lds
  s_add_u32 s34, s34, 262144
  s_add_u32 m0, s36, 20480
  s_nop 0
  buffer_load_dwordx4 v11, s[16:19], s35 offen offset:0 lds
  buffer_load_dwordx4 v12, s[16:19], s35 offen offset:1024 lds
  s_add_u32 s35, s35, 81920
  s_waitcnt vmcnt(20)
  s_barrier
  s_add_u32 m0, s33, 40960
  s_nop 0
  buffer_load_dwordx4 v8, s[8:11], s34 offen offset:0 lds
  buffer_load_dwordx4 v9, s[8:11], s34 offen offset:1024 lds
  buffer_load_dwordx4 v10, s[8:11], s34 offen offset:2048 lds
  s_add_u32 s34, s34, 262144
  s_add_u32 m0, s36, 40960
  s_nop 0
  buffer_load_dwordx4 v11, s[16:19], s35 offen offset:0 lds
  buffer_load_dwordx4 v12, s[16:19], s35 offen offset:1024 lds
  s_add_u32 s35, s35, 81920
  s_waitcnt vmcnt(20)
  s_barrier
  s_waitcnt vmcnt(15)
  s_barrier
  s_waitcnt vmcnt(10)
  s_barrier
  s_waitcnt vmcnt(5)
  s_barrier
  s_waitcnt vmcnt(0)
  s_barrier
  s_branch main_wo60_fin2
main_wo60_cons:
  s_cmp_eq_u32 s28, 3
  s_cbranch_scc0 main_wo60_c3
  s_barrier
  s_barrier
  s_barrier
  s_barrier
  s_barrier
  s_barrier
  s_barrier
  s_barrier
  s_barrier
  s_barrier
  s_barrier
  s_branch main_wo60_fin
main_wo60_c3:
  v_lshrrev_b32 v3, 5, v1
  v_and_b32 v4, 31, v1
  s_mul_i32 s31, s24, 96
  s_lshl_b32 s32, s28, 5
  s_add_u32 s31, s31, s32
  v_add_u32 v5, s31, v4
  v_lshlrev_b32 v6, 4, v5
  v_lshlrev_b32 v7, 3, v3
  v_add_u32 v6, v6, v7
  s_lshl_b32 s33, s25, 18
  s_add_u32 s33, s33, s5
  s_add_u32 s33, s33, 20185088
  s_mov_b32 s39, 32768
  s_mov_b32 s48, s6
  s_mov_b32 s49, s7
  s_mov_b32 s50, 2621440
  s_mov_b32 s51, 0x20000
  s_cmp_eq_u32 s5, 0
  s_cbranch_scc1 main_xs63
  s_mov_b32 s48, s8
  s_mov_b32 s49, s9
  s_mov_b32 s50, s10
main_xs63:
  s_cmp_eq_u32 s5, 0
  s_cbranch_scc0 main_rn64
  v_mul_u32_u24 v6, 1280, v5
  v_add_u32 v6, v6, v7
  s_lshl_b32 s33, s25, 7
  s_mov_b32 s39, 16
main_rn64:
  s_cmp_ge_u32 s31, 2048
  s_cselect_b32 s37, 1, 0
  v_mul_u32_u24 v8, 1536, v3
  s_lshl_b32 s34, s28, 5
  v_add_u32 v9, s34, v4
  v_lshlrev_b32 v9, 4, v9
  v_add_u32 v8, v8, v9
  v_lshrrev_b32 v14, 2, v1
  v_and_b32 v14, 3, v14
  v_lshlrev_b32 v15, 3, v3
  v_add_u32 v15, v15, v14
  v_lshlrev_b32 v15, 7, v15
  v_lshrrev_b32 v14, 1, v14
  v_lshlrev_b32 v14, 2, v14
  v_lshrrev_b32 v9, 4, v1
  v_and_b32 v9, 1, v9
  v_lshlrev_b32 v9, 1, v9
  v_add_u32 v14, v14, v9
  v_lshrrev_b32 v9, 1, v1
  v_and_b32 v9, 1, v9
  v_add_u32 v14, v14, v9
  v_lshlrev_b32 v14, 4, v14
  v_and_b32 v9, 1, v1
  v_lshlrev_b32 v9, 3, v9
  v_add_u32 v14, v14, v9
  v_add_u32 v9, v15, v14
  v_add_u32 v9, 12288, v9
  v_xor_b32 v10, 64, v9
  v_add_u32 v11, 61440, v8
  v_add_u32 v12, 61440, v9
  v_add_u32 v13, 61440, v10
  v_add_u32 v32, 122880, v8
  v_add_u32 v33, 122880, v9
  v_add_u32 v34, 122880, v10
  s_cmp_eq_u32 s3, 0
  s_cbranch_scc0 main_pw65
  v_and_b32 v60, 63, v0
  v_add_u32 v60, s42, v60
  v_min_u32 v60, s43, v60
  v_mul_u32_u24 v60, 128, v60
  s_add_u32 s46, s5, 24184832
  s_mov_b32 s47, 0
  s_and_b32 s45, s2, 7
  s_lshl_b32 s45, s45, 14
  s_add_u32 s46, s46, s45
  buffer_load_dword v252, v60, s[8:11], s46 offen sc1
main_pl66:
  s_waitcnt vmcnt(0)
  v_cmp_gt_u32 vcc, 16, v252
  s_cbranch_vccz main_pw65
  s_sleep 2
  buffer_load_dword v252, v60, s[8:11], s46 offen sc1
  s_add_u32 s47, s47, 1
  s_cmp_ge_u32 s47, 131072
  s_cbranch_scc0 main_pl66
main_pw65:
  s_barrier
  s_cmp_eq_u32 s37, 1
  s_cbranch_scc1 main_wo60_nr
  buffer_load_dwordx2 v[16:17], v6, s[48:51], s33 offen
  s_add_u32 s33, s33, s39
  buffer_load_dwordx2 v[18:19], v6, s[48:51], s33 offen
  s_add_u32 s33, s33, s39
  buffer_load_dwordx2 v[20:21], v6, s[48:51], s33 offen
  s_add_u32 s33, s33, s39
  buffer_load_dwordx2 v[22:23], v6, s[48:51], s33 offen
  s_add_u32 s33, s33, s39
  buffer_load_dwordx2 v[24:25], v6, s[48:51], s33 offen
  s_add_u32 s33, s33, s39
  buffer_load_dwordx2 v[26:27], v6, s[48:51], s33 offen
  s_add_u32 s33, s33, s39
  buffer_load_dwordx2 v[28:29], v6, s[48:51], s33 offen
  s_add_u32 s33, s33, s39
  buffer_load_dwordx2 v[30:31], v6, s[48:51], s33 offen
  s_add_u32 s33, s33, s39
main_wo60_nr:
  s_barrier
  ds_read_b64_tr_b16 v[64:65], v9 offset:0
  ds_read_b64_tr_b16 v[66:67], v9 offset:512
  ds_read_b128 v[72:75], v8 offset:0
  ds_read_b64_tr_b16 v[68:69], v10 offset:0
  ds_read_b64_tr_b16 v[70:71], v10 offset:512
  ds_read_b64_tr_b16 v[76:77], v9 offset:2048
  ds_read_b64_tr_b16 v[78:79], v9 offset:2560
  ds_read_b128 v[84:87], v8 offset:3072
  ds_read_b64_tr_b16 v[80:81], v10 offset:2048
  ds_read_b64_tr_b16 v[82:83], v10 offset:2560
  s_waitcnt lgkmcnt(7)
  v_mfma_f32_32x32x16_bf16 v[128:143], v[64:67], v[72:75], 0
  ds_read_b64_tr_b16 v[88:89], v9 offset:4096
  ds_read_b64_tr_b16 v[90:91], v9 offset:4608
  ds_read_b128 v[96:99], v8 offset:6144
  s_waitcnt lgkmcnt(8)
  v_mfma_f32_32x32x16_bf16 v[144:159], v[68:71], v[72:75], 0
  ds_read_b64_tr_b16 v[92:93], v10 offset:4096
  ds_read_b64_tr_b16 v[94:95], v10 offset:4608
  ds_read_b64_tr_b16 v[100:101], v9 offset:6144
  s_waitcnt lgkmcnt(8)
  v_mfma_f32_32x32x16_bf16 v[128:143], v[76:79], v[84:87], v[128:143]
  ds_read_b64_tr_b16 v[102:103], v9 offset:6656
  ds_read_b128 v[108:111], v8 offset:9216
  ds_read_b64_tr_b16 v[104:105], v10 offset:6144
  s_waitcnt lgkmcnt(9)
  v_mfma_f32_32x32x16_bf16 v[144:159], v[80:83], v[84:87], v[144:159]
  ds_read_b64_tr_b16 v[106:107], v10 offset:6656
  s_barrier
  s_waitcnt lgkmcnt(7)
  v_mfma_f32_32x32x16_bf16 v[128:143], v[88:91], v[96:99], v[128:143]
  ds_read_b64_tr_b16 v[64:65], v9 offset:20480
  ds_read_b64_tr_b16 v[66:67], v9 offset:20992
  ds_read_b128 v[72:75], v8 offset:20480
  s_waitcnt lgkmcnt(8)
  v_mfma_f32_32x32x16_bf16 v[144:159], v[92:95], v[96:99], v[144:159]
  ds_read_b64_tr_b16 v[68:69], v10 offset:20480
  ds_read_b64_tr_b16 v[70:71], v10 offset:20992
  ds_read_b64_tr_b16 v[76:77], v9 offset:22528
  s_waitcnt lgkmcnt(8)
  v_mfma_f32_32x32x16_bf16 v[128:143], v[100:103], v[108:111], v[128:143]
  ds_read_b64_tr_b16 v[78:79], v9 offset:23040
  ds_read_b128 v[84:87], v8 offset:23552
  ds_read_b64_tr_b16 v[80:81], v10 offset:22528
  s_waitcnt lgkmcnt(9)
  v_mfma_f32_32x32x16_bf16 v[144:159], v[104:107], v[108:111], v[144:159]
  ds_read_b64_tr_b16 v[82:83], v10 offset:23040
  s_waitcnt lgkmcnt(7)
  v_mfma_f32_32x32x16_bf16 v[128:143], v[64:67], v[72:75], v[128:143]
  ds_read_b64_tr_b16 v[88:89], v9 offset:24576
  ds_read_b64_tr_b16 v[90:91], v9 offset:25088
  ds_read_b128 v[96:99], v8 offset:26624
  s_waitcnt lgkmcnt(8)
  v_mfma_f32_32x32x16_bf16 v[144:159], v[68:71], v[72:75], v[144:159]
  ds_read_b64_tr_b16 v[92:93], v10 offset:24576
  ds_read_b64_tr_b16 v[94:95], v10 offset:25088
  ds_read_b64_tr_b16 v[100:101], v9 offset:26624
  s_waitcnt lgkmcnt(8)
  v_mfma_f32_32x32x16_bf16 v[128:143], v[76:79], v[84:87], v[128:143]
  ds_read_b64_tr_b16 v[102:103], v9 offset:27136
  ds_read_b128 v[108:111], v8 offset:29696
  ds_read_b64_tr_b16 v[104:105], v10 offset:26624
  s_waitcnt lgkmcnt(9)
  v_mfma_f32_32x32x16_bf16 v[144:159], v[80:83], v[84:87], v[144:159]
  ds_read_b64_tr_b16 v[106:107], v10 offset:27136
  s_barrier
  s_waitcnt lgkmcnt(7)
  v_mfma_f32_32x32x16_bf16 v[128:143], v[88:91], v[96:99], v[128:143]
  ds_read_b64_tr_b16 v[64:65], v9 offset:40960
  ds_read_b64_tr_b16 v[66:67], v9 offset:41472
  ds_read_b128 v[72:75], v8 offset:40960
  s_waitcnt lgkmcnt(8)
  v_mfma_f32_32x32x16_bf16 v[144:159], v[92:95], v[96:99], v[144:159]
  ds_read_b64_tr_b16 v[68:69], v10 offset:40960
  ds_read_b64_tr_b16 v[70:71], v10 offset:41472
  ds_read_b64_tr_b16 v[76:77], v9 offset:43008
  s_waitcnt lgkmcnt(8)
  v_mfma_f32_32x32x16_bf16 v[128:143], v[100:103], v[108:111], v[128:143]
  ds_read_b64_tr_b16 v[78:79], v9 offset:43520
  ds_read_b128 v[84:87], v8 offset:44032
  ds_read_b64_tr_b16 v[80:81], v10 offset:43008
  s_waitcnt lgkmcnt(9)
  v_mfma_f32_32x32x16_bf16 v[144:159], v[104:107], v[108:111], v[144:159]
  ds_read_b64_tr_b16 v[82:83], v10 offset:43520
  s_waitcnt lgkmcnt(7)
  v_mfma_f32_32x32x16_bf16 v[128:143], v[64:67], v[72:75], v[128:143]
  ds_read_b64_tr_b16 v[88:89], v9 offset:45056
  ds_read_b64_tr_b16 v[90:91], v9 offset:45568
  ds_read_b128 v[96:99], v8 offset:47104
  s_waitcnt lgkmcnt(8)
  v_mfma_f32_32x32x16_bf16 v[144:159], v[68:71], v[72:75], v[144:159]
  ds_read_b64_tr_b16 v[92:93], v10 offset:45056
  ds_read_b64_tr_b16 v[94:95], v10 offset:45568
  ds_read_b64_tr_b16 v[100:101], v9 offset:47104
  s_waitcnt lgkmcnt(8)
  v_mfma_f32_32x32x16_bf16 v[128:143], v[76:79], v[84:87], v[128:143]
  ds_read_b64_tr_b16 v[102:103], v9 offset:47616
  ds_read_b128 v[108:111], v8 offset:50176
  ds_read_b64_tr_b16 v[104:105], v10 offset:47104
  s_waitcnt lgkmcnt(9)
  v_mfma_f32_32x32x16_bf16 v[144:159], v[80:83], v[84:87], v[144:159]
  ds_read_b64_tr_b16 v[106:107], v10 offset:47616
  s_barrier
  s_waitcnt lgkmcnt(7)
  v_mfma_f32_32x32x16_bf16 v[128:143], v[88:91], v[96:99], v[128:143]
  ds_read_b64_tr_b16 v[64:65], v12 offset:0
  ds_read_b64_tr_b16 v[66:67], v12 offset:512
  ds_read_b128 v[72:75], v11 offset:0
  s_waitcnt lgkmcnt(8)
  v_mfma_f32_32x32x16_bf16 v[144:159], v[92:95], v[96:99], v[144:159]
  ds_read_b64_tr_b16 v[68:69], v13 offset:0
  ds_read_b64_tr_b16 v[70:71], v13 offset:512
  ds_read_b64_tr_b16 v[76:77], v12 offset:2048
  s_waitcnt lgkmcnt(8)
  v_mfma_f32_32x32x16_bf16 v[128:143], v[100:103], v[108:111], v[128:143]
  ds_read_b64_tr_b16 v[78:79], v12 offset:2560
  ds_read_b128 v[84:87], v11 offset:3072
  ds_read_b64_tr_b16 v[80:81], v13 offset:2048
  s_waitcnt lgkmcnt(9)
  v_mfma_f32_32x32x16_bf16 v[144:159], v[104:107], v[108:111], v[144:159]
  ds_read_b64_tr_b16 v[82:83], v13 offset:2560
  s_waitcnt lgkmcnt(7)
  v_mfma_f32_32x32x16_bf16 v[128:143], v[64:67], v[72:75], v[128:143]
  ds_read_b64_tr_b16 v[88:89], v12 offset:4096
  ds_read_b64_tr_b16 v[90:91], v12 offset:4608
  ds_read_b128 v[96:99], v11 offset:6144
  s_waitcnt lgkmcnt(8)
  v_mfma_f32_32x32x16_bf16 v[144:159], v[68:71], v[72:75], v[144:159]
  ds_read_b64_tr_b16 v[92:93], v13 offset:4096
  ds_read_b64_tr_b16 v[94:95], v13 offset:4608
  ds_read_b64_tr_b16 v[100:101], v12 offset:6144
  s_waitcnt lgkmcnt(8)
  v_mfma_f32_32x32x16_bf16 v[128:143], v[76:79], v[84:87], v[128:143]
  ds_read_b64_tr_b16 v[102:103], v12 offset:6656
  ds_read_b128 v[108:111], v11 offset:9216
  ds_read_b64_tr_b16 v[104:105], v13 offset:6144
  s_waitcnt lgkmcnt(9)
  v_mfma_f32_32x32x16_bf16 v[144:159], v[80:83], v[84:87], v[144:159]
  ds_read_b64_tr_b16 v[106:107], v13 offset:6656
  s_barrier
  s_waitcnt lgkmcnt(7)
  v_mfma_f32_32x32x16_bf16 v[128:143], v[88:91], v[96:99], v[128:143]
  ds_read_b64_tr_b16 v[64:65], v12 offset:20480
  ds_read_b64_tr_b16 v[66:67], v12 offset:20992
  ds_read_b128 v[72:75], v11 offset:20480
  s_waitcnt lgkmcnt(8)
  v_mfma_f32_32x32x16_bf16 v[144:159], v[92:95], v[96:99], v[144:159]
  ds_read_b64_tr_b16 v[68:69], v13 offset:20480
  ds_read_b64_tr_b16 v[70:71], v13 offset:20992
  ds_read_b64_tr_b16 v[76:77], v12 offset:22528
  s_waitcnt lgkmcnt(8)
  v_mfma_f32_32x32x16_bf16 v[128:143], v[100:103], v[108:111], v[128:143]
  ds_read_b64_tr_b16 v[78:79], v12 offset:23040
  ds_read_b128 v[84:87], v11 offset:23552
  ds_read_b64_tr_b16 v[80:81], v13 offset:22528
  s_waitcnt lgkmcnt(9)
  v_mfma_f32_32x32x16_bf16 v[144:159], v[104:107], v[108:111], v[144:159]
  ds_read_b64_tr_b16 v[82:83], v13 offset:23040
  s_waitcnt lgkmcnt(7)
  v_mfma_f32_32x32x16_bf16 v[128:143], v[64:67], v[72:75], v[128:143]
  ds_read_b64_tr_b16 v[88:89], v12 offset:24576
  ds_read_b64_tr_b16 v[90:91], v12 offset:25088
  ds_read_b128 v[96:99], v11 offset:26624
  s_waitcnt lgkmcnt(8)
  v_mfma_f32_32x32x16_bf16 v[144:159], v[68:71], v[72:75], v[144:159]
  ds_read_b64_tr_b16 v[92:93], v13 offset:24576
  ds_read_b64_tr_b16 v[94:95], v13 offset:25088
  ds_read_b64_tr_b16 v[100:101], v12 offset:26624
  s_waitcnt lgkmcnt(8)
  v_mfma_f32_32x32x16_bf16 v[128:143], v[76:79], v[84:87], v[128:143]
  ds_read_b64_tr_b16 v[102:103], v12 offset:27136
  ds_read_b128 v[108:111], v11 offset:29696
  ds_read_b64_tr_b16 v[104:105], v13 offset:26624
  s_waitcnt lgkmcnt(9)
  v_mfma_f32_32x32x16_bf16 v[144:159], v[80:83], v[84:87], v[144:159]
  ds_read_b64_tr_b16 v[106:107], v13 offset:27136
  s_barrier
  s_waitcnt lgkmcnt(7)
  v_mfma_f32_32x32x16_bf16 v[128:143], v[88:91], v[96:99], v[128:143]
  ds_read_b64_tr_b16 v[64:65], v12 offset:40960
  ds_read_b64_tr_b16 v[66:67], v12 offset:41472
  ds_read_b128 v[72:75], v11 offset:40960
  s_waitcnt lgkmcnt(8)
  v_mfma_f32_32x32x16_bf16 v[144:159], v[92:95], v[96:99], v[144:159]
  ds_read_b64_tr_b16 v[68:69], v13 offset:40960
  ds_read_b64_tr_b16 v[70:71], v13 offset:41472
  ds_read_b64_tr_b16 v[76:77], v12 offset:43008
  s_waitcnt lgkmcnt(8)
  v_mfma_f32_32x32x16_bf16 v[128:143], v[100:103], v[108:111], v[128:143]
  ds_read_b64_tr_b16 v[78:79], v12 offset:43520
  ds_read_b128 v[84:87], v11 offset:44032
  ds_read_b64_tr_b16 v[80:81], v13 offset:43008
  s_waitcnt lgkmcnt(9)
  v_mfma_f32_32x32x16_bf16 v[144:159], v[104:107], v[108:111], v[144:159]
  ds_read_b64_tr_b16 v[82:83], v13 offset:43520
  s_waitcnt lgkmcnt(7)
  v_mfma_f32_32x32x16_bf16 v[128:143], v[64:67], v[72:75], v[128:143]
  ds_read_b64_tr_b16 v[88:89], v12 offset:45056
  ds_read_b64_tr_b16 v[90:91], v12 offset:45568
  ds_read_b128 v[96:99], v11 offset:47104
  s_waitcnt lgkmcnt(8)
  v_mfma_f32_32x32x16_bf16 v[144:159], v[68:71], v[72:75], v[144:159]
  ds_read_b64_tr_b16 v[92:93], v13 offset:45056
  ds_read_b64_tr_b16 v[94:95], v13 offset:45568
  ds_read_b64_tr_b16 v[100:101], v12 offset:47104
  s_waitcnt lgkmcnt(8)
  v_mfma_f32_32x32x16_bf16 v[128:143], v[76:79], v[84:87], v[128:143]
  ds_read_b64_tr_b16 v[102:103], v12 offset:47616
  ds_read_b128 v[108:111], v11 offset:50176
  ds_read_b64_tr_b16 v[104:105], v13 offset:47104
  s_waitcnt lgkmcnt(9)
  v_mfma_f32_32x32x16_bf16 v[144:159], v[80:83], v[84:87], v[144:159]
  ds_read_b64_tr_b16 v[106:107], v13 offset:47616
  s_barrier
  s_waitcnt lgkmcnt(7)
  v_mfma_f32_32x32x16_bf16 v[128:143], v[88:91], v[96:99], v[128:143]
  ds_read_b64_tr_b16 v[64:65], v33 offset:0
  ds_read_b64_tr_b16 v[66:67], v33 offset:512
  ds_read_b128 v[72:75], v32 offset:0
  s_waitcnt lgkmcnt(8)
  v_mfma_f32_32x32x16_bf16 v[144:159], v[92:95], v[96:99], v[144:159]
  ds_read_b64_tr_b16 v[68:69], v34 offset:0
  ds_read_b64_tr_b16 v[70:71], v34 offset:512
  ds_read_b64_tr_b16 v[76:77], v33 offset:2048
  s_waitcnt lgkmcnt(8)
  v_mfma_f32_32x32x16_bf16 v[128:143], v[100:103], v[108:111], v[128:143]
  ds_read_b64_tr_b16 v[78:79], v33 offset:2560
  ds_read_b128 v[84:87], v32 offset:3072
  ds_read_b64_tr_b16 v[80:81], v34 offset:2048
  s_waitcnt lgkmcnt(9)
  v_mfma_f32_32x32x16_bf16 v[144:159], v[104:107], v[108:111], v[144:159]
  ds_read_b64_tr_b16 v[82:83], v34 offset:2560
  s_waitcnt lgkmcnt(7)
  v_mfma_f32_32x32x16_bf16 v[128:143], v[64:67], v[72:75], v[128:143]
  ds_read_b64_tr_b16 v[88:89], v33 offset:4096
  ds_read_b64_tr_b16 v[90:91], v33 offset:4608
  ds_read_b128 v[96:99], v32 offset:6144
  s_waitcnt lgkmcnt(8)
  v_mfma_f32_32x32x16_bf16 v[144:159], v[68:71], v[72:75], v[144:159]
  ds_read_b64_tr_b16 v[92:93], v34 offset:4096
  ds_read_b64_tr_b16 v[94:95], v34 offset:4608
  ds_read_b64_tr_b16 v[100:101], v33 offset:6144
  s_waitcnt lgkmcnt(8)
  v_mfma_f32_32x32x16_bf16 v[128:143], v[76:79], v[84:87], v[128:143]
  ds_read_b64_tr_b16 v[102:103], v33 offset:6656
  ds_read_b128 v[108:111], v32 offset:9216
  ds_read_b64_tr_b16 v[104:105], v34 offset:6144
  s_waitcnt lgkmcnt(9)
  v_mfma_f32_32x32x16_bf16 v[144:159], v[80:83], v[84:87], v[144:159]
  ds_read_b64_tr_b16 v[106:107], v34 offset:6656
  s_barrier
  s_waitcnt lgkmcnt(7)
  v_mfma_f32_32x32x16_bf16 v[128:143], v[88:91], v[96:99], v[128:143]
  ds_read_b64_tr_b16 v[64:65], v9 offset:0
  ds_read_b64_tr_b16 v[66:67], v9 offset:512
  ds_read_b128 v[72:75], v8 offset:0
  s_waitcnt lgkmcnt(8)
  v_mfma_f32_32x32x16_bf16 v[144:159], v[92:95], v[96:99], v[144:159]
  ds_read_b64_tr_b16 v[68:69], v10 offset:0
  ds_read_b64_tr_b16 v[70:71], v10 offset:512
  ds_read_b64_tr_b16 v[76:77], v9 offset:2048
  s_waitcnt lgkmcnt(8)
  v_mfma_f32_32x32x16_bf16 v[128:143], v[100:103], v[108:111], v[128:143]
  ds_read_b64_tr_b16 v[78:79], v9 offset:2560
  ds_read_b128 v[84:87], v8 offset:3072
  ds_read_b64_tr_b16 v[80:81], v10 offset:2048
  s_waitcnt lgkmcnt(9)
  v_mfma_f32_32x32x16_bf16 v[144:159], v[104:107], v[108:111], v[144:159]
  ds_read_b64_tr_b16 v[82:83], v10 offset:2560
  s_waitcnt lgkmcnt(7)
  v_mfma_f32_32x32x16_bf16 v[128:143], v[64:67], v[72:75], v[128:143]
  ds_read_b64_tr_b16 v[88:89], v9 offset:4096
  ds_read_b64_tr_b16 v[90:91], v9 offset:4608
  ds_read_b128 v[96:99], v8 offset:6144
  s_waitcnt lgkmcnt(8)
  v_mfma_f32_32x32x16_bf16 v[144:159], v[68:71], v[72:75], v[144:159]
  ds_read_b64_tr_b16 v[92:93], v10 offset:4096
  ds_read_b64_tr_b16 v[94:95], v10 offset:4608
  ds_read_b64_tr_b16 v[100:101], v9 offset:6144
  s_waitcnt lgkmcnt(8)
  v_mfma_f32_32x32x16_bf16 v[128:143], v[76:79], v[84:87], v[128:143]
  ds_read_b64_tr_b16 v[102:103], v9 offset:6656
  ds_read_b128 v[108:111], v8 offset:9216
  ds_read_b64_tr_b16 v[104:105], v10 offset:6144
  s_waitcnt lgkmcnt(9)
  v_mfma_f32_32x32x16_bf16 v[144:159], v[80:83], v[84:87], v[144:159]
  ds_read_b64_tr_b16 v[106:107], v10 offset:6656
  s_barrier
  s_waitcnt lgkmcnt(7)
  v_mfma_f32_32x32x16_bf16 v[128:143], v[88:91], v[96:99], v[128:143]
  ds_read_b64_tr_b16 v[64:65], v9 offset:20480
  ds_read_b64_tr_b16 v[66:67], v9 offset:20992
  ds_read_b128 v[72:75], v8 offset:20480
  s_waitcnt lgkmcnt(8)
  v_mfma_f32_32x32x16_bf16 v[144:159], v[92:95], v[96:99], v[144:159]
  ds_read_b64_tr_b16 v[68:69], v10 offset:20480
  ds_read_b64_tr_b16 v[70:71], v10 offset:20992
  ds_read_b64_tr_b16 v[76:77], v9 offset:22528
  s_waitcnt lgkmcnt(8)
  v_mfma_f32_32x32x16_bf16 v[128:143], v[100:103], v[108:111], v[128:143]
  ds_read_b64_tr_b16 v[78:79], v9 offset:23040
  ds_read_b128 v[84:87], v8 offset:23552
  ds_read_b64_tr_b16 v[80:81], v10 offset:22528
  s_waitcnt lgkmcnt(9)
  v_mfma_f32_32x32x16_bf16 v[144:159], v[104:107], v[108:111], v[144:159]
  ds_read_b64_tr_b16 v[82:83], v10 offset:23040
  s_waitcnt lgkmcnt(7)
  v_mfma_f32_32x32x16_bf16 v[128:143], v[64:67], v[72:75], v[128:143]
  ds_read_b64_tr_b16 v[88:89], v9 offset:24576
  ds_read_b64_tr_b16 v[90:91], v9 offset:25088
  ds_read_b128 v[96:99], v8 offset:26624
  s_waitcnt lgkmcnt(8)
  v_mfma_f32_32x32x16_bf16 v[144:159], v[68:71], v[72:75], v[144:159]
  ds_read_b64_tr_b16 v[92:93], v10 offset:24576
  ds_read_b64_tr_b16 v[94:95], v10 offset:25088
  ds_read_b64_tr_b16 v[100:101], v9 offset:26624
  s_waitcnt lgkmcnt(8)
  v_mfma_f32_32x32x16_bf16 v[128:143], v[76:79], v[84:87], v[128:143]
  ds_read_b64_tr_b16 v[102:103], v9 offset:27136
  ds_read_b128 v[108:111], v8 offset:29696
  ds_read_b64_tr_b16 v[104:105], v10 offset:26624
  s_waitcnt lgkmcnt(9)
  v_mfma_f32_32x32x16_bf16 v[144:159], v[80:83], v[84:87], v[144:159]
  ds_read_b64_tr_b16 v[106:107], v10 offset:27136
  s_barrier
  s_waitcnt lgkmcnt(7)
  v_mfma_f32_32x32x16_bf16 v[128:143], v[88:91], v[96:99], v[128:143]
  ds_read_b64_tr_b16 v[64:65], v9 offset:40960
  ds_read_b64_tr_b16 v[66:67], v9 offset:41472
  ds_read_b128 v[72:75], v8 offset:40960
  s_waitcnt lgkmcnt(8)
  v_mfma_f32_32x32x16_bf16 v[144:159], v[92:95], v[96:99], v[144:159]
  ds_read_b64_tr_b16 v[68:69], v10 offset:40960
  ds_read_b64_tr_b16 v[70:71], v10 offset:41472
  ds_read_b64_tr_b16 v[76:77], v9 offset:43008
  s_waitcnt lgkmcnt(8)
  v_mfma_f32_32x32x16_bf16 v[128:143], v[100:103], v[108:111], v[128:143]
  ds_read_b64_tr_b16 v[78:79], v9 offset:43520
  ds_read_b128 v[84:87], v8 offset:44032
  ds_read_b64_tr_b16 v[80:81], v10 offset:43008
  s_waitcnt lgkmcnt(9)
  v_mfma_f32_32x32x16_bf16 v[144:159], v[104:107], v[108:111], v[144:159]
  ds_read_b64_tr_b16 v[82:83], v10 offset:43520
  s_waitcnt lgkmcnt(7)
  v_mfma_f32_32x32x16_bf16 v[128:143], v[64:67], v[72:75], v[128:143]
  ds_read_b64_tr_b16 v[88:89], v9 offset:45056
  ds_read_b64_tr_b16 v[90:91], v9 offset:45568
  ds_read_b128 v[96:99], v8 offset:47104
  s_waitcnt lgkmcnt(8)
  v_mfma_f32_32x32x16_bf16 v[144:159], v[68:71], v[72:75], v[144:159]
  ds_read_b64_tr_b16 v[92:93], v10 offset:45056
  ds_read_b64_tr_b16 v[94:95], v10 offset:45568
  ds_read_b64_tr_b16 v[100:101], v9 offset:47104
  s_waitcnt lgkmcnt(8)
  v_mfma_f32_32x32x16_bf16 v[128:143], v[76:79], v[84:87], v[128:143]
  ds_read_b64_tr_b16 v[102:103], v9 offset:47616
  ds_read_b128 v[108:111], v8 offset:50176
  ds_read_b64_tr_b16 v[104:105], v10 offset:47104
  s_waitcnt lgkmcnt(9)
  v_mfma_f32_32x32x16_bf16 v[144:159], v[80:83], v[84:87], v[144:159]
  ds_read_b64_tr_b16 v[106:107], v10 offset:47616
  s_waitcnt lgkmcnt(7)
  v_mfma_f32_32x32x16_bf16 v[128:143], v[88:91], v[96:99], v[128:143]
  s_waitcnt lgkmcnt(5)
  v_mfma_f32_32x32x16_bf16 v[144:159], v[92:95], v[96:99], v[144:159]
  s_waitcnt lgkmcnt(2)
  v_mfma_f32_32x32x16_bf16 v[128:143], v[100:103], v[108:111], v[128:143]
  s_waitcnt lgkmcnt(0)
  v_mfma_f32_32x32x16_bf16 v[144:159], v[104:107], v[108:111], v[144:159]
  s_cmp_eq_u32 s37, 1
  s_cbranch_scc1 main_wo60_fin
  s_waitcnt vmcnt(0)
  s_nop 7
  s_nop 3
  v_lshlrev_b32 v64, 16, v16
  v_and_b32 v65, 0xffff0000, v16
  v_lshlrev_b32 v66, 16, v17
  v_and_b32 v67, 0xffff0000, v17
  v_pk_add_f32 v[128:129], v[128:129], v[64:65]
  v_pk_add_f32 v[130:131], v[130:131], v[66:67]
  v_lshlrev_b32 v68, 16, v18
  v_and_b32 v69, 0xffff0000, v18
  v_lshlrev_b32 v70, 16, v19
  v_and_b32 v71, 0xffff0000, v19
  v_pk_add_f32 v[132:133], v[132:133], v[68:69]
  v_pk_add_f32 v[134:135], v[134:135], v[70:71]
  v_lshlrev_b32 v64, 16, v20
  v_and_b32 v65, 0xffff0000, v20
  v_lshlrev_b32 v66, 16, v21
  v_and_b32 v67, 0xffff0000, v21
  v_pk_add_f32 v[136:137], v[136:137], v[64:65]
  v_pk_add_f32 v[138:139], v[138:139], v[66:67]
  v_lshlrev_b32 v68, 16, v22
  v_and_b32 v69, 0xffff0000, v22
  v_lshlrev_b32 v70, 16, v23
  v_and_b32 v71, 0xffff0000, v23
  v_pk_add_f32 v[140:141], v[140:141], v[68:69]
  v_pk_add_f32 v[142:143], v[142:143], v[70:71]
  v_lshlrev_b32 v64, 16, v24
  v_and_b32 v65, 0xffff0000, v24
  v_lshlrev_b32 v66, 16, v25
  v_and_b32 v67, 0xffff0000, v25
  v_pk_add_f32 v[144:145], v[144:145], v[64:65]
  v_pk_add_f32 v[146:147], v[146:147], v[66:67]
  v_lshlrev_b32 v68, 16, v26
  v_and_b32 v69, 0xffff0000, v26
  v_lshlrev_b32 v70, 16, v27
  v_and_b32 v71, 0xffff0000, v27
  v_pk_add_f32 v[148:149], v[148:149], v[68:69]
  v_pk_add_f32 v[150:151], v[150:151], v[70:71]
  v_lshlrev_b32 v64, 16, v28
  v_and_b32 v65, 0xffff0000, v28
  v_lshlrev_b32 v66, 16, v29
  v_and_b32 v67, 0xffff0000, v29
  v_pk_add_f32 v[152:153], v[152:153], v[64:65]
  v_pk_add_f32 v[154:155], v[154:155], v[66:67]
  v_lshlrev_b32 v68, 16, v30
  v_and_b32 v69, 0xffff0000, v30
  v_lshlrev_b32 v70, 16, v31
  v_and_b32 v71, 0xffff0000, v31
  v_pk_add_f32 v[156:157], v[156:157], v[68:69]
  v_pk_add_f32 v[158:159], v[158:159], v[70:71]
  v_cvt_pk_bf16_f32 v80, v128, v129
  v_cvt_pk_bf16_f32 v81, v130, v131
  v_cvt_pk_bf16_f32 v82, v132, v133
  v_cvt_pk_bf16_f32 v83, v134, v135
  s_nop 1
  v_permlane32_swap_b32 v80, v82
  v_permlane32_swap_b32 v81, v83
  v_cvt_pk_bf16_f32 v84, v136, v137
  v_cvt_pk_bf16_f32 v85, v138, v139
  v_cvt_pk_bf16_f32 v86, v140, v141
  v_cvt_pk_bf16_f32 v87, v142, v143
  s_nop 1
  v_permlane32_swap_b32 v84, v86
  v_permlane32_swap_b32 v85, v87
  v_cvt_pk_bf16_f32 v88, v144, v145
  v_cvt_pk_bf16_f32 v89, v146, v147
  v_cvt_pk_bf16_f32 v90, v148, v149
  v_cvt_pk_bf16_f32 v91, v150, v151
  s_nop 1
  v_permlane32_swap_b32 v88, v90
  v_permlane32_swap_b32 v89, v91
  v_cvt_pk_bf16_f32 v92, v152, v153
  v_cvt_pk_bf16_f32 v93, v154, v155
  v_cvt_pk_bf16_f32 v94, v156, v157
  v_cvt_pk_bf16_f32 v95, v158, v159
  s_nop 1
  v_permlane32_swap_b32 v92, v94
  v_permlane32_swap_b32 v93, v95
  v_lshlrev_b32 v14, 15, v3
  v_lshlrev_b32 v15, 4, v5
  v_add_u32 v14, v14, v15
  s_lshl_b32 s34, s25, 18
  s_add_u32 s34, s34, s5
  s_add_u32 s34, s34, 17563648
  buffer_store_dwordx4 v[80:83], v14, s[8:11], s34 offen sc1
  s_add_u32 s34, s34, 65536
  buffer_store_dwordx4 v[84:87], v14, s[8:11], s34 offen sc1
  s_add_u32 s34, s34, 65536
  buffer_store_dwordx4 v[88:91], v14, s[8:11], s34 offen sc1
  s_add_u32 s34, s34, 65536
  buffer_store_dwordx4 v[92:95], v14, s[8:11], s34 offen sc1
  s_add_u32 s34, s34, 65536
  v_pk_add_f32 v[100:101], v[128:129], v[130:131]
  v_pk_mul_f32 v[102:103], v[128:129], v[128:129]
  v_pk_fma_f32 v[102:103], v[130:131], v[130:131], v[102:103]
  v_pk_add_f32 v[100:101], v[100:101], v[132:133]
  v_pk_fma_f32 v[102:103], v[132:133], v[132:133], v[102:103]
  v_pk_add_f32 v[100:101], v[100:101], v[134:135]
  v_pk_fma_f32 v[102:103], v[134:135], v[134:135], v[102:103]
  v_pk_add_f32 v[100:101], v[100:101], v[136:137]
  v_pk_fma_f32 v[102:103], v[136:137], v[136:137], v[102:103]
  v_pk_add_f32 v[100:101], v[100:101], v[138:139]
  v_pk_fma_f32 v[102:103], v[138:139], v[138:139], v[102:103]
  v_pk_add_f32 v[100:101], v[100:101], v[140:141]
  v_pk_fma_f32 v[102:103], v[140:141], v[140:141], v[102:103]
  v_pk_add_f32 v[100:101], v[100:101], v[142:143]
  v_pk_fma_f32 v[102:103], v[142:143], v[142:143], v[102:103]
  v_pk_add_f32 v[100:101], v[100:101], v[144:145]
  v_pk_fma_f32 v[102:103], v[144:145], v[144:145], v[102:103]
  v_pk_add_f32 v[100:101], v[100:101], v[146:147]
  v_pk_fma_f32 v[102:103], v[146:147], v[146:147], v[102:103]
  v_pk_add_f32 v[100:101], v[100:101], v[148:149]
  v_pk_fma_f32 v[102:103], v[148:149], v[148:149], v[102:103]
  v_pk_add_f32 v[100:101], v[100:101], v[150:151]
  v_pk_fma_f32 v[102:103], v[150:151], v[150:151], v[102:103]
  v_pk_add_f32 v[100:101], v[100:101], v[152:153]
  v_pk_fma_f32 v[102:103], v[152:153], v[152:153], v[102:103]
  v_pk_add_f32 v[100:101], v[100:101], v[154:155]
  v_pk_fma_f32 v[102:103], v[154:155], v[154:155], v[102:103]
  v_pk_add_f32 v[100:101], v[100:101], v[156:157]
  v_pk_fma_f32 v[102:103], v[156:157], v[156:157], v[102:103]
  v_pk_add_f32 v[100:101], v[100:101], v[158:159]
  v_pk_fma_f32 v[102:103], v[158:159], v[158:159], v[102:103]
  v_add_f32 v100, v100, v101
  v_add_f32 v101, v102, v103
  v_mov_b32 v104, v100
  s_nop 1
  v_permlane32_swap_b32 v100, v104
  s_nop 1
  v_add_f32 v100, v100, v104
  v_mov_b32 v104, v101
  s_nop 1
  v_permlane32_swap_b32 v101, v104
  s_nop 1
  v_add_f32 v101, v101, v104
  v_lshlrev_b32 v15, 3, v4
  s_lshl_b32 s35, s31, 3
  s_lshl_b32 s36, s25, 14
  s_add_u32 s35, s35, s36
  s_add_u32 s35, s35, s5
  s_add_u32 s35, s35, 22806528
  v_cmp_gt_u32 vcc, 32, v1
  s_and_saveexec_b64 s[40:41], vcc
  buffer_store_dwordx2 v[100:101], v15, s[8:11], s35 offen sc1
  s_mov_b64 exec, s[40:41]
main_wo60_fin:
  s_waitcnt vmcnt(0)
main_wo60_fin2:
  s_barrier
  s_cmp_eq_u32 s3, 0
  s_cbranch_scc0 main_ar67
  s_mul_i32 s46, s24, 128
  s_add_u32 s46, s46, s5
  s_add_u32 s46, s46, 24186880
  v_and_b32 v60, 63, v0
  v_lshlrev_b32 v60, 14, v60
  v_mov_b32 v61, 1
  s_mov_b64 s[44:45], exec
  s_mov_b64 exec, 255
  buffer_atomic_add v61, v60, s[8:11], s46 offen sc1
  s_mov_b64 exec, s[44:45]
main_ar67:
main_wo60_end:
  s_cmp_ge_u32 s2, 224
  s_cbranch_scc1 main_w168_end
  v_and_b32 v1, 63, v0
  s_and_b32 s24, s2, 7
  s_lshr_b32 s25, s2, 3
  s_mov_b32 s28, s3
  s_lshr_b32 s26, s24, 2
  s_mul_i32 s26, s26, 28
  s_add_u32 s26, s26, s25
  s_and_b32 s24, s24, 3
  s_lshl_b32 s24, s24, 2
  s_and_b32 s25, s26, 3
  s_add_u32 s24, s24, s25
  s_lshr_b32 s25, s26, 2
  s_mul_i32 s26, s24, 344
  s_lshr_b32 s26, s26, 8
  s_add_u32 s27, s26, 1
  s_cmp_ge_u32 s28, 4
  s_cbranch_scc0 main_w168_cons
  s_sub_u32 s28, s28, 4
  s_lshl_b32 s29, s24, 11
  s_lshl_b32 s30, s28, 16
  s_add_u32 s29, s29, s30
  v_lshlrev_b32 v3, 4, v1
  v_add_u32 v4, s29, v3
  v_add_u32 v6, 30720, v4
  v_lshrrev_b32 v8, 4, v1
  v_and_b32 v9, 15, v1
  v_lshlrev_b32 v10, 2, v8
  v_xor_b32 v9, v9, v10
  v_mov_b32 v12, v4
  v_mov_b32 v13, v4
  v_mov_b32 v14, v6
  v_mov_b32 v15, v6
  s_add_u32 s34, s5, 17563648
  s_mov_b32 s39, 262144
  s_cmp_eq_u32 s25, 13
  s_cselect_b32 s31, 7, 15
  v_and_b32 v9, s31, v9
  s_lshl_b32 s31, s28, 4
  v_add_u32 v8, s31, v8
  s_mov_b32 s32, 3456
  v_mul_lo_u32 v8, v8, s32
  v_lshlrev_b32 v9, 4, v9
  v_add_u32 v8, v8, v9
  s_lshl_b32 s31, s25, 8
  v_add_u32 v8, s31, v8
  v_add_u32 v9, 12800, v8
  v_add_u32 v10, 25600, v8
  v_add_u32 v11, 38400, v8
  s_lshl_b32 s33, s28, 12
  s_mov_b32 s35, 0
  s_add_u32 m0, s33, 16384
  s_nop 0
  buffer_load_dwordx4 v8, s[20:23], s35 offen offset:0 lds
  buffer_load_dwordx4 v9, s[20:23], s35 offen offset:1024 lds
  buffer_load_dwordx4 v10, s[20:23], s35 offen offset:2048 lds
  buffer_load_dwordx4 v11, s[20:23], s35 offen offset:3072 lds
  s_add_u32 s35, s35, 221184
  s_add_u32 m0, s33, 49152
  s_nop 0
  buffer_load_dwordx4 v8, s[20:23], s35 offen offset:0 lds
  buffer_load_dwordx4 v9, s[20:23], s35 offen offset:1024 lds
  buffer_load_dwordx4 v10, s[20:23], s35 offen offset:2048 lds
  buffer_load_dwordx4 v11, s[20:23], s35 offen offset:3072 lds
  s_add_u32 s35, s35, 221184
  s_add_u32 m0, s33, 81920
  s_nop 0
  buffer_load_dwordx4 v8, s[20:23], s35 offen offset:0 lds
  buffer_load_dwordx4 v9, s[20:23], s35 offen offset:1024 lds
  buffer_load_dwordx4 v10, s[20:23], s35 offen offset:2048 lds
  buffer_load_dwordx4 v11, s[20:23], s35 offen offset:3072 lds
  s_add_u32 s35, s35, 221184
  s_cmp_eq_u32 s3, 0
  s_cbranch_scc0 main_pw69
  v_and_b32 v60, 63, v0
  v_add_u32 v60, s26, v60
  v_min_u32 v60, s27, v60
  v_mul_u32_u24 v60, 128, v60
  s_add_u32 s46, s5, 24186880
  s_mov_b32 s47, 0
  s_and_b32 s45, s2, 7
  s_lshl_b32 s45, s45, 14
  s_add_u32 s46, s46, s45
  buffer_load_dword v252, v60, s[8:11], s46 offen sc1
main_pl70:
  s_waitcnt vmcnt(0)
  v_cmp_gt_u32 vcc, 10, v252
  s_cbranch_vccz main_pw69
  s_sleep 2
  buffer_load_dword v252, v60, s[8:11], s46 offen sc1
  s_add_u32 s47, s47, 1
  s_cmp_ge_u32 s47, 131072
  s_cbranch_scc0 main_pl70
main_pw69:
  s_barrier
  s_add_u32 m0, s33, 0
  s_nop 0
  buffer_load_dwordx4 v12, s[8:11], s34 offen offset:0 lds
  buffer_load_dwordx4 v13, s[8:11], s34 offen offset:1024 lds
  buffer_load_dwordx4 v14, s[8:11], s34 offen offset:2048 lds
  buffer_load_dwordx4 v15, s[8:11], s34 offen offset:3072 lds
  s_add_u32 s34, s34, s39
  s_add_u32 m0, s33, 32768
  s_nop 0
  buffer_load_dwordx4 v12, s[8:11], s34 offen offset:0 lds
  buffer_load_dwordx4 v13, s[8:11], s34 offen offset:1024 lds
  buffer_load_dwordx4 v14, s[8:11], s34 offen offset:2048 lds
  buffer_load_dwordx4 v15, s[8:11], s34 offen offset:3072 lds
  s_add_u32 s34, s34, s39
  s_add_u32 m0, s33, 65536
  s_nop 0
  buffer_load_dwordx4 v12, s[8:11], s34 offen offset:0 lds
  buffer_load_dwordx4 v13, s[8:11], s34 offen offset:1024 lds
  buffer_load_dwordx4 v14, s[8:11], s34 offen offset:2048 lds
  buffer_load_dwordx4 v15, s[8:11], s34 offen offset:3072 lds
  s_add_u32 s34, s34, s39
  s_waitcnt vmcnt(8)
  s_barrier
  s_add_u32 m0, s33, 98304
  s_nop 0
  buffer_load_dwordx4 v12, s[8:11], s34 offen offset:0 lds
  buffer_load_dwordx4 v13, s[8:11], s34 offen offset:1024 lds
  buffer_load_dwordx4 v14, s[8:11], s34 offen offset:2048 lds
  buffer_load_dwordx4 v15, s[8:11], s34 offen offset:3072 lds
  s_add_u32 s34, s34, s39
  s_add_u32 m0, s33, 114688
  s_nop 0
  buffer_load_dwordx4 v8, s[20:23], s35 offen offset:0 lds
  buffer_load_dwordx4 v9, s[20:23], s35 offen offset:1024 lds
  buffer_load_dwordx4 v10, s[20:23], s35 offen offset:2048 lds
  buffer_load_dwordx4 v11, s[20:23], s35 offen offset:3072 lds
  s_add_u32 s35, s35, 221184
  s_waitcnt vmcnt(12)
  s_barrier
  s_add_u32 m0, s33, 131072
  s_nop 0
  buffer_load_dwordx4 v12, s[8:11], s34 offen offset:0 lds
  buffer_load_dwordx4 v13, s[8:11], s34 offen offset:1024 lds
  buffer_load_dwordx4 v14, s[8:11], s34 offen offset:2048 lds
  buffer_load_dwordx4 v15, s[8:11], s34 offen offset:3072 lds
  s_add_u32 s34, s34, s39
  s_add_u32 m0, s33, 147456
  s_nop 0
  buffer_load_dwordx4 v8, s[20:23], s35 offen offset:0 lds
  buffer_load_dwordx4 v9, s[20:23], s35 offen offset:1024 lds
  buffer_load_dwordx4 v10, s[20:23], s35 offen offset:2048 lds
  buffer_load_dwordx4 v11, s[20:23], s35 offen offset:3072 lds
  s_add_u32 s35, s35, 221184
  s_waitcnt vmcnt(16)
  s_barrier
  s_add_u32 m0, s33, 0
  s_nop 0
  buffer_load_dwordx4 v12, s[8:11], s34 offen offset:0 lds
  buffer_load_dwordx4 v13, s[8:11], s34 offen offset:1024 lds
  buffer_load_dwordx4 v14, s[8:11], s34 offen offset:2048 lds
  buffer_load_dwordx4 v15, s[8:11], s34 offen offset:3072 lds
  s_add_u32 s34, s34, s39
  s_add_u32 m0, s33, 16384
  s_nop 0
  buffer_load_dwordx4 v8, s[20:23], s35 offen offset:0 lds
  buffer_load_dwordx4 v9, s[20:23], s35 offen offset:1024 lds
  buffer_load_dwordx4 v10, s[20:23], s35 offen offset:2048 lds
  buffer_load_dwordx4 v11, s[20:23], s35 offen offset:3072 lds
  s_add_u32 s35, s35, 221184
  s_waitcnt vmcnt(16)
  s_barrier
  s_add_u32 m0, s33, 32768
  s_nop 0
  buffer_load_dwordx4 v12, s[8:11], s34 offen offset:0 lds
  buffer_load_dwordx4 v13, s[8:11], s34 offen offset:1024 lds
  buffer_load_dwordx4 v14, s[8:11], s34 offen offset:2048 lds
  buffer_load_dwordx4 v15, s[8:11], s34 offen offset:3072 lds
  s_add_u32 s34, s34, s39
  s_add_u32 m0, s33, 49152
  s_nop 0
  buffer_load_dwordx4 v8, s[20:23], s35 offen offset:0 lds
  buffer_load_dwordx4 v9, s[20:23], s35 offen offset:1024 lds
  buffer_load_dwordx4 v10, s[20:23], s35 offen offset:2048 lds
  buffer_load_dwordx4 v11, s[20:23], s35 offen offset:3072 lds
  s_add_u32 s35, s35, 221184
  s_waitcnt vmcnt(16)
  s_barrier
  s_add_u32 m0, s33, 65536
  s_nop 0
  buffer_load_dwordx4 v12, s[8:11], s34 offen offset:0 lds
  buffer_load_dwordx4 v13, s[8:11], s34 offen offset:1024 lds
  buffer_load_dwordx4 v14, s[8:11], s34 offen offset:2048 lds
  buffer_load_dwordx4 v15, s[8:11], s34 offen offset:3072 lds
  s_add_u32 s34, s34, s39
  s_add_u32 m0, s33, 81920
  s_nop 0
  buffer_load_dwordx4 v8, s[20:23], s35 offen offset:0 lds
  buffer_load_dwordx4 v9, s[20:23], s35 offen offset:1024 lds
  buffer_load_dwordx4 v10, s[20:23], s35 offen offset:2048 lds
  buffer_load_dwordx4 v11, s[20:23], s35 offen offset:3072 lds
  s_add_u32 s35, s35, 221184
  s_waitcnt vmcnt(16)
  s_barrier
  s_add_u32 m0, s33, 98304
  s_nop 0
  buffer_load_dwordx4 v12, s[8:11], s34 offen offset:0 lds
  buffer_load_dwordx4 v13, s[8:11], s34 offen offset:1024 lds
  buffer_load_dwordx4 v14, s[8:11], s34 offen offset:2048 lds
  buffer_load_dwordx4 v15, s[8:11], s34 offen offset:3072 lds
  s_add_u32 s34, s34, s39
  s_add_u32 m0, s33, 114688
  s_nop 0
  buffer_load_dwordx4 v8, s[20:23], s35 offen offset:0 lds
  buffer_load_dwordx4 v9, s[20:23], s35 offen offset:1024 lds
  buffer_load_dwordx4 v10, s[20:23], s35 offen offset:2048 lds
  buffer_load_dwordx4 v11, s[20:23], s35 offen offset:3072 lds
  s_add_u32 s35, s35, 221184
  s_waitcnt vmcnt(16)
  s_barrier
  s_add_u32 m0, s33, 131072
  s_nop 0
  buffer_load_dwordx4 v12, s[8:11], s34 offen offset:0 lds
  buffer_load_dwordx4 v13, s[8:11], s34 offen offset:1024 lds
  buffer_load_dwordx4 v14, s[8:11], s34 offen offset:2048 lds
  buffer_load_dwordx4 v15, s[8:11], s34 offen offset:3072 lds
  s_add_u32 s34, s34, s39
  s_add_u32 m0, s33, 147456
  s_nop 0
  buffer_load_dwordx4 v8, s[20:23], s35 offen offset:0 lds
  buffer_load_dwordx4 v9, s[20:23], s35 offen offset:1024 lds
  buffer_load_dwordx4 v10, s[20:23], s35 offen offset:2048 lds
  buffer_load_dwordx4 v11, s[20:23], s35 offen offset:3072 lds
  s_add_u32 s35, s35, 221184
  s_waitcnt vmcnt(16)
  s_barrier
  s_waitcnt vmcnt(8)
  s_barrier
  s_waitcnt vmcnt(0)
  s_barrier
  s_branch main_w168_fin2
main_w168_cons:
  s_and_b32 s29, s28, 1
  s_lshr_b32 s30, s28, 1
  v_lshrrev_b32 v3, 5, v1
  v_and_b32 v4, 31, v1
  s_lshl_b32 s31, s24, 7
  s_lshl_b32 s32, s29, 6
  s_add_u32 s31, s31, s32
  v_add_u32 v5, s31, v4
  v_lshlrev_b32 v6, 3, v5
  v_mul_u32_u24 v7, 81920, v3
  v_add_u32 v6, v6, v7
  s_lshl_b32 s33, s25, 7
  s_lshl_b32 s34, s30, 6
  s_add_u32 s33, s33, s34
  v_lshlrev_b32 v7, 2, v3
  v_add_u32 v7, s33, v7
  v_lshlrev_b32 v8, 2, v7
  v_lshlrev_b32 v9, 1, v7
  s_mov_b32 s34, 24125440
  buffer_load_dwordx4 v[160:163], v8, s[8:11], s34 offen offset:0
  buffer_load_dwordx4 v[164:167], v8, s[8:11], s34 offen offset:32
  buffer_load_dwordx4 v[168:171], v8, s[8:11], s34 offen offset:64
  buffer_load_dwordx4 v[172:175], v8, s[8:11], s34 offen offset:96
  buffer_load_dwordx4 v[176:179], v8, s[8:11], s34 offen offset:128
  buffer_load_dwordx4 v[180:183], v8, s[8:11], s34 offen offset:160
  buffer_load_dwordx4 v[184:187], v8, s[8:11], s34 offen offset:192
  buffer_load_dwordx4 v[188:191], v8, s[8:11], s34 offen offset:224
  buffer_load_dwordx2 v[192:193], v9, s[88:91], 0 offen offset:0
  buffer_load_dwordx2 v[194:195], v9, s[88:91], 0 offen offset:16
  buffer_load_dwordx2 v[196:197], v9, s[88:91], 0 offen offset:32
  buffer_load_dwordx2 v[198:199], v9, s[88:91], 0 offen offset:48
  buffer_load_dwordx2 v[200:201], v9, s[88:91], 0 offen offset:64
  buffer_load_dwordx2 v[202:203], v9, s[88:91], 0 offen offset:80
  buffer_load_dwordx2 v[204:205], v9, s[88:91], 0 offen offset:96
  buffer_load_dwordx2 v[206:207], v9, s[88:91], 0 offen offset:112
  v_lshlrev_b32 v10, 11, v3
  s_lshl_b32 s34, s29, 6
  v_add_u32 v11, s34, v4
  v_lshlrev_b32 v11, 4, v11
  v_add_u32 v10, v10, v11
  v_lshrrev_b32 v16, 2, v1
  v_and_b32 v16, 3, v16
  v_lshlrev_b32 v17, 3, v3
  v_add_u32 v17, v17, v16
  v_lshlrev_b32 v17, 8, v17
  s_lshl_b32 s34, s30, 3
  v_lshlrev_b32 v18, 2, v16
  v_xor_b32 v18, s34, v18
  v_lshrrev_b32 v19, 4, v1
  v_and_b32 v19, 1, v19
  v_lshlrev_b32 v19, 1, v19
  v_add_u32 v18, v18, v19
  v_lshrrev_b32 v19, 1, v1
  v_and_b32 v19, 1, v19
  v_add_u32 v18, v18, v19
  v_lshlrev_b32 v18, 4, v18
  v_and_b32 v19, 1, v1
  v_lshlrev_b32 v19, 3, v19
  v_add_u32 v18, v18, v19
  v_add_u32 v11, v17, v18
  v_add_u32 v11, 16384, v11
  v_xor_b32 v12, 64, v11
  v_add_u32 v13, 65536, v10
  v_add_u32 v14, 65536, v11
  v_add_u32 v15, 65536, v12
  v_add_u32 v56, 131072, v10
  v_add_u32 v57, 131072, v11
  v_add_u32 v62, 131072, v12
  s_cmp_eq_u32 s3, 0
  s_cbranch_scc0 main_pw71
  v_and_b32 v60, 63, v0
  v_add_u32 v60, s26, v60
  v_min_u32 v60, s27, v60
  v_mul_u32_u24 v60, 128, v60
  s_add_u32 s46, s5, 24186880
  s_mov_b32 s47, 0
  s_and_b32 s45, s2, 7
  s_lshl_b32 s45, s45, 14
  s_add_u32 s46, s46, s45
  buffer_load_dword v252, v60, s[8:11], s46 offen sc1
main_pl72:
  s_waitcnt vmcnt(0)
  v_cmp_gt_u32 vcc, 10, v252
  s_cbranch_vccz main_pw71
  s_sleep 2
  buffer_load_dword v252, v60, s[8:11], s46 offen sc1
  s_add_u32 s47, s47, 1
  s_cmp_ge_u32 s47, 131072
  s_cbranch_scc0 main_pl72
main_pw71:
  s_barrier
  s_add_u32 s38, s5, 22806528
  buffer_load_dwordx2 v[208:209], v6, s[8:11], s38 offen offset:0
  buffer_load_dwordx2 v[210:211], v6, s[8:11], s38 offen offset:256
  s_add_u32 s38, s5, 22822912
  buffer_load_dwordx2 v[212:213], v6, s[8:11], s38 offen offset:0
  buffer_load_dwordx2 v[214:215], v6, s[8:11], s38 offen offset:256
  s_add_u32 s38, s5, 22839296
  buffer_load_dwordx2 v[216:217], v6, s[8:11], s38 offen offset:0
  buffer_load_dwordx2 v[218:219], v6, s[8:11], s38 offen offset:256
  s_add_u32 s38, s5, 22855680
  buffer_load_dwordx2 v[220:221], v6, s[8:11], s38 offen offset:0
  buffer_load_dwordx2 v[222:223], v6, s[8:11], s38 offen offset:256
  s_add_u32 s38, s5, 22872064
  buffer_load_dwordx2 v[224:225], v6, s[8:11], s38 offen offset:0
  buffer_load_dwordx2 v[226:227], v6, s[8:11], s38 offen offset:256
main_st73:
  s_barrier
  ds_read_b64_tr_b16 v[128:129], v11 offset:0
  ds_read_b64_tr_b16 v[130:131], v11 offset:1024
  ds_read_b128 v[136:139], v10 offset:0
  ds_read_b64_tr_b16 v[132:133], v12 offset:0
  ds_read_b64_tr_b16 v[134:135], v12 offset:1024
  ds_read_b128 v[140:143], v10 offset:512
  s_waitcnt lgkmcnt(3)
  v_mfma_f32_32x32x16_bf16 v[64:79], v[128:131], v[136:139], 0
  ds_read_b64_tr_b16 v[144:145], v11 offset:4096
  ds_read_b64_tr_b16 v[146:147], v11 offset:5120
  s_waitcnt lgkmcnt(3)
  v_mfma_f32_32x32x16_bf16 v[96:111], v[132:135], v[136:139], 0
  ds_read_b128 v[152:155], v10 offset:4096
  ds_read_b64_tr_b16 v[148:149], v12 offset:4096
  s_waitcnt lgkmcnt(4)
  v_mfma_f32_32x32x16_bf16 v[80:95], v[128:131], v[140:143], 0
  ds_read_b64_tr_b16 v[150:151], v12 offset:5120
  ds_read_b128 v[156:159], v10 offset:4608
  v_mfma_f32_32x32x16_bf16 v[112:127], v[132:135], v[140:143], 0
  s_waitcnt lgkmcnt(3)
  v_mfma_f32_32x32x16_bf16 v[64:79], v[144:147], v[152:155], v[64:79]
  ds_read_b64_tr_b16 v[128:129], v11 offset:8192
  ds_read_b64_tr_b16 v[130:131], v11 offset:9216
  s_waitcnt lgkmcnt(3)
  v_mfma_f32_32x32x16_bf16 v[96:111], v[148:151], v[152:155], v[96:111]
  ds_read_b128 v[136:139], v10 offset:8192
  ds_read_b64_tr_b16 v[132:133], v12 offset:8192
  s_waitcnt lgkmcnt(4)
  v_mfma_f32_32x32x16_bf16 v[80:95], v[144:147], v[156:159], v[80:95]
  ds_read_b64_tr_b16 v[134:135], v12 offset:9216
  ds_read_b128 v[140:143], v10 offset:8704
  v_mfma_f32_32x32x16_bf16 v[112:127], v[148:151], v[156:159], v[112:127]
  s_waitcnt lgkmcnt(3)
  v_mfma_f32_32x32x16_bf16 v[64:79], v[128:131], v[136:139], v[64:79]
  ds_read_b64_tr_b16 v[144:145], v11 offset:12288
  ds_read_b64_tr_b16 v[146:147], v11 offset:13312
  s_waitcnt lgkmcnt(3)
  v_mfma_f32_32x32x16_bf16 v[96:111], v[132:135], v[136:139], v[96:111]
  ds_read_b128 v[152:155], v10 offset:12288
  ds_read_b64_tr_b16 v[148:149], v12 offset:12288
  s_waitcnt lgkmcnt(4)
  v_mfma_f32_32x32x16_bf16 v[80:95], v[128:131], v[140:143], v[80:95]
  ds_read_b64_tr_b16 v[150:151], v12 offset:13312
  ds_read_b128 v[156:159], v10 offset:12800
  v_mfma_f32_32x32x16_bf16 v[112:127], v[132:135], v[140:143], v[112:127]
  s_barrier
  s_waitcnt lgkmcnt(3)
  v_mfma_f32_32x32x16_bf16 v[64:79], v[144:147], v[152:155], v[64:79]
  ds_read_b64_tr_b16 v[128:129], v11 offset:32768
  ds_read_b64_tr_b16 v[130:131], v11 offset:33792
  s_waitcnt lgkmcnt(3)
  v_mfma_f32_32x32x16_bf16 v[96:111], v[148:151], v[152:155], v[96:111]
  ds_read_b128 v[136:139], v10 offset:32768
  ds_read_b64_tr_b16 v[132:133], v12 offset:32768
  s_waitcnt lgkmcnt(4)
  v_mfma_f32_32x32x16_bf16 v[80:95], v[144:147], v[156:159], v[80:95]
  ds_read_b64_tr_b16 v[134:135], v12 offset:33792
  ds_read_b128 v[140:143], v10 offset:33280
  v_mfma_f32_32x32x16_bf16 v[112:127], v[148:151], v[156:159], v[112:127]
  s_waitcnt lgkmcnt(3)
  v_mfma_f32_32x32x16_bf16 v[64:79], v[128:131], v[136:139], v[64:79]
  ds_read_b64_tr_b16 v[144:145], v11 offset:36864
  ds_read_b64_tr_b16 v[146:147], v11 offset:37888
  s_waitcnt lgkmcnt(3)
  v_mfma_f32_32x32x16_bf16 v[96:111], v[132:135], v[136:139], v[96:111]
  ds_read_b128 v[152:155], v10 offset:36864
  ds_read_b64_tr_b16 v[148:149], v12 offset:36864
  s_waitcnt lgkmcnt(4)
  v_mfma_f32_32x32x16_bf16 v[80:95], v[128:131], v[140:143], v[80:95]
  ds_read_b64_tr_b16 v[150:151], v12 offset:37888
  ds_read_b128 v[156:159], v10 offset:37376
  v_mfma_f32_32x32x16_bf16 v[112:127], v[132:135], v[140:143], v[112:127]
  s_waitcnt lgkmcnt(3)
  v_mfma_f32_32x32x16_bf16 v[64:79], v[144:147], v[152:155], v[64:79]
  ds_read_b64_tr_b16 v[128:129], v11 offset:40960
  ds_read_b64_tr_b16 v[130:131], v11 offset:41984
  s_waitcnt lgkmcnt(3)
  v_mfma_f32_32x32x16_bf16 v[96:111], v[148:151], v[152:155], v[96:111]
  ds_read_b128 v[136:139], v10 offset:40960
  ds_read_b64_tr_b16 v[132:133], v12 offset:40960
  s_waitcnt lgkmcnt(4)
  v_mfma_f32_32x32x16_bf16 v[80:95], v[144:147], v[156:159], v[80:95]
  ds_read_b64_tr_b16 v[134:135], v12 offset:41984
  ds_read_b128 v[140:143], v10 offset:41472
  v_mfma_f32_32x32x16_bf16 v[112:127], v[148:151], v[156:159], v[112:127]
  s_waitcnt lgkmcnt(3)
  v_mfma_f32_32x32x16_bf16 v[64:79], v[128:131], v[136:139], v[64:79]
  ds_read_b64_tr_b16 v[144:145], v11 offset:45056
  ds_read_b64_tr_b16 v[146:147], v11 offset:46080
  s_waitcnt lgkmcnt(3)
  v_mfma_f32_32x32x16_bf16 v[96:111], v[132:135], v[136:139], v[96:111]
  ds_read_b128 v[152:155], v10 offset:45056
  ds_read_b64_tr_b16 v[148:149], v12 offset:45056
  s_waitcnt lgkmcnt(4)
  v_mfma_f32_32x32x16_bf16 v[80:95], v[128:131], v[140:143], v[80:95]
  ds_read_b64_tr_b16 v[150:151], v12 offset:46080
  ds_read_b128 v[156:159], v10 offset:45568
  v_mfma_f32_32x32x16_bf16 v[112:127], v[132:135], v[140:143], v[112:127]
  s_barrier
  s_waitcnt lgkmcnt(3)
  v_mfma_f32_32x32x16_bf16 v[64:79], v[144:147], v[152:155], v[64:79]
  ds_read_b64_tr_b16 v[128:129], v14 offset:0
  ds_read_b64_tr_b16 v[130:131], v14 offset:1024
  s_waitcnt lgkmcnt(3)
  v_mfma_f32_32x32x16_bf16 v[96:111], v[148:151], v[152:155], v[96:111]
  ds_read_b128 v[136:139], v13 offset:0
  ds_read_b64_tr_b16 v[132:133], v15 offset:0
  s_waitcnt lgkmcnt(4)
  v_mfma_f32_32x32x16_bf16 v[80:95], v[144:147], v[156:159], v[80:95]
  ds_read_b64_tr_b16 v[134:135], v15 offset:1024
  ds_read_b128 v[140:143], v13 offset:512
  v_mfma_f32_32x32x16_bf16 v[112:127], v[148:151], v[156:159], v[112:127]
  s_waitcnt lgkmcnt(3)
  v_mfma_f32_32x32x16_bf16 v[64:79], v[128:131], v[136:139], v[64:79]
  ds_read_b64_tr_b16 v[144:145], v14 offset:4096
  ds_read_b64_tr_b16 v[146:147], v14 offset:5120
  s_waitcnt lgkmcnt(3)
  v_mfma_f32_32x32x16_bf16 v[96:111], v[132:135], v[136:139], v[96:111]
  ds_read_b128 v[152:155], v13 offset:4096
  ds_read_b64_tr_b16 v[148:149], v15 offset:4096
  s_waitcnt lgkmcnt(4)
  v_mfma_f32_32x32x16_bf16 v[80:95], v[128:131], v[140:143], v[80:95]
  ds_read_b64_tr_b16 v[150:151], v15 offset:5120
  ds_read_b128 v[156:159], v13 offset:4608
  v_mfma_f32_32x32x16_bf16 v[112:127], v[132:135], v[140:143], v[112:127]
  s_waitcnt lgkmcnt(3)
  v_mfma_f32_32x32x16_bf16 v[64:79], v[144:147], v[152:155], v[64:79]
  ds_read_b64_tr_b16 v[128:129], v14 offset:8192
  ds_read_b64_tr_b16 v[130:131], v14 offset:9216
  s_waitcnt lgkmcnt(3)
  v_mfma_f32_32x32x16_bf16 v[96:111], v[148:151], v[152:155], v[96:111]
  ds_read_b128 v[136:139], v13 offset:8192
  ds_read_b64_tr_b16 v[132:133], v15 offset:8192
  s_waitcnt lgkmcnt(4)
  v_mfma_f32_32x32x16_bf16 v[80:95], v[144:147], v[156:159], v[80:95]
  ds_read_b64_tr_b16 v[134:135], v15 offset:9216
  ds_read_b128 v[140:143], v13 offset:8704
  v_mfma_f32_32x32x16_bf16 v[112:127], v[148:151], v[156:159], v[112:127]
  s_waitcnt lgkmcnt(3)
  v_mfma_f32_32x32x16_bf16 v[64:79], v[128:131], v[136:139], v[64:79]
  ds_read_b64_tr_b16 v[144:145], v14 offset:12288
  ds_read_b64_tr_b16 v[146:147], v14 offset:13312
  s_waitcnt lgkmcnt(3)
  v_mfma_f32_32x32x16_bf16 v[96:111], v[132:135], v[136:139], v[96:111]
  ds_read_b128 v[152:155], v13 offset:12288
  ds_read_b64_tr_b16 v[148:149], v15 offset:12288
  s_waitcnt lgkmcnt(4)
  v_mfma_f32_32x32x16_bf16 v[80:95], v[128:131], v[140:143], v[80:95]
  ds_read_b64_tr_b16 v[150:151], v15 offset:13312
  ds_read_b128 v[156:159], v13 offset:12800
  v_mfma_f32_32x32x16_bf16 v[112:127], v[132:135], v[140:143], v[112:127]
  s_barrier
  s_waitcnt lgkmcnt(3)
  v_mfma_f32_32x32x16_bf16 v[64:79], v[144:147], v[152:155], v[64:79]
  ds_read_b64_tr_b16 v[128:129], v14 offset:32768
  ds_read_b64_tr_b16 v[130:131], v14 offset:33792
  s_waitcnt lgkmcnt(3)
  v_mfma_f32_32x32x16_bf16 v[96:111], v[148:151], v[152:155], v[96:111]
  ds_read_b128 v[136:139], v13 offset:32768
  ds_read_b64_tr_b16 v[132:133], v15 offset:32768
  s_waitcnt lgkmcnt(4)
  v_mfma_f32_32x32x16_bf16 v[80:95], v[144:147], v[156:159], v[80:95]
  ds_read_b64_tr_b16 v[134:135], v15 offset:33792
  ds_read_b128 v[140:143], v13 offset:33280
  v_mfma_f32_32x32x16_bf16 v[112:127], v[148:151], v[156:159], v[112:127]
  s_waitcnt lgkmcnt(3)
  v_mfma_f32_32x32x16_bf16 v[64:79], v[128:131], v[136:139], v[64:79]
  ds_read_b64_tr_b16 v[144:145], v14 offset:36864
  ds_read_b64_tr_b16 v[146:147], v14 offset:37888
  s_waitcnt lgkmcnt(3)
  v_mfma_f32_32x32x16_bf16 v[96:111], v[132:135], v[136:139], v[96:111]
  ds_read_b128 v[152:155], v13 offset:36864
  ds_read_b64_tr_b16 v[148:149], v15 offset:36864
  s_waitcnt lgkmcnt(4)
  v_mfma_f32_32x32x16_bf16 v[80:95], v[128:131], v[140:143], v[80:95]
  ds_read_b64_tr_b16 v[150:151], v15 offset:37888
  ds_read_b128 v[156:159], v13 offset:37376
  v_mfma_f32_32x32x16_bf16 v[112:127], v[132:135], v[140:143], v[112:127]
  s_waitcnt lgkmcnt(3)
  v_mfma_f32_32x32x16_bf16 v[64:79], v[144:147], v[152:155], v[64:79]
  ds_read_b64_tr_b16 v[128:129], v14 offset:40960
  ds_read_b64_tr_b16 v[130:131], v14 offset:41984
  s_waitcnt lgkmcnt(3)
  v_mfma_f32_32x32x16_bf16 v[96:111], v[148:151], v[152:155], v[96:111]
  ds_read_b128 v[136:139], v13 offset:40960
  ds_read_b64_tr_b16 v[132:133], v15 offset:40960
  s_waitcnt lgkmcnt(4)
  v_mfma_f32_32x32x16_bf16 v[80:95], v[144:147], v[156:159], v[80:95]
  ds_read_b64_tr_b16 v[134:135], v15 offset:41984
  ds_read_b128 v[140:143], v13 offset:41472
  v_mfma_f32_32x32x16_bf16 v[112:127], v[148:151], v[156:159], v[112:127]
  s_waitcnt lgkmcnt(3)
  v_mfma_f32_32x32x16_bf16 v[64:79], v[128:131], v[136:139], v[64:79]
  ds_read_b64_tr_b16 v[144:145], v14 offset:45056
  ds_read_b64_tr_b16 v[146:147], v14 offset:46080
  s_waitcnt lgkmcnt(3)
  v_mfma_f32_32x32x16_bf16 v[96:111], v[132:135], v[136:139], v[96:111]
  ds_read_b128 v[152:155], v13 offset:45056
  ds_read_b64_tr_b16 v[148:149], v15 offset:45056
  s_waitcnt lgkmcnt(4)
  v_mfma_f32_32x32x16_bf16 v[80:95], v[128:131], v[140:143], v[80:95]
  ds_read_b64_tr_b16 v[150:151], v15 offset:46080
  ds_read_b128 v[156:159], v13 offset:45568
  v_mfma_f32_32x32x16_bf16 v[112:127], v[132:135], v[140:143], v[112:127]
  s_barrier
  s_waitcnt lgkmcnt(3)
  v_mfma_f32_32x32x16_bf16 v[64:79], v[144:147], v[152:155], v[64:79]
  ds_read_b64_tr_b16 v[128:129], v57 offset:0
  ds_read_b64_tr_b16 v[130:131], v57 offset:1024
  s_waitcnt lgkmcnt(3)
  v_mfma_f32_32x32x16_bf16 v[96:111], v[148:151], v[152:155], v[96:111]
  ds_read_b128 v[136:139], v56 offset:0
  ds_read_b64_tr_b16 v[132:133], v62 offset:0
  s_waitcnt lgkmcnt(4)
  v_mfma_f32_32x32x16_bf16 v[80:95], v[144:147], v[156:159], v[80:95]
  ds_read_b64_tr_b16 v[134:135], v62 offset:1024
  ds_read_b128 v[140:143], v56 offset:512
  v_mfma_f32_32x32x16_bf16 v[112:127], v[148:151], v[156:159], v[112:127]
  s_waitcnt lgkmcnt(3)
  v_mfma_f32_32x32x16_bf16 v[64:79], v[128:131], v[136:139], v[64:79]
  ds_read_b64_tr_b16 v[144:145], v57 offset:4096
  ds_read_b64_tr_b16 v[146:147], v57 offset:5120
  s_waitcnt lgkmcnt(3)
  v_mfma_f32_32x32x16_bf16 v[96:111], v[132:135], v[136:139], v[96:111]
  ds_read_b128 v[152:155], v56 offset:4096
  ds_read_b64_tr_b16 v[148:149], v62 offset:4096
  s_waitcnt lgkmcnt(4)
  v_mfma_f32_32x32x16_bf16 v[80:95], v[128:131], v[140:143], v[80:95]
  ds_read_b64_tr_b16 v[150:151], v62 offset:5120
  ds_read_b128 v[156:159], v56 offset:4608
  v_mfma_f32_32x32x16_bf16 v[112:127], v[132:135], v[140:143], v[112:127]
  s_waitcnt lgkmcnt(3)
  v_mfma_f32_32x32x16_bf16 v[64:79], v[144:147], v[152:155], v[64:79]
  ds_read_b64_tr_b16 v[128:129], v57 offset:8192
  ds_read_b64_tr_b16 v[130:131], v57 offset:9216
  s_waitcnt lgkmcnt(3)
  v_mfma_f32_32x32x16_bf16 v[96:111], v[148:151], v[152:155], v[96:111]
  ds_read_b128 v[136:139], v56 offset:8192
  ds_read_b64_tr_b16 v[132:133], v62 offset:8192
  s_waitcnt lgkmcnt(4)
  v_mfma_f32_32x32x16_bf16 v[80:95], v[144:147], v[156:159], v[80:95]
  ds_read_b64_tr_b16 v[134:135], v62 offset:9216
  ds_read_b128 v[140:143], v56 offset:8704
  v_mfma_f32_32x32x16_bf16 v[112:127], v[148:151], v[156:159], v[112:127]
  s_waitcnt lgkmcnt(3)
  v_mfma_f32_32x32x16_bf16 v[64:79], v[128:131], v[136:139], v[64:79]
  ds_read_b64_tr_b16 v[144:145], v57 offset:12288
  ds_read_b64_tr_b16 v[146:147], v57 offset:13312
  s_waitcnt lgkmcnt(3)
  v_mfma_f32_32x32x16_bf16 v[96:111], v[132:135], v[136:139], v[96:111]
  ds_read_b128 v[152:155], v56 offset:12288
  ds_read_b64_tr_b16 v[148:149], v62 offset:12288
  s_waitcnt lgkmcnt(4)
  v_mfma_f32_32x32x16_bf16 v[80:95], v[128:131], v[140:143], v[80:95]
  ds_read_b64_tr_b16 v[150:151], v62 offset:13312
  ds_read_b128 v[156:159], v56 offset:12800
  v_mfma_f32_32x32x16_bf16 v[112:127], v[132:135], v[140:143], v[112:127]
  s_barrier
  s_waitcnt lgkmcnt(3)
  v_mfma_f32_32x32x16_bf16 v[64:79], v[144:147], v[152:155], v[64:79]
  ds_read_b64_tr_b16 v[128:129], v11 offset:0
  ds_read_b64_tr_b16 v[130:131], v11 offset:1024
  s_waitcnt lgkmcnt(3)
  v_mfma_f32_32x32x16_bf16 v[96:111], v[148:151], v[152:155], v[96:111]
  ds_read_b128 v[136:139], v10 offset:0
  ds_read_b64_tr_b16 v[132:133], v12 offset:0
  s_waitcnt lgkmcnt(4)
  v_mfma_f32_32x32x16_bf16 v[80:95], v[144:147], v[156:159], v[80:95]
  ds_read_b64_tr_b16 v[134:135], v12 offset:1024
  ds_read_b128 v[140:143], v10 offset:512
  v_mfma_f32_32x32x16_bf16 v[112:127], v[148:151], v[156:159], v[112:127]
  s_waitcnt lgkmcnt(3)
  v_mfma_f32_32x32x16_bf16 v[64:79], v[128:131], v[136:139], v[64:79]
  ds_read_b64_tr_b16 v[144:145], v11 offset:4096
  ds_read_b64_tr_b16 v[146:147], v11 offset:5120
  s_waitcnt lgkmcnt(3)
  v_mfma_f32_32x32x16_bf16 v[96:111], v[132:135], v[136:139], v[96:111]
  ds_read_b128 v[152:155], v10 offset:4096
  ds_read_b64_tr_b16 v[148:149], v12 offset:4096
  s_waitcnt lgkmcnt(4)
  v_mfma_f32_32x32x16_bf16 v[80:95], v[128:131], v[140:143], v[80:95]
  ds_read_b64_tr_b16 v[150:151], v12 offset:5120
  ds_read_b128 v[156:159], v10 offset:4608
  v_mfma_f32_32x32x16_bf16 v[112:127], v[132:135], v[140:143], v[112:127]
  s_waitcnt lgkmcnt(3)
  v_mfma_f32_32x32x16_bf16 v[64:79], v[144:147], v[152:155], v[64:79]
  ds_read_b64_tr_b16 v[128:129], v11 offset:8192
  ds_read_b64_tr_b16 v[130:131], v11 offset:9216
  s_waitcnt lgkmcnt(3)
  v_mfma_f32_32x32x16_bf16 v[96:111], v[148:151], v[152:155], v[96:111]
  ds_read_b128 v[136:139], v10 offset:8192
  ds_read_b64_tr_b16 v[132:133], v12 offset:8192
  s_waitcnt lgkmcnt(4)
  v_mfma_f32_32x32x16_bf16 v[80:95], v[144:147], v[156:159], v[80:95]
  ds_read_b64_tr_b16 v[134:135], v12 offset:9216
  ds_read_b128 v[140:143], v10 offset:8704
  v_mfma_f32_32x32x16_bf16 v[112:127], v[148:151], v[156:159], v[112:127]
  s_waitcnt lgkmcnt(3)
  v_mfma_f32_32x32x16_bf16 v[64:79], v[128:131], v[136:139], v[64:79]
  ds_read_b64_tr_b16 v[144:145], v11 offset:12288
  ds_read_b64_tr_b16 v[146:147], v11 offset:13312
  s_waitcnt lgkmcnt(3)
  v_mfma_f32_32x32x16_bf16 v[96:111], v[132:135], v[136:139], v[96:111]
  ds_read_b128 v[152:155], v10 offset:12288
  ds_read_b64_tr_b16 v[148:149], v12 offset:12288
  s_waitcnt lgkmcnt(4)
  v_mfma_f32_32x32x16_bf16 v[80:95], v[128:131], v[140:143], v[80:95]
  ds_read_b64_tr_b16 v[150:151], v12 offset:13312
  ds_read_b128 v[156:159], v10 offset:12800
  v_mfma_f32_32x32x16_bf16 v[112:127], v[132:135], v[140:143], v[112:127]
  s_barrier
  s_waitcnt lgkmcnt(3)
  v_mfma_f32_32x32x16_bf16 v[64:79], v[144:147], v[152:155], v[64:79]
  ds_read_b64_tr_b16 v[128:129], v11 offset:32768
  ds_read_b64_tr_b16 v[130:131], v11 offset:33792
  s_waitcnt lgkmcnt(3)
  v_mfma_f32_32x32x16_bf16 v[96:111], v[148:151], v[152:155], v[96:111]
  ds_read_b128 v[136:139], v10 offset:32768
  ds_read_b64_tr_b16 v[132:133], v12 offset:32768
  s_waitcnt lgkmcnt(4)
  v_mfma_f32_32x32x16_bf16 v[80:95], v[144:147], v[156:159], v[80:95]
  ds_read_b64_tr_b16 v[134:135], v12 offset:33792
  ds_read_b128 v[140:143], v10 offset:33280
  v_mfma_f32_32x32x16_bf16 v[112:127], v[148:151], v[156:159], v[112:127]
  s_waitcnt lgkmcnt(3)
  v_mfma_f32_32x32x16_bf16 v[64:79], v[128:131], v[136:139], v[64:79]
  ds_read_b64_tr_b16 v[144:145], v11 offset:36864
  ds_read_b64_tr_b16 v[146:147], v11 offset:37888
  s_waitcnt lgkmcnt(3)
  v_mfma_f32_32x32x16_bf16 v[96:111], v[132:135], v[136:139], v[96:111]
  ds_read_b128 v[152:155], v10 offset:36864
  ds_read_b64_tr_b16 v[148:149], v12 offset:36864
  s_waitcnt lgkmcnt(4)
  v_mfma_f32_32x32x16_bf16 v[80:95], v[128:131], v[140:143], v[80:95]
  ds_read_b64_tr_b16 v[150:151], v12 offset:37888
  ds_read_b128 v[156:159], v10 offset:37376
  v_mfma_f32_32x32x16_bf16 v[112:127], v[132:135], v[140:143], v[112:127]
  s_waitcnt lgkmcnt(3)
  v_mfma_f32_32x32x16_bf16 v[64:79], v[144:147], v[152:155], v[64:79]
  ds_read_b64_tr_b16 v[128:129], v11 offset:40960
  ds_read_b64_tr_b16 v[130:131], v11 offset:41984
  s_waitcnt lgkmcnt(3)
  v_mfma_f32_32x32x16_bf16 v[96:111], v[148:151], v[152:155], v[96:111]
  ds_read_b128 v[136:139], v10 offset:40960
  ds_read_b64_tr_b16 v[132:133], v12 offset:40960
  s_waitcnt lgkmcnt(4)
  v_mfma_f32_32x32x16_bf16 v[80:95], v[144:147], v[156:159], v[80:95]
  ds_read_b64_tr_b16 v[134:135], v12 offset:41984
  ds_read_b128 v[140:143], v10 offset:41472
  v_mfma_f32_32x32x16_bf16 v[112:127], v[148:151], v[156:159], v[112:127]
  s_waitcnt lgkmcnt(3)
  v_mfma_f32_32x32x16_bf16 v[64:79], v[128:131], v[136:139], v[64:79]
  ds_read_b64_tr_b16 v[144:145], v11 offset:45056
  ds_read_b64_tr_b16 v[146:147], v11 offset:46080
  s_waitcnt lgkmcnt(3)
  v_mfma_f32_32x32x16_bf16 v[96:111], v[132:135], v[136:139], v[96:111]
  ds_read_b128 v[152:155], v10 offset:45056
  ds_read_b64_tr_b16 v[148:149], v12 offset:45056
  s_waitcnt lgkmcnt(4)
  v_mfma_f32_32x32x16_bf16 v[80:95], v[128:131], v[140:143], v[80:95]
  ds_read_b64_tr_b16 v[150:151], v12 offset:46080
  ds_read_b128 v[156:159], v10 offset:45568
  v_mfma_f32_32x32x16_bf16 v[112:127], v[132:135], v[140:143], v[112:127]
  s_barrier
  s_waitcnt lgkmcnt(3)
  v_mfma_f32_32x32x16_bf16 v[64:79], v[144:147], v[152:155], v[64:79]
  ds_read_b64_tr_b16 v[128:129], v14 offset:0
  ds_read_b64_tr_b16 v[130:131], v14 offset:1024
  s_waitcnt lgkmcnt(3)
  v_mfma_f32_32x32x16_bf16 v[96:111], v[148:151], v[152:155], v[96:111]
  ds_read_b128 v[136:139], v13 offset:0
  ds_read_b64_tr_b16 v[132:133], v15 offset:0
  s_waitcnt lgkmcnt(4)
  v_mfma_f32_32x32x16_bf16 v[80:95], v[144:147], v[156:159], v[80:95]
  ds_read_b64_tr_b16 v[134:135], v15 offset:1024
  ds_read_b128 v[140:143], v13 offset:512
  v_mfma_f32_32x32x16_bf16 v[112:127], v[148:151], v[156:159], v[112:127]
  s_waitcnt lgkmcnt(3)
  v_mfma_f32_32x32x16_bf16 v[64:79], v[128:131], v[136:139], v[64:79]
  ds_read_b64_tr_b16 v[144:145], v14 offset:4096
  ds_read_b64_tr_b16 v[146:147], v14 offset:5120
  s_waitcnt lgkmcnt(3)
  v_mfma_f32_32x32x16_bf16 v[96:111], v[132:135], v[136:139], v[96:111]
  ds_read_b128 v[152:155], v13 offset:4096
  ds_read_b64_tr_b16 v[148:149], v15 offset:4096
  s_waitcnt lgkmcnt(4)
  v_mfma_f32_32x32x16_bf16 v[80:95], v[128:131], v[140:143], v[80:95]
  ds_read_b64_tr_b16 v[150:151], v15 offset:5120
  ds_read_b128 v[156:159], v13 offset:4608
  v_mfma_f32_32x32x16_bf16 v[112:127], v[132:135], v[140:143], v[112:127]
  s_waitcnt lgkmcnt(3)
  v_mfma_f32_32x32x16_bf16 v[64:79], v[144:147], v[152:155], v[64:79]
  ds_read_b64_tr_b16 v[128:129], v14 offset:8192
  ds_read_b64_tr_b16 v[130:131], v14 offset:9216
  s_waitcnt lgkmcnt(3)
  v_mfma_f32_32x32x16_bf16 v[96:111], v[148:151], v[152:155], v[96:111]
  ds_read_b128 v[136:139], v13 offset:8192
  ds_read_b64_tr_b16 v[132:133], v15 offset:8192
  s_waitcnt lgkmcnt(4)
  v_mfma_f32_32x32x16_bf16 v[80:95], v[144:147], v[156:159], v[80:95]
  ds_read_b64_tr_b16 v[134:135], v15 offset:9216
  ds_read_b128 v[140:143], v13 offset:8704
  v_mfma_f32_32x32x16_bf16 v[112:127], v[148:151], v[156:159], v[112:127]
  s_waitcnt lgkmcnt(3)
  v_mfma_f32_32x32x16_bf16 v[64:79], v[128:131], v[136:139], v[64:79]
  ds_read_b64_tr_b16 v[144:145], v14 offset:12288
  ds_read_b64_tr_b16 v[146:147], v14 offset:13312
  s_waitcnt lgkmcnt(3)
  v_mfma_f32_32x32x16_bf16 v[96:111], v[132:135], v[136:139], v[96:111]
  ds_read_b128 v[152:155], v13 offset:12288
  ds_read_b64_tr_b16 v[148:149], v15 offset:12288
  s_waitcnt lgkmcnt(4)
  v_mfma_f32_32x32x16_bf16 v[80:95], v[128:131], v[140:143], v[80:95]
  ds_read_b64_tr_b16 v[150:151], v15 offset:13312
  ds_read_b128 v[156:159], v13 offset:12800
  v_mfma_f32_32x32x16_bf16 v[112:127], v[132:135], v[140:143], v[112:127]
  s_barrier
  s_waitcnt lgkmcnt(3)
  v_mfma_f32_32x32x16_bf16 v[64:79], v[144:147], v[152:155], v[64:79]
  ds_read_b64_tr_b16 v[128:129], v14 offset:32768
  ds_read_b64_tr_b16 v[130:131], v14 offset:33792
  s_waitcnt lgkmcnt(3)
  v_mfma_f32_32x32x16_bf16 v[96:111], v[148:151], v[152:155], v[96:111]
  ds_read_b128 v[136:139], v13 offset:32768
  ds_read_b64_tr_b16 v[132:133], v15 offset:32768
  s_waitcnt lgkmcnt(4)
  v_mfma_f32_32x32x16_bf16 v[80:95], v[144:147], v[156:159], v[80:95]
  ds_read_b64_tr_b16 v[134:135], v15 offset:33792
  ds_read_b128 v[140:143], v13 offset:33280
  v_mfma_f32_32x32x16_bf16 v[112:127], v[148:151], v[156:159], v[112:127]
  s_waitcnt lgkmcnt(3)
  v_mfma_f32_32x32x16_bf16 v[64:79], v[128:131], v[136:139], v[64:79]
  ds_read_b64_tr_b16 v[144:145], v14 offset:36864
  ds_read_b64_tr_b16 v[146:147], v14 offset:37888
  s_waitcnt lgkmcnt(3)
  v_mfma_f32_32x32x16_bf16 v[96:111], v[132:135], v[136:139], v[96:111]
  ds_read_b128 v[152:155], v13 offset:36864
  ds_read_b64_tr_b16 v[148:149], v15 offset:36864
  s_waitcnt lgkmcnt(4)
  v_mfma_f32_32x32x16_bf16 v[80:95], v[128:131], v[140:143], v[80:95]
  ds_read_b64_tr_b16 v[150:151], v15 offset:37888
  ds_read_b128 v[156:159], v13 offset:37376
  v_mfma_f32_32x32x16_bf16 v[112:127], v[132:135], v[140:143], v[112:127]
  s_waitcnt lgkmcnt(3)
  v_mfma_f32_32x32x16_bf16 v[64:79], v[144:147], v[152:155], v[64:79]
  ds_read_b64_tr_b16 v[128:129], v14 offset:40960
  ds_read_b64_tr_b16 v[130:131], v14 offset:41984
  s_waitcnt lgkmcnt(3)
  v_mfma_f32_32x32x16_bf16 v[96:111], v[148:151], v[152:155], v[96:111]
  ds_read_b128 v[136:139], v13 offset:40960
  ds_read_b64_tr_b16 v[132:133], v15 offset:40960
  s_waitcnt lgkmcnt(4)
  v_mfma_f32_32x32x16_bf16 v[80:95], v[144:147], v[156:159], v[80:95]
  ds_read_b64_tr_b16 v[134:135], v15 offset:41984
  ds_read_b128 v[140:143], v13 offset:41472
  v_mfma_f32_32x32x16_bf16 v[112:127], v[148:151], v[156:159], v[112:127]
  s_waitcnt lgkmcnt(3)
  v_mfma_f32_32x32x16_bf16 v[64:79], v[128:131], v[136:139], v[64:79]
  ds_read_b64_tr_b16 v[144:145], v14 offset:45056
  ds_read_b64_tr_b16 v[146:147], v14 offset:46080
  s_waitcnt lgkmcnt(3)
  v_mfma_f32_32x32x16_bf16 v[96:111], v[132:135], v[136:139], v[96:111]
  ds_read_b128 v[152:155], v13 offset:45056
  ds_read_b64_tr_b16 v[148:149], v15 offset:45056
  s_waitcnt lgkmcnt(4)
  v_mfma_f32_32x32x16_bf16 v[80:95], v[128:131], v[140:143], v[80:95]
  ds_read_b64_tr_b16 v[150:151], v15 offset:46080
  ds_read_b128 v[156:159], v13 offset:45568
  v_mfma_f32_32x32x16_bf16 v[112:127], v[132:135], v[140:143], v[112:127]
  s_barrier
  s_waitcnt lgkmcnt(3)
  v_mfma_f32_32x32x16_bf16 v[64:79], v[144:147], v[152:155], v[64:79]
  ds_read_b64_tr_b16 v[128:129], v57 offset:0
  ds_read_b64_tr_b16 v[130:131], v57 offset:1024
  s_waitcnt lgkmcnt(3)
  v_mfma_f32_32x32x16_bf16 v[96:111], v[148:151], v[152:155], v[96:111]
  ds_read_b128 v[136:139], v56 offset:0
  ds_read_b64_tr_b16 v[132:133], v62 offset:0
  s_waitcnt lgkmcnt(4)
  v_mfma_f32_32x32x16_bf16 v[80:95], v[144:147], v[156:159], v[80:95]
  ds_read_b64_tr_b16 v[134:135], v62 offset:1024
  ds_read_b128 v[140:143], v56 offset:512
  v_mfma_f32_32x32x16_bf16 v[112:127], v[148:151], v[156:159], v[112:127]
  s_waitcnt lgkmcnt(3)
  v_mfma_f32_32x32x16_bf16 v[64:79], v[128:131], v[136:139], v[64:79]
  ds_read_b64_tr_b16 v[144:145], v57 offset:4096
  ds_read_b64_tr_b16 v[146:147], v57 offset:5120
  s_waitcnt lgkmcnt(3)
  v_mfma_f32_32x32x16_bf16 v[96:111], v[132:135], v[136:139], v[96:111]
  ds_read_b128 v[152:155], v56 offset:4096
  ds_read_b64_tr_b16 v[148:149], v62 offset:4096
  s_waitcnt lgkmcnt(4)
  v_mfma_f32_32x32x16_bf16 v[80:95], v[128:131], v[140:143], v[80:95]
  ds_read_b64_tr_b16 v[150:151], v62 offset:5120
  ds_read_b128 v[156:159], v56 offset:4608
  v_mfma_f32_32x32x16_bf16 v[112:127], v[132:135], v[140:143], v[112:127]
  s_waitcnt lgkmcnt(3)
  v_mfma_f32_32x32x16_bf16 v[64:79], v[144:147], v[152:155], v[64:79]
  ds_read_b64_tr_b16 v[128:129], v57 offset:8192
  ds_read_b64_tr_b16 v[130:131], v57 offset:9216
  s_waitcnt lgkmcnt(3)
  v_mfma_f32_32x32x16_bf16 v[96:111], v[148:151], v[152:155], v[96:111]
  ds_read_b128 v[136:139], v56 offset:8192
  ds_read_b64_tr_b16 v[132:133], v62 offset:8192
  s_waitcnt lgkmcnt(4)
  v_mfma_f32_32x32x16_bf16 v[80:95], v[144:147], v[156:159], v[80:95]
  ds_read_b64_tr_b16 v[134:135], v62 offset:9216
  ds_read_b128 v[140:143], v56 offset:8704
  v_mfma_f32_32x32x16_bf16 v[112:127], v[148:151], v[156:159], v[112:127]
  s_waitcnt lgkmcnt(3)
  v_mfma_f32_32x32x16_bf16 v[64:79], v[128:131], v[136:139], v[64:79]
  ds_read_b64_tr_b16 v[144:145], v57 offset:12288
  ds_read_b64_tr_b16 v[146:147], v57 offset:13312
  s_waitcnt lgkmcnt(3)
  v_mfma_f32_32x32x16_bf16 v[96:111], v[132:135], v[136:139], v[96:111]
  ds_read_b128 v[152:155], v56 offset:12288
  ds_read_b64_tr_b16 v[148:149], v62 offset:12288
  s_waitcnt lgkmcnt(4)
  v_mfma_f32_32x32x16_bf16 v[80:95], v[128:131], v[140:143], v[80:95]
  ds_read_b64_tr_b16 v[150:151], v62 offset:13312
  ds_read_b128 v[156:159], v56 offset:12800
  v_mfma_f32_32x32x16_bf16 v[112:127], v[132:135], v[140:143], v[112:127]
  s_waitcnt lgkmcnt(3)
  v_mfma_f32_32x32x16_bf16 v[64:79], v[144:147], v[152:155], v[64:79]
  s_waitcnt lgkmcnt(1)
  v_mfma_f32_32x32x16_bf16 v[96:111], v[148:151], v[152:155], v[96:111]
  s_waitcnt lgkmcnt(0)
  v_mfma_f32_32x32x16_bf16 v[80:95], v[144:147], v[156:159], v[80:95]
  v_mfma_f32_32x32x16_bf16 v[112:127], v[148:151], v[156:159], v[112:127]
  s_cmp_eq_u32 s25, 13
  s_cselect_b32 s34, s30, 0
  s_cmp_eq_u32 s34, 1
  s_cbranch_scc1 main_w168_fin
  s_waitcnt vmcnt(0)
  v_pk_add_f32 v[208:209], v[208:209], v[212:213]
  v_pk_add_f32 v[210:211], v[210:211], v[214:215]
  v_pk_add_f32 v[208:209], v[208:209], v[216:217]
  v_pk_add_f32 v[210:211], v[210:211], v[218:219]
  v_pk_add_f32 v[208:209], v[208:209], v[220:221]
  v_pk_add_f32 v[210:211], v[210:211], v[222:223]
  v_pk_add_f32 v[208:209], v[208:209], v[224:225]
  v_pk_add_f32 v[210:211], v[210:211], v[226:227]
  v_mov_b32 v20, v208
  s_nop 1
  v_permlane32_swap_b32 v208, v20
  s_nop 1
  v_add_f32 v208, v208, v20
  v_mov_b32 v20, v209
  s_nop 1
  v_permlane32_swap_b32 v209, v20
  s_nop 1
  v_add_f32 v209, v209, v20
  v_mov_b32 v20, v210
  s_nop 1
  v_permlane32_swap_b32 v210, v20
  s_nop 1
  v_add_f32 v210, v210, v20
  v_mov_b32 v20, v211
  s_nop 1
  v_permlane32_swap_b32 v211, v20
  s_nop 1
  v_add_f32 v211, v211, v20
  s_mov_b32 s35, 0x3acccccd
  s_mov_b32 s36, 0x3727c5ac
  v_mul_f32 v22, s35, v208
  v_mul_f32 v20, s35, v209
  v_fma_f32 v20, -v22, v22, v20
  v_add_f32 v20, s36, v20
  v_rsq_f32 v24, v20
  s_nop 0
  v_mul_f32 v26, s35, v210
  v_mul_f32 v20, s35, v211
  v_fma_f32 v20, -v26, v26, v20
  v_add_f32 v20, s36, v20
  v_rsq_f32 v28, v20
  s_nop 0
  v_lshlrev_b32 v224, 16, v192
  v_and_b32 v225, 0xffff0000, v192
  v_lshlrev_b32 v226, 16, v193
  v_and_b32 v227, 0xffff0000, v193
  v_lshlrev_b32 v228, 16, v194
  v_and_b32 v229, 0xffff0000, v194
  v_lshlrev_b32 v230, 16, v195
  v_and_b32 v231, 0xffff0000, v195
  v_lshlrev_b32 v232, 16, v196
  v_and_b32 v233, 0xffff0000, v196
  v_lshlrev_b32 v234, 16, v197
  v_and_b32 v235, 0xffff0000, v197
  v_lshlrev_b32 v236, 16, v198
  v_and_b32 v237, 0xffff0000, v198
  v_lshlrev_b32 v238, 16, v199
  v_and_b32 v239, 0xffff0000, v199
  v_lshlrev_b32 v240, 16, v200
  v_and_b32 v241, 0xffff0000, v200
  v_lshlrev_b32 v242, 16, v201
  v_and_b32 v243, 0xffff0000, v201
  v_lshlrev_b32 v244, 16, v202
  v_and_b32 v245, 0xffff0000, v202
  v_lshlrev_b32 v246, 16, v203
  v_and_b32 v247, 0xffff0000, v203
  v_lshlrev_b32 v248, 16, v204
  v_and_b32 v249, 0xffff0000, v204
  v_lshlrev_b32 v250, 16, v205
  v_and_b32 v251, 0xffff0000, v205
  v_lshlrev_b32 v252, 16, v206
  v_and_b32 v253, 0xffff0000, v206
  v_lshlrev_b32 v254, 16, v207
  v_and_b32 v255, 0xffff0000, v207
  v_lshlrev_b32 v30, 15, v3
  v_lshlrev_b32 v31, 4, v5
  v_add_u32 v30, v30, v31
  s_lshr_b32 s37, s33, 3
  s_lshl_b32 s37, s37, 15
  s_add_u32 s37, s37, s5
  s_add_u32 s37, s37, 10485760
  v_pk_fma_f32 v[64:65], v[22:23], v[160:161], v[64:65] op_sel_hi:[0,1,1] neg_lo:[1,0,0] neg_hi:[1,0,0]
  v_pk_fma_f32 v[66:67], v[22:23], v[162:163], v[66:67] op_sel_hi:[0,1,1] neg_lo:[1,0,0] neg_hi:[1,0,0]
  v_pk_fma_f32 v[68:69], v[22:23], v[164:165], v[68:69] op_sel_hi:[0,1,1] neg_lo:[1,0,0] neg_hi:[1,0,0]
  v_pk_fma_f32 v[70:71], v[22:23], v[166:167], v[70:71] op_sel_hi:[0,1,1] neg_lo:[1,0,0] neg_hi:[1,0,0]
  v_pk_fma_f32 v[64:65], v[24:25], v[64:65], v[224:225] op_sel_hi:[0,1,1]
  v_pk_fma_f32 v[66:67], v[24:25], v[66:67], v[226:227] op_sel_hi:[0,1,1]
  v_pk_fma_f32 v[68:69], v[24:25], v[68:69], v[228:229] op_sel_hi:[0,1,1]
  v_pk_fma_f32 v[70:71], v[24:25], v[70:71], v[230:231] op_sel_hi:[0,1,1]
  v_max_f32 v64, 0, v64
  v_max_f32 v65, 0, v65
  v_max_f32 v66, 0, v66
  v_max_f32 v67, 0, v67
  v_max_f32 v68, 0, v68
  v_max_f32 v69, 0, v69
  v_max_f32 v70, 0, v70
  v_max_f32 v71, 0, v71
  v_pk_mul_f32 v[64:65], v[64:65], v[64:65]
  v_pk_mul_f32 v[66:67], v[66:67], v[66:67]
  v_pk_mul_f32 v[68:69], v[68:69], v[68:69]
  v_pk_mul_f32 v[70:71], v[70:71], v[70:71]
  v_cvt_pk_bf16_f32 v32, v64, v65
  v_cvt_pk_bf16_f32 v33, v66, v67
  v_cvt_pk_bf16_f32 v34, v68, v69
  v_cvt_pk_bf16_f32 v35, v70, v71
  s_nop 1
  v_permlane32_swap_b32 v32, v34
  v_permlane32_swap_b32 v33, v35
  s_nop 0
  buffer_store_dwordx4 v[32:35], v30, s[8:11], s37 offen offset:0 sc1
  v_pk_fma_f32 v[80:81], v[26:27], v[160:161], v[80:81] op_sel_hi:[0,1,1] neg_lo:[1,0,0] neg_hi:[1,0,0]
  v_pk_fma_f32 v[82:83], v[26:27], v[162:163], v[82:83] op_sel_hi:[0,1,1] neg_lo:[1,0,0] neg_hi:[1,0,0]
  v_pk_fma_f32 v[84:85], v[26:27], v[164:165], v[84:85] op_sel_hi:[0,1,1] neg_lo:[1,0,0] neg_hi:[1,0,0]
  v_pk_fma_f32 v[86:87], v[26:27], v[166:167], v[86:87] op_sel_hi:[0,1,1] neg_lo:[1,0,0] neg_hi:[1,0,0]
  v_pk_fma_f32 v[80:81], v[28:29], v[80:81], v[224:225] op_sel_hi:[0,1,1]
  v_pk_fma_f32 v[82:83], v[28:29], v[82:83], v[226:227] op_sel_hi:[0,1,1]
  v_pk_fma_f32 v[84:85], v[28:29], v[84:85], v[228:229] op_sel_hi:[0,1,1]
  v_pk_fma_f32 v[86:87], v[28:29], v[86:87], v[230:231] op_sel_hi:[0,1,1]
  v_max_f32 v80, 0, v80
  v_max_f32 v81, 0, v81
  v_max_f32 v82, 0, v82
  v_max_f32 v83, 0, v83
  v_max_f32 v84, 0, v84
  v_max_f32 v85, 0, v85
  v_max_f32 v86, 0, v86
  v_max_f32 v87, 0, v87
  v_pk_mul_f32 v[80:81], v[80:81], v[80:81]
  v_pk_mul_f32 v[82:83], v[82:83], v[82:83]
  v_pk_mul_f32 v[84:85], v[84:85], v[84:85]
  v_pk_mul_f32 v[86:87], v[86:87], v[86:87]
  v_cvt_pk_bf16_f32 v36, v80, v81
  v_cvt_pk_bf16_f32 v37, v82, v83
  v_cvt_pk_bf16_f32 v38, v84, v85
  v_cvt_pk_bf16_f32 v39, v86, v87
  s_nop 1
  v_permlane32_swap_b32 v36, v38
  v_permlane32_swap_b32 v37, v39
  s_nop 0
  buffer_store_dwordx4 v[36:39], v30, s[8:11], s37 offen offset:512 sc1
  s_add_u32 s37, s37, 65536
  v_pk_fma_f32 v[72:73], v[22:23], v[168:169], v[72:73] op_sel_hi:[0,1,1] neg_lo:[1,0,0] neg_hi:[1,0,0]
  v_pk_fma_f32 v[74:75], v[22:23], v[170:171], v[74:75] op_sel_hi:[0,1,1] neg_lo:[1,0,0] neg_hi:[1,0,0]
  v_pk_fma_f32 v[76:77], v[22:23], v[172:173], v[76:77] op_sel_hi:[0,1,1] neg_lo:[1,0,0] neg_hi:[1,0,0]
  v_pk_fma_f32 v[78:79], v[22:23], v[174:175], v[78:79] op_sel_hi:[0,1,1] neg_lo:[1,0,0] neg_hi:[1,0,0]
  v_pk_fma_f32 v[72:73], v[24:25], v[72:73], v[232:233] op_sel_hi:[0,1,1]
  v_pk_fma_f32 v[74:75], v[24:25], v[74:75], v[234:235] op_sel_hi:[0,1,1]
  v_pk_fma_f32 v[76:77], v[24:25], v[76:77], v[236:237] op_sel_hi:[0,1,1]
  v_pk_fma_f32 v[78:79], v[24:25], v[78:79], v[238:239] op_sel_hi:[0,1,1]
  v_max_f32 v72, 0, v72
  v_max_f32 v73, 0, v73
  v_max_f32 v74, 0, v74
  v_max_f32 v75, 0, v75
  v_max_f32 v76, 0, v76
  v_max_f32 v77, 0, v77
  v_max_f32 v78, 0, v78
  v_max_f32 v79, 0, v79
  v_pk_mul_f32 v[72:73], v[72:73], v[72:73]
  v_pk_mul_f32 v[74:75], v[74:75], v[74:75]
  v_pk_mul_f32 v[76:77], v[76:77], v[76:77]
  v_pk_mul_f32 v[78:79], v[78:79], v[78:79]
  v_cvt_pk_bf16_f32 v40, v72, v73
  v_cvt_pk_bf16_f32 v41, v74, v75
  v_cvt_pk_bf16_f32 v42, v76, v77
  v_cvt_pk_bf16_f32 v43, v78, v79
  s_nop 1
  v_permlane32_swap_b32 v40, v42
  v_permlane32_swap_b32 v41, v43
  s_nop 0
  buffer_store_dwordx4 v[40:43], v30, s[8:11], s37 offen offset:0 sc1
  v_pk_fma_f32 v[88:89], v[26:27], v[168:169], v[88:89] op_sel_hi:[0,1,1] neg_lo:[1,0,0] neg_hi:[1,0,0]
  v_pk_fma_f32 v[90:91], v[26:27], v[170:171], v[90:91] op_sel_hi:[0,1,1] neg_lo:[1,0,0] neg_hi:[1,0,0]
  v_pk_fma_f32 v[92:93], v[26:27], v[172:173], v[92:93] op_sel_hi:[0,1,1] neg_lo:[1,0,0] neg_hi:[1,0,0]
  v_pk_fma_f32 v[94:95], v[26:27], v[174:175], v[94:95] op_sel_hi:[0,1,1] neg_lo:[1,0,0] neg_hi:[1,0,0]
  v_pk_fma_f32 v[88:89], v[28:29], v[88:89], v[232:233] op_sel_hi:[0,1,1]
  v_pk_fma_f32 v[90:91], v[28:29], v[90:91], v[234:235] op_sel_hi:[0,1,1]
  v_pk_fma_f32 v[92:93], v[28:29], v[92:93], v[236:237] op_sel_hi:[0,1,1]
  v_pk_fma_f32 v[94:95], v[28:29], v[94:95], v[238:239] op_sel_hi:[0,1,1]
  v_max_f32 v88, 0, v88
  v_max_f32 v89, 0, v89
  v_max_f32 v90, 0, v90
  v_max_f32 v91, 0, v91
  v_max_f32 v92, 0, v92
  v_max_f32 v93, 0, v93
  v_max_f32 v94, 0, v94
  v_max_f32 v95, 0, v95
  v_pk_mul_f32 v[88:89], v[88:89], v[88:89]
  v_pk_mul_f32 v[90:91], v[90:91], v[90:91]
  v_pk_mul_f32 v[92:93], v[92:93], v[92:93]
  v_pk_mul_f32 v[94:95], v[94:95], v[94:95]
  v_cvt_pk_bf16_f32 v44, v88, v89
  v_cvt_pk_bf16_f32 v45, v90, v91
  v_cvt_pk_bf16_f32 v46, v92, v93
  v_cvt_pk_bf16_f32 v47, v94, v95
  s_nop 1
  v_permlane32_swap_b32 v44, v46
  v_permlane32_swap_b32 v45, v47
  s_nop 0
  buffer_store_dwordx4 v[44:47], v30, s[8:11], s37 offen offset:512 sc1
  s_add_u32 s37, s37, 65536
  v_pk_fma_f32 v[96:97], v[22:23], v[176:177], v[96:97] op_sel_hi:[0,1,1] neg_lo:[1,0,0] neg_hi:[1,0,0]
  v_pk_fma_f32 v[98:99], v[22:23], v[178:179], v[98:99] op_sel_hi:[0,1,1] neg_lo:[1,0,0] neg_hi:[1,0,0]
  v_pk_fma_f32 v[100:101], v[22:23], v[180:181], v[100:101] op_sel_hi:[0,1,1] neg_lo:[1,0,0] neg_hi:[1,0,0]
  v_pk_fma_f32 v[102:103], v[22:23], v[182:183], v[102:103] op_sel_hi:[0,1,1] neg_lo:[1,0,0] neg_hi:[1,0,0]
  v_pk_fma_f32 v[96:97], v[24:25], v[96:97], v[240:241] op_sel_hi:[0,1,1]
  v_pk_fma_f32 v[98:99], v[24:25], v[98:99], v[242:243] op_sel_hi:[0,1,1]
  v_pk_fma_f32 v[100:101], v[24:25], v[100:101], v[244:245] op_sel_hi:[0,1,1]
  v_pk_fma_f32 v[102:103], v[24:25], v[102:103], v[246:247] op_sel_hi:[0,1,1]
  v_max_f32 v96, 0, v96
  v_max_f32 v97, 0, v97
  v_max_f32 v98, 0, v98
  v_max_f32 v99, 0, v99
  v_max_f32 v100, 0, v100
  v_max_f32 v101, 0, v101
  v_max_f32 v102, 0, v102
  v_max_f32 v103, 0, v103
  v_pk_mul_f32 v[96:97], v[96:97], v[96:97]
  v_pk_mul_f32 v[98:99], v[98:99], v[98:99]
  v_pk_mul_f32 v[100:101], v[100:101], v[100:101]
  v_pk_mul_f32 v[102:103], v[102:103], v[102:103]
  v_cvt_pk_bf16_f32 v32, v96, v97
  v_cvt_pk_bf16_f32 v33, v98, v99
  v_cvt_pk_bf16_f32 v34, v100, v101
  v_cvt_pk_bf16_f32 v35, v102, v103
  s_nop 1
  v_permlane32_swap_b32 v32, v34
  v_permlane32_swap_b32 v33, v35
  s_nop 0
  buffer_store_dwordx4 v[32:35], v30, s[8:11], s37 offen offset:0 sc1
  v_pk_fma_f32 v[112:113], v[26:27], v[176:177], v[112:113] op_sel_hi:[0,1,1] neg_lo:[1,0,0] neg_hi:[1,0,0]
  v_pk_fma_f32 v[114:115], v[26:27], v[178:179], v[114:115] op_sel_hi:[0,1,1] neg_lo:[1,0,0] neg_hi:[1,0,0]
  v_pk_fma_f32 v[116:117], v[26:27], v[180:181], v[116:117] op_sel_hi:[0,1,1] neg_lo:[1,0,0] neg_hi:[1,0,0]
  v_pk_fma_f32 v[118:119], v[26:27], v[182:183], v[118:119] op_sel_hi:[0,1,1] neg_lo:[1,0,0] neg_hi:[1,0,0]
  v_pk_fma_f32 v[112:113], v[28:29], v[112:113], v[240:241] op_sel_hi:[0,1,1]
  v_pk_fma_f32 v[114:115], v[28:29], v[114:115], v[242:243] op_sel_hi:[0,1,1]
  v_pk_fma_f32 v[116:117], v[28:29], v[116:117], v[244:245] op_sel_hi:[0,1,1]
  v_pk_fma_f32 v[118:119], v[28:29], v[118:119], v[246:247] op_sel_hi:[0,1,1]
  v_max_f32 v112, 0, v112
  v_max_f32 v113, 0, v113
  v_max_f32 v114, 0, v114
  v_max_f32 v115, 0, v115
  v_max_f32 v116, 0, v116
  v_max_f32 v117, 0, v117
  v_max_f32 v118, 0, v118
  v_max_f32 v119, 0, v119
  v_pk_mul_f32 v[112:113], v[112:113], v[112:113]
  v_pk_mul_f32 v[114:115], v[114:115], v[114:115]
  v_pk_mul_f32 v[116:117], v[116:117], v[116:117]
  v_pk_mul_f32 v[118:119], v[118:119], v[118:119]
  v_cvt_pk_bf16_f32 v36, v112, v113
  v_cvt_pk_bf16_f32 v37, v114, v115
  v_cvt_pk_bf16_f32 v38, v116, v117
  v_cvt_pk_bf16_f32 v39, v118, v119
  s_nop 1
  v_permlane32_swap_b32 v36, v38
  v_permlane32_swap_b32 v37, v39
  s_nop 0
  buffer_store_dwordx4 v[36:39], v30, s[8:11], s37 offen offset:512 sc1
  s_add_u32 s37, s37, 65536
  v_pk_fma_f32 v[104:105], v[22:23], v[184:185], v[104:105] op_sel_hi:[0,1,1] neg_lo:[1,0,0] neg_hi:[1,0,0]
  v_pk_fma_f32 v[106:107], v[22:23], v[186:187], v[106:107] op_sel_hi:[0,1,1] neg_lo:[1,0,0] neg_hi:[1,0,0]
  v_pk_fma_f32 v[108:109], v[22:23], v[188:189], v[108:109] op_sel_hi:[0,1,1] neg_lo:[1,0,0] neg_hi:[1,0,0]
  v_pk_fma_f32 v[110:111], v[22:23], v[190:191], v[110:111] op_sel_hi:[0,1,1] neg_lo:[1,0,0] neg_hi:[1,0,0]
  v_pk_fma_f32 v[104:105], v[24:25], v[104:105], v[248:249] op_sel_hi:[0,1,1]
  v_pk_fma_f32 v[106:107], v[24:25], v[106:107], v[250:251] op_sel_hi:[0,1,1]
  v_pk_fma_f32 v[108:109], v[24:25], v[108:109], v[252:253] op_sel_hi:[0,1,1]
  v_pk_fma_f32 v[110:111], v[24:25], v[110:111], v[254:255] op_sel_hi:[0,1,1]
  v_max_f32 v104, 0, v104
  v_max_f32 v105, 0, v105
  v_max_f32 v106, 0, v106
  v_max_f32 v107, 0, v107
  v_max_f32 v108, 0, v108
  v_max_f32 v109, 0, v109
  v_max_f32 v110, 0, v110
  v_max_f32 v111, 0, v111
  v_pk_mul_f32 v[104:105], v[104:105], v[104:105]
  v_pk_mul_f32 v[106:107], v[106:107], v[106:107]
  v_pk_mul_f32 v[108:109], v[108:109], v[108:109]
  v_pk_mul_f32 v[110:111], v[110:111], v[110:111]
  v_cvt_pk_bf16_f32 v40, v104, v105
  v_cvt_pk_bf16_f32 v41, v106, v107
  v_cvt_pk_bf16_f32 v42, v108, v109
  v_cvt_pk_bf16_f32 v43, v110, v111
  s_nop 1
  v_permlane32_swap_b32 v40, v42
  v_permlane32_swap_b32 v41, v43
  s_nop 0
  buffer_store_dwordx4 v[40:43], v30, s[8:11], s37 offen offset:0 sc1
  v_pk_fma_f32 v[120:121], v[26:27], v[184:185], v[120:121] op_sel_hi:[0,1,1] neg_lo:[1,0,0] neg_hi:[1,0,0]
  v_pk_fma_f32 v[122:123], v[26:27], v[186:187], v[122:123] op_sel_hi:[0,1,1] neg_lo:[1,0,0] neg_hi:[1,0,0]
  v_pk_fma_f32 v[124:125], v[26:27], v[188:189], v[124:125] op_sel_hi:[0,1,1] neg_lo:[1,0,0] neg_hi:[1,0,0]
  v_pk_fma_f32 v[126:127], v[26:27], v[190:191], v[126:127] op_sel_hi:[0,1,1] neg_lo:[1,0,0] neg_hi:[1,0,0]
  v_pk_fma_f32 v[120:121], v[28:29], v[120:121], v[248:249] op_sel_hi:[0,1,1]
  v_pk_fma_f32 v[122:123], v[28:29], v[122:123], v[250:251] op_sel_hi:[0,1,1]
  v_pk_fma_f32 v[124:125], v[28:29], v[124:125], v[252:253] op_sel_hi:[0,1,1]
  v_pk_fma_f32 v[126:127], v[28:29], v[126:127], v[254:255] op_sel_hi:[0,1,1]
  v_max_f32 v120, 0, v120
  v_max_f32 v121, 0, v121
  v_max_f32 v122, 0, v122
  v_max_f32 v123, 0, v123
  v_max_f32 v124, 0, v124
  v_max_f32 v125, 0, v125
  v_max_f32 v126, 0, v126
  v_max_f32 v127, 0, v127
  v_pk_mul_f32 v[120:121], v[120:121], v[120:121]
  v_pk_mul_f32 v[122:123], v[122:123], v[122:123]
  v_pk_mul_f32 v[124:125], v[124:125], v[124:125]
  v_pk_mul_f32 v[126:127], v[126:127], v[126:127]
  v_cvt_pk_bf16_f32 v44, v120, v121
  v_cvt_pk_bf16_f32 v45, v122, v123
  v_cvt_pk_bf16_f32 v46, v124, v125
  v_cvt_pk_bf16_f32 v47, v126, v127
  s_nop 1
  v_permlane32_swap_b32 v44, v46
  v_permlane32_swap_b32 v45, v47
  s_nop 0
  buffer_store_dwordx4 v[44:47], v30, s[8:11], s37 offen offset:512 sc1
  s_add_u32 s37, s37, 65536
main_w168_fin:
  s_waitcnt vmcnt(0)
main_w168_fin2:
  s_barrier
  s_cmp_eq_u32 s3, 0
  s_cbranch_scc0 main_ar74
  s_mul_i32 s46, s24, 128
  s_add_u32 s46, s46, s5
  s_add_u32 s46, s46, 24190976
  v_and_b32 v60, 63, v0
  v_lshlrev_b32 v60, 14, v60
  v_mov_b32 v61, 1
  s_mov_b64 s[44:45], exec
  s_mov_b64 exec, 255
  buffer_atomic_add v61, v60, s[8:11], s46 offen sc1
  s_mov_b64 exec, s[44:45]
main_ar74:
main_w168_end:
  s_and_b32 s24, s2, 7
  s_lshr_b32 s25, s2, 3
  s_cmp_ge_u32 s25, 28
  s_cbranch_scc1 main_w275_end
  v_and_b32 v1, 63, v0
  s_mov_b32 s28, s3
  s_mul_i32 s26, s24, 28
  s_add_u32 s26, s26, s25
  s_cmp_ge_u32 s26, 220
  s_cbranch_scc1 main_w275_end
  s_mul_i32 s24, s26, 6554
  s_lshr_b32 s24, s24, 16
  s_mul_i32 s25, s24, 10
  s_sub_u32 s25, s26, s25
  s_mul_i32 s42, s24, 3
  s_add_u32 s43, s42, 2
  s_lshr_b32 s42, s42, 2
  s_lshr_b32 s43, s43, 2
  s_min_u32 s43, s43, 15
  s_cmp_ge_u32 s28, 4
  s_cbranch_scc0 main_w275_cons
  s_sub_u32 s28, s28, 4
  s_mul_i32 s29, s28, 192
  s_mul_i32 s30, s24, 96
  s_mov_b32 s31, 683
  s_mov_b32 s32, 96
  s_cmp_eq_u32 s24, 21
  s_cselect_b32 s38, 31, 127
  v_add_u32 v3, s29, v1
  v_add_u32 v3, 0, v3
  v_mul_lo_u32 v4, v3, s31
  v_lshrrev_b32 v4, 16, v4
  v_mul_lo_u32 v5, v4, s32
  v_sub_u32 v5, v3, v5
  v_and_b32 v5, s38, v5
  v_add_u32 v5, s30, v5
  v_lshlrev_b32 v5, 4, v5
  v_lshlrev_b32 v4, 15, v4
  v_add_u32 v5, v5, v4
  v_subrev_u32 v8, 0, v5
  v_add_u32 v3, s29, v1
  v_add_u32 v3, 64, v3
  v_mul_lo_u32 v4, v3, s31
  v_lshrrev_b32 v4, 16, v4
  v_mul_lo_u32 v5, v4, s32
  v_sub_u32 v5, v3, v5
  v_and_b32 v5, s38, v5
  v_add_u32 v5, s30, v5
  v_lshlrev_b32 v5, 4, v5
  v_lshlrev_b32 v4, 15, v4
  v_add_u32 v5, v5, v4
  v_subrev_u32 v9, 1024, v5
  v_add_u32 v3, s29, v1
  v_add_u32 v3, 128, v3
  v_mul_lo_u32 v4, v3, s31
  v_lshrrev_b32 v4, 16, v4
  v_mul_lo_u32 v5, v4, s32
  v_sub_u32 v5, v3, v5
  v_and_b32 v5, s38, v5
  v_add_u32 v5, s30, v5
  v_lshlrev_b32 v5, 4, v5
  v_lshlrev_b32 v4, 15, v4
  v_add_u32 v5, v5, v4
  v_subrev_u32 v10, 2048, v5
  v_lshrrev_b32 v3, 3, v1
  s_lshl_b32 s31, s28, 4
  v_add_u32 v3, s31, v3
  s_mov_b32 s32, 1280
  v_mul_lo_u32 v3, v3, s32
  v_and_b32 v4, 7, v1
  v_lshrrev_b32 v5, 4, v1
  v_and_b32 v5, 1, v5
  v_lshlrev_b32 v5, 2, v5
  v_xor_b32 v4, v4, v5
  v_lshlrev_b32 v4, 4, v4
  v_add_u32 v3, v3, v4
  s_lshl_b32 s31, s25, 7
  v_add_u32 v11, s31, v3
  v_add_u32 v12, 9216, v11
  s_mul_i32 s33, s28, 3072
  s_lshl_b32 s36, s28, 11
  s_add_u32 s36, s36, 12288
  s_add_u32 s34, s5, 10485760
  s_mov_b32 s35, 0
  s_add_u32 m0, s36, 0
  s_nop 0
  buffer_load_dwordx4 v11, s[84:87], s35 offen offset:0 lds
  buffer_load_dwordx4 v12, s[84:87], s35 offen offset:1024 lds
  s_add_u32 s35, s35, 81920
  s_add_u32 m0, s36, 20480
  s_nop 0
  buffer_load_dwordx4 v11, s[84:87], s35 offen offset:0 lds
  buffer_load_dwordx4 v12, s[84:87], s35 offen offset:1024 lds
  s_add_u32 s35, s35, 81920
  s_add_u32 m0, s36, 40960
  s_nop 0
  buffer_load_dwordx4 v11, s[84:87], s35 offen offset:0 lds
  buffer_load_dwordx4 v12, s[84:87], s35 offen offset:1024 lds
  s_add_u32 s35, s35, 81920
  s_add_u32 m0, s36, 61440
  s_nop 0
  buffer_load_dwordx4 v11, s[84:87], s35 offen offset:0 lds
  buffer_load_dwordx4 v12, s[84:87], s35 offen offset:1024 lds
  s_add_u32 s35, s35, 81920
  s_add_u32 m0, s36, 81920
  s_nop 0
  buffer_load_dwordx4 v11, s[84:87], s35 offen offset:0 lds
  buffer_load_dwordx4 v12, s[84:87], s35 offen offset:1024 lds
  s_add_u32 s35, s35, 81920
  s_cmp_eq_u32 s3, 0
  s_cbranch_scc0 main_pw76
  v_and_b32 v60, 63, v0
  v_add_u32 v60, s42, v60
  v_min_u32 v60, s43, v60
  v_mul_u32_u24 v60, 128, v60
  s_add_u32 s46, s5, 24190976
  s_mov_b32 s47, 0
  s_and_b32 s45, s2, 7
  s_lshl_b32 s45, s45, 14
  s_add_u32 s46, s46, s45
  buffer_load_dword v252, v60, s[8:11], s46 offen sc1
main_pl77:
  s_waitcnt vmcnt(0)
  v_cmp_gt_u32 vcc, 14, v252
  s_cbranch_vccz main_pw76
  s_sleep 2
  buffer_load_dword v252, v60, s[8:11], s46 offen sc1
  s_add_u32 s47, s47, 1
  s_cmp_ge_u32 s47, 131072
  s_cbranch_scc0 main_pl77
main_pw76:
  s_barrier
  s_add_u32 m0, s33, 0
  s_nop 0
  buffer_load_dwordx4 v8, s[8:11], s34 offen offset:0 lds
  buffer_load_dwordx4 v9, s[8:11], s34 offen offset:1024 lds
  buffer_load_dwordx4 v10, s[8:11], s34 offen offset:2048 lds
  s_add_u32 s34, s34, 262144
  s_add_u32 m0, s33, 20480
  s_nop 0
  buffer_load_dwordx4 v8, s[8:11], s34 offen offset:0 lds
  buffer_load_dwordx4 v9, s[8:11], s34 offen offset:1024 lds
  buffer_load_dwordx4 v10, s[8:11], s34 offen offset:2048 lds
  s_add_u32 s34, s34, 262144
  s_add_u32 m0, s33, 40960
  s_nop 0
  buffer_load_dwordx4 v8, s[8:11], s34 offen offset:0 lds
  buffer_load_dwordx4 v9, s[8:11], s34 offen offset:1024 lds
  buffer_load_dwordx4 v10, s[8:11], s34 offen offset:2048 lds
  s_add_u32 s34, s34, 262144
  s_add_u32 m0, s33, 61440
  s_nop 0
  buffer_load_dwordx4 v8, s[8:11], s34 offen offset:0 lds
  buffer_load_dwordx4 v9, s[8:11], s34 offen offset:1024 lds
  buffer_load_dwordx4 v10, s[8:11], s34 offen offset:2048 lds
  s_add_u32 s34, s34, 262144
  s_add_u32 m0, s33, 81920
  s_nop 0
  buffer_load_dwordx4 v8, s[8:11], s34 offen offset:0 lds
  buffer_load_dwordx4 v9, s[8:11], s34 offen offset:1024 lds
  buffer_load_dwordx4 v10, s[8:11], s34 offen offset:2048 lds
  s_add_u32 s34, s34, 262144
  s_waitcnt vmcnt(12)
  s_barrier
  s_add_u32 m0, s33, 102400
  s_nop 0
  buffer_load_dwordx4 v8, s[8:11], s34 offen offset:0 lds
  buffer_load_dwordx4 v9, s[8:11], s34 offen offset:1024 lds
  buffer_load_dwordx4 v10, s[8:11], s34 offen offset:2048 lds
  s_add_u32 s34, s34, 262144
  s_add_u32 m0, s36, 102400
  s_nop 0
  buffer_load_dwordx4 v11, s[84:87], s35 offen offset:0 lds
  buffer_load_dwordx4 v12, s[84:87], s35 offen offset:1024 lds
  s_add_u32 s35, s35, 81920
  s_waitcnt vmcnt(14)
  s_barrier
  s_add_u32 m0, s33, 122880
  s_nop 0
  buffer_load_dwordx4 v8, s[8:11], s34 offen offset:0 lds
  buffer_load_dwordx4 v9, s[8:11], s34 offen offset:1024 lds
  buffer_load_dwordx4 v10, s[8:11], s34 offen offset:2048 lds
  s_add_u32 s34, s34, 262144
  s_add_u32 m0, s36, 122880
  s_nop 0
  buffer_load_dwordx4 v11, s[84:87], s35 offen offset:0 lds
  buffer_load_dwordx4 v12, s[84:87], s35 offen offset:1024 lds
  s_add_u32 s35, s35, 81920
  s_waitcnt vmcnt(16)
  s_barrier
  s_add_u32 m0, s33, 0
  s_nop 0
  buffer_load_dwordx4 v8, s[8:11], s34 offen offset:0 lds
  buffer_load_dwordx4 v9, s[8:11], s34 offen offset:1024 lds
  buffer_load_dwordx4 v10, s[8:11], s34 offen offset:2048 lds
  s_add_u32 s34, s34, 262144
  s_add_u32 m0, s36, 0
  s_nop 0
  buffer_load_dwordx4 v11, s[84:87], s35 offen offset:0 lds
  buffer_load_dwordx4 v12, s[84:87], s35 offen offset:1024 lds
  s_add_u32 s35, s35, 81920
  s_waitcnt vmcnt(18)
  s_barrier
  s_add_u32 m0, s33, 20480
  s_nop 0
  buffer_load_dwordx4 v8, s[8:11], s34 offen offset:0 lds
  buffer_load_dwordx4 v9, s[8:11], s34 offen offset:1024 lds
  buffer_load_dwordx4 v10, s[8:11], s34 offen offset:2048 lds
  s_add_u32 s34, s34, 262144
  s_add_u32 m0, s36, 20480
  s_nop 0
  buffer_load_dwordx4 v11, s[84:87], s35 offen offset:0 lds
  buffer_load_dwordx4 v12, s[84:87], s35 offen offset:1024 lds
  s_add_u32 s35, s35, 81920
  s_waitcnt vmcnt(20)
  s_barrier
  s_add_u32 m0, s33, 40960
  s_nop 0
  buffer_load_dwordx4 v8, s[8:11], s34 offen offset:0 lds
  buffer_load_dwordx4 v9, s[8:11], s34 offen offset:1024 lds
  buffer_load_dwordx4 v10, s[8:11], s34 offen offset:2048 lds
  s_add_u32 s34, s34, 262144
  s_add_u32 m0, s36, 40960
  s_nop 0
  buffer_load_dwordx4 v11, s[84:87], s35 offen offset:0 lds
  buffer_load_dwordx4 v12, s[84:87], s35 offen offset:1024 lds
  s_add_u32 s35, s35, 81920
  s_waitcnt vmcnt(20)
  s_barrier
  s_add_u32 m0, s33, 61440
  s_nop 0
  buffer_load_dwordx4 v8, s[8:11], s34 offen offset:0 lds
  buffer_load_dwordx4 v9, s[8:11], s34 offen offset:1024 lds
  buffer_load_dwordx4 v10, s[8:11], s34 offen offset:2048 lds
  s_add_u32 s34, s34, 262144
  s_add_u32 m0, s36, 61440
  s_nop 0
  buffer_load_dwordx4 v11, s[84:87], s35 offen offset:0 lds
  buffer_load_dwordx4 v12, s[84:87], s35 offen offset:1024 lds
  s_add_u32 s35, s35, 81920
  s_waitcnt vmcnt(20)
  s_barrier
  s_add_u32 m0, s33, 81920
  s_nop 0
  buffer_load_dwordx4 v8, s[8:11], s34 offen offset:0 lds
  buffer_load_dwordx4 v9, s[8:11], s34 offen offset:1024 lds
  buffer_load_dwordx4 v10, s[8:11], s34 offen offset:2048 lds
  s_add_u32 s34, s34, 262144
  s_add_u32 m0, s36, 81920
  s_nop 0
  buffer_load_dwordx4 v11, s[84:87], s35 offen offset:0 lds
  buffer_load_dwordx4 v12, s[84:87], s35 offen offset:1024 lds
  s_add_u32 s35, s35, 81920
  s_waitcnt vmcnt(20)
  s_barrier
  s_add_u32 m0, s33, 102400
  s_nop 0
  buffer_load_dwordx4 v8, s[8:11], s34 offen offset:0 lds
  buffer_load_dwordx4 v9, s[8:11], s34 offen offset:1024 lds
  buffer_load_dwordx4 v10, s[8:11], s34 offen offset:2048 lds
  s_add_u32 s34, s34, 262144
  s_add_u32 m0, s36, 102400
  s_nop 0
  buffer_load_dwordx4 v11, s[84:87], s35 offen offset:0 lds
  buffer_load_dwordx4 v12, s[84:87], s35 offen offset:1024 lds
  s_add_u32 s35, s35, 81920
  s_waitcnt vmcnt(20)
  s_barrier
  s_add_u32 m0, s33, 122880
  s_nop 0
  buffer_load_dwordx4 v8, s[8:11], s34 offen offset:0 lds
  buffer_load_dwordx4 v9, s[8:11], s34 offen offset:1024 lds
  buffer_load_dwordx4 v10, s[8:11], s34 offen offset:2048 lds
  s_add_u32 s34, s34, 262144
  s_add_u32 m0, s36, 122880
  s_nop 0
  buffer_load_dwordx4 v11, s[84:87], s35 offen offset:0 lds
  buffer_load_dwordx4 v12, s[84:87], s35 offen offset:1024 lds
  s_add_u32 s35, s35, 81920
  s_waitcnt vmcnt(20)
  s_barrier
  s_add_u32 m0, s33, 0
  s_nop 0
  buffer_load_dwordx4 v8, s[8:11], s34 offen offset:0 lds
  buffer_load_dwordx4 v9, s[8:11], s34 offen offset:1024 lds
  buffer_load_dwordx4 v10, s[8:11], s34 offen offset:2048 lds
  s_add_u32 s34, s34, 262144
  s_add_u32 m0, s36, 0
  s_nop 0
  buffer_load_dwordx4 v11, s[84:87], s35 offen offset:0 lds
  buffer_load_dwordx4 v12, s[84:87], s35 offen offset:1024 lds
  s_add_u32 s35, s35, 81920
  s_waitcnt vmcnt(20)
  s_barrier
  s_add_u32 m0, s33, 20480
  s_nop 0
  buffer_load_dwordx4 v8, s[8:11], s34 offen offset:0 lds
  buffer_load_dwordx4 v9, s[8:11], s34 offen offset:1024 lds
  buffer_load_dwordx4 v10, s[8:11], s34 offen offset:2048 lds
  s_add_u32 s34, s34, 262144
  s_add_u32 m0, s36, 20480
  s_nop 0
  buffer_load_dwordx4 v11, s[84:87], s35 offen offset:0 lds
  buffer_load_dwordx4 v12, s[84:87], s35 offen offset:1024 lds
  s_add_u32 s35, s35, 81920
  s_waitcnt vmcnt(20)
  s_barrier
  s_add_u32 m0, s33, 40960
  s_nop 0
  buffer_load_dwordx4 v8, s[8:11], s34 offen offset:0 lds
  buffer_load_dwordx4 v9, s[8:11], s34 offen offset:1024 lds
  buffer_load_dwordx4 v10, s[8:11], s34 offen offset:2048 lds
  s_add_u32 s34, s34, 262144
  s_add_u32 m0, s36, 40960
  s_nop 0
  buffer_load_dwordx4 v11, s[84:87], s35 offen offset:0 lds
  buffer_load_dwordx4 v12, s[84:87], s35 offen offset:1024 lds
  s_add_u32 s35, s35, 81920
  s_waitcnt vmcnt(20)
  s_barrier
  s_add_u32 m0, s33, 61440
  s_nop 0
  buffer_load_dwordx4 v8, s[8:11], s34 offen offset:0 lds
  buffer_load_dwordx4 v9, s[8:11], s34 offen offset:1024 lds
  buffer_load_dwordx4 v10, s[8:11], s34 offen offset:2048 lds
  s_add_u32 s34, s34, 262144
  s_add_u32 m0, s36, 61440
  s_nop 0
  buffer_load_dwordx4 v11, s[84:87], s35 offen offset:0 lds
  buffer_load_dwordx4 v12, s[84:87], s35 offen offset:1024 lds
  s_add_u32 s35, s35, 81920
  s_waitcnt vmcnt(20)
  s_barrier
  s_add_u32 m0, s33, 81920
  s_nop 0
  buffer_load_dwordx4 v8, s[8:11], s34 offen offset:0 lds
  buffer_load_dwordx4 v9, s[8:11], s34 offen offset:1024 lds
  buffer_load_dwordx4 v10, s[8:11], s34 offen offset:2048 lds
  s_add_u32 s34, s34, 262144
  s_add_u32 m0, s36, 81920
  s_nop 0
  buffer_load_dwordx4 v11, s[84:87], s35 offen offset:0 lds
  buffer_load_dwordx4 v12, s[84:87], s35 offen offset:1024 lds
  s_add_u32 s35, s35, 81920
  s_waitcnt vmcnt(20)
  s_barrier
  s_add_u32 m0, s33, 102400
  s_nop 0
  buffer_load_dwordx4 v8, s[8:11], s34 offen offset:0 lds
  buffer_load_dwordx4 v9, s[8:11], s34 offen offset:1024 lds
  buffer_load_dwordx4 v10, s[8:11], s34 offen offset:2048 lds
  s_add_u32 s34, s34, 262144
  s_add_u32 m0, s36, 102400
  s_nop 0
  buffer_load_dwordx4 v11, s[84:87], s35 offen offset:0 lds
  buffer_load_dwordx4 v12, s[84:87], s35 offen offset:1024 lds
  s_add_u32 s35, s35, 81920
  s_waitcnt vmcnt(20)
  s_barrier
  s_add_u32 m0, s33, 122880
  s_nop 0
  buffer_load_dwordx4 v8, s[8:11], s34 offen offset:0 lds
  buffer_load_dwordx4 v9, s[8:11], s34 offen offset:1024 lds
  buffer_load_dwordx4 v10, s[8:11], s34 offen offset:2048 lds
  s_add_u32 s34, s34, 262144
  s_add_u32 m0, s36, 122880
  s_nop 0
  buffer_load_dwordx4 v11, s[84:87], s35 offen offset:0 lds
  buffer_load_dwordx4 v12, s[84:87], s35 offen offset:1024 lds
  s_add_u32 s35, s35, 81920
  s_waitcnt vmcnt(20)
  s_barrier
  s_add_u32 m0, s33, 0
  s_nop 0
  buffer_load_dwordx4 v8, s[8:11], s34 offen offset:0 lds
  buffer_load_dwordx4 v9, s[8:11], s34 offen offset:1024 lds
  buffer_load_dwordx4 v10, s[8:11], s34 offen offset:2048 lds
  s_add_u32 s34, s34, 262144
  s_add_u32 m0, s36, 0
  s_nop 0
  buffer_load_dwordx4 v11, s[84:87], s35 offen offset:0 lds
  buffer_load_dwordx4 v12, s[84:87], s35 offen offset:1024 lds
  s_add_u32 s35, s35, 81920
  s_waitcnt vmcnt(20)
  s_barrier
  s_add_u32 m0, s33, 20480
  s_nop 0
  buffer_load_dwordx4 v8, s[8:11], s34 offen offset:0 lds
  buffer_load_dwordx4 v9, s[8:11], s34 offen offset:1024 lds
  buffer_load_dwordx4 v10, s[8:11], s34 offen offset:2048 lds
  s_add_u32 s34, s34, 262144
  s_add_u32 m0, s36, 20480
  s_nop 0
  buffer_load_dwordx4 v11, s[84:87], s35 offen offset:0 lds
  buffer_load_dwordx4 v12, s[84:87], s35 offen offset:1024 lds
  s_add_u32 s35, s35, 81920
  s_waitcnt vmcnt(20)
  s_barrier
  s_add_u32 m0, s33, 40960
  s_nop 0
  buffer_load_dwordx4 v8, s[8:11], s34 offen offset:0 lds
  buffer_load_dwordx4 v9, s[8:11], s34 offen offset:1024 lds
  buffer_load_dwordx4 v10, s[8:11], s34 offen offset:2048 lds
  s_add_u32 s34, s34, 262144
  s_add_u32 m0, s36, 40960
  s_nop 0
  buffer_load_dwordx4 v11, s[84:87], s35 offen offset:0 lds
  buffer_load_dwordx4 v12, s[84:87], s35 offen offset:1024 lds
  s_add_u32 s35, s35, 81920
  s_waitcnt vmcnt(20)
  s_barrier
  s_add_u32 m0, s33, 61440
  s_nop 0
  buffer_load_dwordx4 v8, s[8:11], s34 offen offset:0 lds
  buffer_load_dwordx4 v9, s[8:11], s34 offen offset:1024 lds
  buffer_load_dwordx4 v10, s[8:11], s34 offen offset:2048 lds
  s_add_u32 s34, s34, 262144
  s_add_u32 m0, s36, 61440
  s_nop 0
  buffer_load_dwordx4 v11, s[84:87], s35 offen offset:0 lds
  buffer_load_dwordx4 v12, s[84:87], s35 offen offset:1024 lds
  s_add_u32 s35, s35, 81920
  s_waitcnt vmcnt(20)
  s_barrier
  s_add_u32 m0, s33, 81920
  s_nop 0
  buffer_load_dwordx4 v8, s[8:11], s34 offen offset:0 lds
  buffer_load_dwordx4 v9, s[8:11], s34 offen offset:1024 lds
  buffer_load_dwordx4 v10, s[8:11], s34 offen offset:2048 lds
  s_add_u32 s34, s34, 262144
  s_add_u32 m0, s36, 81920
  s_nop 0
  buffer_load_dwordx4 v11, s[84:87], s35 offen offset:0 lds
  buffer_load_dwordx4 v12, s[84:87], s35 offen offset:1024 lds
  s_add_u32 s35, s35, 81920
  s_waitcnt vmcnt(20)
  s_barrier
  s_add_u32 m0, s33, 102400
  s_nop 0
  buffer_load_dwordx4 v8, s[8:11], s34 offen offset:0 lds
  buffer_load_dwordx4 v9, s[8:11], s34 offen offset:1024 lds
  buffer_load_dwordx4 v10, s[8:11], s34 offen offset:2048 lds
  s_add_u32 s34, s34, 262144
  s_add_u32 m0, s36, 102400
  s_nop 0
  buffer_load_dwordx4 v11, s[84:87], s35 offen offset:0 lds
  buffer_load_dwordx4 v12, s[84:87], s35 offen offset:1024 lds
  s_add_u32 s35, s35, 81920
  s_waitcnt vmcnt(20)
  s_barrier
  s_waitcnt vmcnt(15)
  s_barrier
  s_waitcnt vmcnt(10)
  s_barrier
  s_waitcnt vmcnt(5)
  s_barrier
  s_waitcnt vmcnt(0)
  s_barrier
  s_cmp_eq_u32 s5, 0
  s_cbranch_scc0 main_w275_fin
  s_branch main_w275_fin2
main_w275_cons:
  s_cmp_eq_u32 s28, 3
  s_cbranch_scc0 main_w275_c3
  s_barrier
  s_barrier
  s_barrier
  s_barrier
  s_barrier
  s_barrier
  s_barrier
  s_barrier
  s_barrier
  s_barrier
  s_barrier
  s_barrier
  s_barrier
  s_barrier
  s_barrier
  s_barrier
  s_barrier
  s_barrier
  s_barrier
  s_barrier
  s_barrier
  s_barrier
  s_barrier
  s_barrier
  s_barrier
  s_barrier
  s_barrier
  s_barrier
  s_branch main_w275_fin
main_w275_c3:
  v_lshrrev_b32 v3, 5, v1
  v_and_b32 v4, 31, v1
  s_mul_i32 s31, s24, 96
  s_lshl_b32 s32, s28, 5
  s_add_u32 s31, s31, s32
  v_add_u32 v5, s31, v4
  v_lshlrev_b32 v6, 4, v5
  v_lshlrev_b32 v7, 3, v3
  v_add_u32 v6, v6, v7
  s_lshl_b32 s33, s25, 18
  s_add_u32 s33, s33, s5
  s_add_u32 s33, s33, 17563648
  s_mov_b32 s39, 32768
  s_cmp_ge_u32 s31, 2048
  s_cselect_b32 s37, 1, 0
  v_lshlrev_b32 v7, 3, v3
  s_lshl_b32 s34, s25, 7
  v_add_u32 v7, s34, v7
  buffer_load_dwordx2 v[112:113], v7, s[92:95], 0 offen offset:0
  buffer_load_dwordx2 v[114:115], v7, s[92:95], 0 offen offset:16
  buffer_load_dwordx2 v[116:117], v7, s[92:95], 0 offen offset:32
  buffer_load_dwordx2 v[118:119], v7, s[92:95], 0 offen offset:48
  buffer_load_dwordx2 v[120:121], v7, s[92:95], 0 offen offset:64
  buffer_load_dwordx2 v[122:123], v7, s[92:95], 0 offen offset:80
  buffer_load_dwordx2 v[124:125], v7, s[92:95], 0 offen offset:96
  buffer_load_dwordx2 v[126:127], v7, s[92:95], 0 offen offset:112
  v_mul_u32_u24 v8, 1536, v3
  s_lshl_b32 s34, s28, 5
  v_add_u32 v9, s34, v4
  v_lshlrev_b32 v9, 4, v9
  v_add_u32 v8, v8, v9
  v_lshrrev_b32 v14, 2, v1
  v_and_b32 v14, 3, v14
  v_lshlrev_b32 v15, 3, v3
  v_add_u32 v15, v15, v14
  v_lshlrev_b32 v15, 7, v15
  v_lshrrev_b32 v14, 1, v14
  v_lshlrev_b32 v14, 2, v14
  v_lshrrev_b32 v9, 4, v1
  v_and_b32 v9, 1, v9
  v_lshlrev_b32 v9, 1, v9
  v_add_u32 v14, v14, v9
  v_lshrrev_b32 v9, 1, v1
  v_and_b32 v9, 1, v9
  v_add_u32 v14, v14, v9
  v_lshlrev_b32 v14, 4, v14
  v_and_b32 v9, 1, v1
  v_lshlrev_b32 v9, 3, v9
  v_add_u32 v14, v14, v9
  v_add_u32 v9, v15, v14
  v_add_u32 v9, 12288, v9
  v_xor_b32 v10, 64, v9
  v_add_u32 v11, 61440, v8
  v_add_u32 v12, 61440, v9
  v_add_u32 v13, 61440, v10
  v_add_u32 v32, 122880, v8
  v_add_u32 v33, 122880, v9
  v_add_u32 v34, 122880, v10
  s_cmp_eq_u32 s3, 0
  s_cbranch_scc0 main_pw78
  v_and_b32 v60, 63, v0
  v_add_u32 v60, s42, v60
  v_min_u32 v60, s43, v60
  v_mul_u32_u24 v60, 128, v60
  s_add_u32 s46, s5, 24190976
  s_mov_b32 s47, 0
  s_and_b32 s45, s2, 7
  s_lshl_b32 s45, s45, 14
  s_add_u32 s46, s46, s45
  buffer_load_dword v252, v60, s[8:11], s46 offen sc1
main_pl79:
  s_waitcnt vmcnt(0)
  v_cmp_gt_u32 vcc, 14, v252
  s_cbranch_vccz main_pw78
  s_sleep 2
  buffer_load_dword v252, v60, s[8:11], s46 offen sc1
  s_add_u32 s47, s47, 1
  s_cmp_ge_u32 s47, 131072
  s_cbranch_scc0 main_pl79
main_pw78:
  s_barrier
  s_cmp_eq_u32 s37, 1
  s_cbranch_scc1 main_w275_nr
  buffer_load_dwordx2 v[16:17], v6, s[8:11], s33 offen
  s_add_u32 s33, s33, s39
  buffer_load_dwordx2 v[18:19], v6, s[8:11], s33 offen
  s_add_u32 s33, s33, s39
  buffer_load_dwordx2 v[20:21], v6, s[8:11], s33 offen
  s_add_u32 s33, s33, s39
  buffer_load_dwordx2 v[22:23], v6, s[8:11], s33 offen
  s_add_u32 s33, s33, s39
  buffer_load_dwordx2 v[24:25], v6, s[8:11], s33 offen
  s_add_u32 s33, s33, s39
  buffer_load_dwordx2 v[26:27], v6, s[8:11], s33 offen
  s_add_u32 s33, s33, s39
  buffer_load_dwordx2 v[28:29], v6, s[8:11], s33 offen
  s_add_u32 s33, s33, s39
  buffer_load_dwordx2 v[30:31], v6, s[8:11], s33 offen
  s_add_u32 s33, s33, s39
main_w275_nr:
  s_barrier
  ds_read_b64_tr_b16 v[64:65], v9 offset:0
  ds_read_b64_tr_b16 v[66:67], v9 offset:512
  ds_read_b128 v[72:75], v8 offset:0
  ds_read_b64_tr_b16 v[68:69], v10 offset:0
  ds_read_b64_tr_b16 v[70:71], v10 offset:512
  ds_read_b64_tr_b16 v[76:77], v9 offset:2048
  ds_read_b64_tr_b16 v[78:79], v9 offset:2560
  ds_read_b128 v[84:87], v8 offset:3072
  ds_read_b64_tr_b16 v[80:81], v10 offset:2048
  ds_read_b64_tr_b16 v[82:83], v10 offset:2560
  s_waitcnt lgkmcnt(7)
  v_mfma_f32_32x32x16_bf16 v[128:143], v[64:67], v[72:75], 0
  ds_read_b64_tr_b16 v[88:89], v9 offset:4096
  ds_read_b64_tr_b16 v[90:91], v9 offset:4608
  ds_read_b128 v[96:99], v8 offset:6144
  s_waitcnt lgkmcnt(8)
  v_mfma_f32_32x32x16_bf16 v[144:159], v[68:71], v[72:75], 0
  ds_read_b64_tr_b16 v[92:93], v10 offset:4096
  ds_read_b64_tr_b16 v[94:95], v10 offset:4608
  ds_read_b64_tr_b16 v[100:101], v9 offset:6144
  s_waitcnt lgkmcnt(8)
  v_mfma_f32_32x32x16_bf16 v[128:143], v[76:79], v[84:87], v[128:143]
  ds_read_b64_tr_b16 v[102:103], v9 offset:6656
  ds_read_b128 v[108:111], v8 offset:9216
  ds_read_b64_tr_b16 v[104:105], v10 offset:6144
  s_waitcnt lgkmcnt(9)
  v_mfma_f32_32x32x16_bf16 v[144:159], v[80:83], v[84:87], v[144:159]
  ds_read_b64_tr_b16 v[106:107], v10 offset:6656
  s_barrier
  s_waitcnt lgkmcnt(7)
  v_mfma_f32_32x32x16_bf16 v[128:143], v[88:91], v[96:99], v[128:143]
  ds_read_b64_tr_b16 v[64:65], v9 offset:20480
  ds_read_b64_tr_b16 v[66:67], v9 offset:20992
  ds_read_b128 v[72:75], v8 offset:20480
  s_waitcnt lgkmcnt(8)
  v_mfma_f32_32x32x16_bf16 v[144:159], v[92:95], v[96:99], v[144:159]
  ds_read_b64_tr_b16 v[68:69], v10 offset:20480
  ds_read_b64_tr_b16 v[70:71], v10 offset:20992
  ds_read_b64_tr_b16 v[76:77], v9 offset:22528
  s_waitcnt lgkmcnt(8)
  v_mfma_f32_32x32x16_bf16 v[128:143], v[100:103], v[108:111], v[128:143]
  ds_read_b64_tr_b16 v[78:79], v9 offset:23040
  ds_read_b128 v[84:87], v8 offset:23552
  ds_read_b64_tr_b16 v[80:81], v10 offset:22528
  s_waitcnt lgkmcnt(9)
  v_mfma_f32_32x32x16_bf16 v[144:159], v[104:107], v[108:111], v[144:159]
  ds_read_b64_tr_b16 v[82:83], v10 offset:23040
  s_waitcnt lgkmcnt(7)
  v_mfma_f32_32x32x16_bf16 v[128:143], v[64:67], v[72:75], v[128:143]
  ds_read_b64_tr_b16 v[88:89], v9 offset:24576
  ds_read_b64_tr_b16 v[90:91], v9 offset:25088
  ds_read_b128 v[96:99], v8 offset:26624
  s_waitcnt lgkmcnt(8)
  v_mfma_f32_32x32x16_bf16 v[144:159], v[68:71], v[72:75], v[144:159]
  ds_read_b64_tr_b16 v[92:93], v10 offset:24576
  ds_read_b64_tr_b16 v[94:95], v10 offset:25088
  ds_read_b64_tr_b16 v[100:101], v9 offset:26624
  s_waitcnt lgkmcnt(8)
  v_mfma_f32_32x32x16_bf16 v[128:143], v[76:79], v[84:87], v[128:143]
  ds_read_b64_tr_b16 v[102:103], v9 offset:27136
  ds_read_b128 v[108:111], v8 offset:29696
  ds_read_b64_tr_b16 v[104:105], v10 offset:26624
  s_waitcnt lgkmcnt(9)
  v_mfma_f32_32x32x16_bf16 v[144:159], v[80:83], v[84:87], v[144:159]
  ds_read_b64_tr_b16 v[106:107], v10 offset:27136
  s_barrier
  s_waitcnt lgkmcnt(7)
  v_mfma_f32_32x32x16_bf16 v[128:143], v[88:91], v[96:99], v[128:143]
  ds_read_b64_tr_b16 v[64:65], v9 offset:40960
  ds_read_b64_tr_b16 v[66:67], v9 offset:41472
  ds_read_b128 v[72:75], v8 offset:40960
  s_waitcnt lgkmcnt(8)
  v_mfma_f32_32x32x16_bf16 v[144:159], v[92:95], v[96:99], v[144:159]
  ds_read_b64_tr_b16 v[68:69], v10 offset:40960
  ds_read_b64_tr_b16 v[70:71], v10 offset:41472
  ds_read_b64_tr_b16 v[76:77], v9 offset:43008
  s_waitcnt lgkmcnt(8)
  v_mfma_f32_32x32x16_bf16 v[128:143], v[100:103], v[108:111], v[128:143]
  ds_read_b64_tr_b16 v[78:79], v9 offset:43520
  ds_read_b128 v[84:87], v8 offset:44032
  ds_read_b64_tr_b16 v[80:81], v10 offset:43008
  s_waitcnt lgkmcnt(9)
  v_mfma_f32_32x32x16_bf16 v[144:159], v[104:107], v[108:111], v[144:159]
  ds_read_b64_tr_b16 v[82:83], v10 offset:43520
  s_waitcnt lgkmcnt(7)
  v_mfma_f32_32x32x16_bf16 v[128:143], v[64:67], v[72:75], v[128:143]
  ds_read_b64_tr_b16 v[88:89], v9 offset:45056
  ds_read_b64_tr_b16 v[90:91], v9 offset:45568
  ds_read_b128 v[96:99], v8 offset:47104
  s_waitcnt lgkmcnt(8)
  v_mfma_f32_32x32x16_bf16 v[144:159], v[68:71], v[72:75], v[144:159]
  ds_read_b64_tr_b16 v[92:93], v10 offset:45056
  ds_read_b64_tr_b16 v[94:95], v10 offset:45568
  ds_read_b64_tr_b16 v[100:101], v9 offset:47104
  s_waitcnt lgkmcnt(8)
  v_mfma_f32_32x32x16_bf16 v[128:143], v[76:79], v[84:87], v[128:143]
  ds_read_b64_tr_b16 v[102:103], v9 offset:47616
  ds_read_b128 v[108:111], v8 offset:50176
  ds_read_b64_tr_b16 v[104:105], v10 offset:47104
  s_waitcnt lgkmcnt(9)
  v_mfma_f32_32x32x16_bf16 v[144:159], v[80:83], v[84:87], v[144:159]
  ds_read_b64_tr_b16 v[106:107], v10 offset:47616
  s_barrier
  s_waitcnt lgkmcnt(7)
  v_mfma_f32_32x32x16_bf16 v[128:143], v[88:91], v[96:99], v[128:143]
  ds_read_b64_tr_b16 v[64:65], v12 offset:0
  ds_read_b64_tr_b16 v[66:67], v12 offset:512
  ds_read_b128 v[72:75], v11 offset:0
  s_waitcnt lgkmcnt(8)
  v_mfma_f32_32x32x16_bf16 v[144:159], v[92:95], v[96:99], v[144:159]
  ds_read_b64_tr_b16 v[68:69], v13 offset:0
  ds_read_b64_tr_b16 v[70:71], v13 offset:512
  ds_read_b64_tr_b16 v[76:77], v12 offset:2048
  s_waitcnt lgkmcnt(8)
  v_mfma_f32_32x32x16_bf16 v[128:143], v[100:103], v[108:111], v[128:143]
  ds_read_b64_tr_b16 v[78:79], v12 offset:2560
  ds_read_b128 v[84:87], v11 offset:3072
  ds_read_b64_tr_b16 v[80:81], v13 offset:2048
  s_waitcnt lgkmcnt(9)
  v_mfma_f32_32x32x16_bf16 v[144:159], v[104:107], v[108:111], v[144:159]
  ds_read_b64_tr_b16 v[82:83], v13 offset:2560
  s_waitcnt lgkmcnt(7)
  v_mfma_f32_32x32x16_bf16 v[128:143], v[64:67], v[72:75], v[128:143]
  ds_read_b64_tr_b16 v[88:89], v12 offset:4096
  ds_read_b64_tr_b16 v[90:91], v12 offset:4608
  ds_read_b128 v[96:99], v11 offset:6144
  s_waitcnt lgkmcnt(8)
  v_mfma_f32_32x32x16_bf16 v[144:159], v[68:71], v[72:75], v[144:159]
  ds_read_b64_tr_b16 v[92:93], v13 offset:4096
  ds_read_b64_tr_b16 v[94:95], v13 offset:4608
  ds_read_b64_tr_b16 v[100:101], v12 offset:6144
  s_waitcnt lgkmcnt(8)
  v_mfma_f32_32x32x16_bf16 v[128:143], v[76:79], v[84:87], v[128:143]
  ds_read_b64_tr_b16 v[102:103], v12 offset:6656
  ds_read_b128 v[108:111], v11 offset:9216
  ds_read_b64_tr_b16 v[104:105], v13 offset:6144
  s_waitcnt lgkmcnt(9)
  v_mfma_f32_32x32x16_bf16 v[144:159], v[80:83], v[84:87], v[144:159]
  ds_read_b64_tr_b16 v[106:107], v13 offset:6656
  s_barrier
  s_waitcnt lgkmcnt(7)
  v_mfma_f32_32x32x16_bf16 v[128:143], v[88:91], v[96:99], v[128:143]
  ds_read_b64_tr_b16 v[64:65], v12 offset:20480
  ds_read_b64_tr_b16 v[66:67], v12 offset:20992
  ds_read_b128 v[72:75], v11 offset:20480
  s_waitcnt lgkmcnt(8)
  v_mfma_f32_32x32x16_bf16 v[144:159], v[92:95], v[96:99], v[144:159]
  ds_read_b64_tr_b16 v[68:69], v13 offset:20480
  ds_read_b64_tr_b16 v[70:71], v13 offset:20992
  ds_read_b64_tr_b16 v[76:77], v12 offset:22528
  s_waitcnt lgkmcnt(8)
  v_mfma_f32_32x32x16_bf16 v[128:143], v[100:103], v[108:111], v[128:143]
  ds_read_b64_tr_b16 v[78:79], v12 offset:23040
  ds_read_b128 v[84:87], v11 offset:23552
  ds_read_b64_tr_b16 v[80:81], v13 offset:22528
  s_waitcnt lgkmcnt(9)
  v_mfma_f32_32x32x16_bf16 v[144:159], v[104:107], v[108:111], v[144:159]
  ds_read_b64_tr_b16 v[82:83], v13 offset:23040
  s_waitcnt lgkmcnt(7)
  v_mfma_f32_32x32x16_bf16 v[128:143], v[64:67], v[72:75], v[128:143]
  ds_read_b64_tr_b16 v[88:89], v12 offset:24576
  ds_read_b64_tr_b16 v[90:91], v12 offset:25088
  ds_read_b128 v[96:99], v11 offset:26624
  s_waitcnt lgkmcnt(8)
  v_mfma_f32_32x32x16_bf16 v[144:159], v[68:71], v[72:75], v[144:159]
  ds_read_b64_tr_b16 v[92:93], v13 offset:24576
  ds_read_b64_tr_b16 v[94:95], v13 offset:25088
  ds_read_b64_tr_b16 v[100:101], v12 offset:26624
  s_waitcnt lgkmcnt(8)
  v_mfma_f32_32x32x16_bf16 v[128:143], v[76:79], v[84:87], v[128:143]
  ds_read_b64_tr_b16 v[102:103], v12 offset:27136
  ds_read_b128 v[108:111], v11 offset:29696
  ds_read_b64_tr_b16 v[104:105], v13 offset:26624
  s_waitcnt lgkmcnt(9)
  v_mfma_f32_32x32x16_bf16 v[144:159], v[80:83], v[84:87], v[144:159]
  ds_read_b64_tr_b16 v[106:107], v13 offset:27136
  s_barrier
  s_waitcnt lgkmcnt(7)
  v_mfma_f32_32x32x16_bf16 v[128:143], v[88:91], v[96:99], v[128:143]
  ds_read_b64_tr_b16 v[64:65], v12 offset:40960
  ds_read_b64_tr_b16 v[66:67], v12 offset:41472
  ds_read_b128 v[72:75], v11 offset:40960
  s_waitcnt lgkmcnt(8)
  v_mfma_f32_32x32x16_bf16 v[144:159], v[92:95], v[96:99], v[144:159]
  ds_read_b64_tr_b16 v[68:69], v13 offset:40960
  ds_read_b64_tr_b16 v[70:71], v13 offset:41472
  ds_read_b64_tr_b16 v[76:77], v12 offset:43008
  s_waitcnt lgkmcnt(8)
  v_mfma_f32_32x32x16_bf16 v[128:143], v[100:103], v[108:111], v[128:143]
  ds_read_b64_tr_b16 v[78:79], v12 offset:43520
  ds_read_b128 v[84:87], v11 offset:44032
  ds_read_b64_tr_b16 v[80:81], v13 offset:43008
  s_waitcnt lgkmcnt(9)
  v_mfma_f32_32x32x16_bf16 v[144:159], v[104:107], v[108:111], v[144:159]
  ds_read_b64_tr_b16 v[82:83], v13 offset:43520
  s_waitcnt lgkmcnt(7)
  v_mfma_f32_32x32x16_bf16 v[128:143], v[64:67], v[72:75], v[128:143]
  ds_read_b64_tr_b16 v[88:89], v12 offset:45056
  ds_read_b64_tr_b16 v[90:91], v12 offset:45568
  ds_read_b128 v[96:99], v11 offset:47104
  s_waitcnt lgkmcnt(8)
  v_mfma_f32_32x32x16_bf16 v[144:159], v[68:71], v[72:75], v[144:159]
  ds_read_b64_tr_b16 v[92:93], v13 offset:45056
  ds_read_b64_tr_b16 v[94:95], v13 offset:45568
  ds_read_b64_tr_b16 v[100:101], v12 offset:47104
  s_waitcnt lgkmcnt(8)
  v_mfma_f32_32x32x16_bf16 v[128:143], v[76:79], v[84:87], v[128:143]
  ds_read_b64_tr_b16 v[102:103], v12 offset:47616
  ds_read_b128 v[108:111], v11 offset:50176
  ds_read_b64_tr_b16 v[104:105], v13 offset:47104
  s_waitcnt lgkmcnt(9)
  v_mfma_f32_32x32x16_bf16 v[144:159], v[80:83], v[84:87], v[144:159]
  ds_read_b64_tr_b16 v[106:107], v13 offset:47616
  s_barrier
  s_waitcnt lgkmcnt(7)
  v_mfma_f32_32x32x16_bf16 v[128:143], v[88:91], v[96:99], v[128:143]
  ds_read_b64_tr_b16 v[64:65], v33 offset:0
  ds_read_b64_tr_b16 v[66:67], v33 offset:512
  ds_read_b128 v[72:75], v32 offset:0
  s_waitcnt lgkmcnt(8)
  v_mfma_f32_32x32x16_bf16 v[144:159], v[92:95], v[96:99], v[144:159]
  ds_read_b64_tr_b16 v[68:69], v34 offset:0
  ds_read_b64_tr_b16 v[70:71], v34 offset:512
  ds_read_b64_tr_b16 v[76:77], v33 offset:2048
  s_waitcnt lgkmcnt(8)
  v_mfma_f32_32x32x16_bf16 v[128:143], v[100:103], v[108:111], v[128:143]
  ds_read_b64_tr_b16 v[78:79], v33 offset:2560
  ds_read_b128 v[84:87], v32 offset:3072
  ds_read_b64_tr_b16 v[80:81], v34 offset:2048
  s_waitcnt lgkmcnt(9)
  v_mfma_f32_32x32x16_bf16 v[144:159], v[104:107], v[108:111], v[144:159]
  ds_read_b64_tr_b16 v[82:83], v34 offset:2560
  s_waitcnt lgkmcnt(7)
  v_mfma_f32_32x32x16_bf16 v[128:143], v[64:67], v[72:75], v[128:143]
  ds_read_b64_tr_b16 v[88:89], v33 offset:4096
  ds_read_b64_tr_b16 v[90:91], v33 offset:4608
  ds_read_b128 v[96:99], v32 offset:6144
  s_waitcnt lgkmcnt(8)
  v_mfma_f32_32x32x16_bf16 v[144:159], v[68:71], v[72:75], v[144:159]
  ds_read_b64_tr_b16 v[92:93], v34 offset:4096
  ds_read_b64_tr_b16 v[94:95], v34 offset:4608
  ds_read_b64_tr_b16 v[100:101], v33 offset:6144
  s_waitcnt lgkmcnt(8)
  v_mfma_f32_32x32x16_bf16 v[128:143], v[76:79], v[84:87], v[128:143]
  ds_read_b64_tr_b16 v[102:103], v33 offset:6656
  ds_read_b128 v[108:111], v32 offset:9216
  ds_read_b64_tr_b16 v[104:105], v34 offset:6144
  s_waitcnt lgkmcnt(9)
  v_mfma_f32_32x32x16_bf16 v[144:159], v[80:83], v[84:87], v[144:159]
  ds_read_b64_tr_b16 v[106:107], v34 offset:6656
  s_barrier
  s_waitcnt lgkmcnt(7)
  v_mfma_f32_32x32x16_bf16 v[128:143], v[88:91], v[96:99], v[128:143]
  ds_read_b64_tr_b16 v[64:65], v9 offset:0
  ds_read_b64_tr_b16 v[66:67], v9 offset:512
  ds_read_b128 v[72:75], v8 offset:0
  s_waitcnt lgkmcnt(8)
  v_mfma_f32_32x32x16_bf16 v[144:159], v[92:95], v[96:99], v[144:159]
  ds_read_b64_tr_b16 v[68:69], v10 offset:0
  ds_read_b64_tr_b16 v[70:71], v10 offset:512
  ds_read_b64_tr_b16 v[76:77], v9 offset:2048
  s_waitcnt lgkmcnt(8)
  v_mfma_f32_32x32x16_bf16 v[128:143], v[100:103], v[108:111], v[128:143]
  ds_read_b64_tr_b16 v[78:79], v9 offset:2560
  ds_read_b128 v[84:87], v8 offset:3072
  ds_read_b64_tr_b16 v[80:81], v10 offset:2048
  s_waitcnt lgkmcnt(9)
  v_mfma_f32_32x32x16_bf16 v[144:159], v[104:107], v[108:111], v[144:159]
  ds_read_b64_tr_b16 v[82:83], v10 offset:2560
  s_waitcnt lgkmcnt(7)
  v_mfma_f32_32x32x16_bf16 v[128:143], v[64:67], v[72:75], v[128:143]
  ds_read_b64_tr_b16 v[88:89], v9 offset:4096
  ds_read_b64_tr_b16 v[90:91], v9 offset:4608
  ds_read_b128 v[96:99], v8 offset:6144
  s_waitcnt lgkmcnt(8)
  v_mfma_f32_32x32x16_bf16 v[144:159], v[68:71], v[72:75], v[144:159]
  ds_read_b64_tr_b16 v[92:93], v10 offset:4096
  ds_read_b64_tr_b16 v[94:95], v10 offset:4608
  ds_read_b64_tr_b16 v[100:101], v9 offset:6144
  s_waitcnt lgkmcnt(8)
  v_mfma_f32_32x32x16_bf16 v[128:143], v[76:79], v[84:87], v[128:143]
  ds_read_b64_tr_b16 v[102:103], v9 offset:6656
  ds_read_b128 v[108:111], v8 offset:9216
  ds_read_b64_tr_b16 v[104:105], v10 offset:6144
  s_waitcnt lgkmcnt(9)
  v_mfma_f32_32x32x16_bf16 v[144:159], v[80:83], v[84:87], v[144:159]
  ds_read_b64_tr_b16 v[106:107], v10 offset:6656
  s_barrier
  s_waitcnt lgkmcnt(7)
  v_mfma_f32_32x32x16_bf16 v[128:143], v[88:91], v[96:99], v[128:143]
  ds_read_b64_tr_b16 v[64:65], v9 offset:20480
  ds_read_b64_tr_b16 v[66:67], v9 offset:20992
  ds_read_b128 v[72:75], v8 offset:20480
  s_waitcnt lgkmcnt(8)
  v_mfma_f32_32x32x16_bf16 v[144:159], v[92:95], v[96:99], v[144:159]
  ds_read_b64_tr_b16 v[68:69], v10 offset:20480
  ds_read_b64_tr_b16 v[70:71], v10 offset:20992
  ds_read_b64_tr_b16 v[76:77], v9 offset:22528
  s_waitcnt lgkmcnt(8)
  v_mfma_f32_32x32x16_bf16 v[128:143], v[100:103], v[108:111], v[128:143]
  ds_read_b64_tr_b16 v[78:79], v9 offset:23040
  ds_read_b128 v[84:87], v8 offset:23552
  ds_read_b64_tr_b16 v[80:81], v10 offset:22528
  s_waitcnt lgkmcnt(9)
  v_mfma_f32_32x32x16_bf16 v[144:159], v[104:107], v[108:111], v[144:159]
  ds_read_b64_tr_b16 v[82:83], v10 offset:23040
  s_waitcnt lgkmcnt(7)
  v_mfma_f32_32x32x16_bf16 v[128:143], v[64:67], v[72:75], v[128:143]
  ds_read_b64_tr_b16 v[88:89], v9 offset:24576
  ds_read_b64_tr_b16 v[90:91], v9 offset:25088
  ds_read_b128 v[96:99], v8 offset:26624
  s_waitcnt lgkmcnt(8)
  v_mfma_f32_32x32x16_bf16 v[144:159], v[68:71], v[72:75], v[144:159]
  ds_read_b64_tr_b16 v[92:93], v10 offset:24576
  ds_read_b64_tr_b16 v[94:95], v10 offset:25088
  ds_read_b64_tr_b16 v[100:101], v9 offset:26624
  s_waitcnt lgkmcnt(8)
  v_mfma_f32_32x32x16_bf16 v[128:143], v[76:79], v[84:87], v[128:143]
  ds_read_b64_tr_b16 v[102:103], v9 offset:27136
  ds_read_b128 v[108:111], v8 offset:29696
  ds_read_b64_tr_b16 v[104:105], v10 offset:26624
  s_waitcnt lgkmcnt(9)
  v_mfma_f32_32x32x16_bf16 v[144:159], v[80:83], v[84:87], v[144:159]
  ds_read_b64_tr_b16 v[106:107], v10 offset:27136
  s_barrier
  s_waitcnt lgkmcnt(7)
  v_mfma_f32_32x32x16_bf16 v[128:143], v[88:91], v[96:99], v[128:143]
  ds_read_b64_tr_b16 v[64:65], v9 offset:40960
  ds_read_b64_tr_b16 v[66:67], v9 offset:41472
  ds_read_b128 v[72:75], v8 offset:40960
  s_waitcnt lgkmcnt(8)
  v_mfma_f32_32x32x16_bf16 v[144:159], v[92:95], v[96:99], v[144:159]
  ds_read_b64_tr_b16 v[68:69], v10 offset:40960
  ds_read_b64_tr_b16 v[70:71], v10 offset:41472
  ds_read_b64_tr_b16 v[76:77], v9 offset:43008
  s_waitcnt lgkmcnt(8)
  v_mfma_f32_32x32x16_bf16 v[128:143], v[100:103], v[108:111], v[128:143]
  ds_read_b64_tr_b16 v[78:79], v9 offset:43520
  ds_read_b128 v[84:87], v8 offset:44032
  ds_read_b64_tr_b16 v[80:81], v10 offset:43008
  s_waitcnt lgkmcnt(9)
  v_mfma_f32_32x32x16_bf16 v[144:159], v[104:107], v[108:111], v[144:159]
  ds_read_b64_tr_b16 v[82:83], v10 offset:43520
  s_waitcnt lgkmcnt(7)
  v_mfma_f32_32x32x16_bf16 v[128:143], v[64:67], v[72:75], v[128:143]
  ds_read_b64_tr_b16 v[88:89], v9 offset:45056
  ds_read_b64_tr_b16 v[90:91], v9 offset:45568
  ds_read_b128 v[96:99], v8 offset:47104
  s_waitcnt lgkmcnt(8)
  v_mfma_f32_32x32x16_bf16 v[144:159], v[68:71], v[72:75], v[144:159]
  ds_read_b64_tr_b16 v[92:93], v10 offset:45056
  ds_read_b64_tr_b16 v[94:95], v10 offset:45568
  ds_read_b64_tr_b16 v[100:101], v9 offset:47104
  s_waitcnt lgkmcnt(8)
  v_mfma_f32_32x32x16_bf16 v[128:143], v[76:79], v[84:87], v[128:143]
  ds_read_b64_tr_b16 v[102:103], v9 offset:47616
  ds_read_b128 v[108:111], v8 offset:50176
  ds_read_b64_tr_b16 v[104:105], v10 offset:47104
  s_waitcnt lgkmcnt(9)
  v_mfma_f32_32x32x16_bf16 v[144:159], v[80:83], v[84:87], v[144:159]
  ds_read_b64_tr_b16 v[106:107], v10 offset:47616
  s_barrier
  s_waitcnt lgkmcnt(7)
  v_mfma_f32_32x32x16_bf16 v[128:143], v[88:91], v[96:99], v[128:143]
  ds_read_b64_tr_b16 v[64:65], v12 offset:0
  ds_read_b64_tr_b16 v[66:67], v12 offset:512
  ds_read_b128 v[72:75], v11 offset:0
  s_waitcnt lgkmcnt(8)
  v_mfma_f32_32x32x16_bf16 v[144:159], v[92:95], v[96:99], v[144:159]
  ds_read_b64_tr_b16 v[68:69], v13 offset:0
  ds_read_b64_tr_b16 v[70:71], v13 offset:512
  ds_read_b64_tr_b16 v[76:77], v12 offset:2048
  s_waitcnt lgkmcnt(8)
  v_mfma_f32_32x32x16_bf16 v[128:143], v[100:103], v[108:111], v[128:143]
  ds_read_b64_tr_b16 v[78:79], v12 offset:2560
  ds_read_b128 v[84:87], v11 offset:3072
  ds_read_b64_tr_b16 v[80:81], v13 offset:2048
  s_waitcnt lgkmcnt(9)
  v_mfma_f32_32x32x16_bf16 v[144:159], v[104:107], v[108:111], v[144:159]
  ds_read_b64_tr_b16 v[82:83], v13 offset:2560
  s_waitcnt lgkmcnt(7)
  v_mfma_f32_32x32x16_bf16 v[128:143], v[64:67], v[72:75], v[128:143]
  ds_read_b64_tr_b16 v[88:89], v12 offset:4096
  ds_read_b64_tr_b16 v[90:91], v12 offset:4608
  ds_read_b128 v[96:99], v11 offset:6144
  s_waitcnt lgkmcnt(8)
  v_mfma_f32_32x32x16_bf16 v[144:159], v[68:71], v[72:75], v[144:159]
  ds_read_b64_tr_b16 v[92:93], v13 offset:4096
  ds_read_b64_tr_b16 v[94:95], v13 offset:4608
  ds_read_b64_tr_b16 v[100:101], v12 offset:6144
  s_waitcnt lgkmcnt(8)
  v_mfma_f32_32x32x16_bf16 v[128:143], v[76:79], v[84:87], v[128:143]
  ds_read_b64_tr_b16 v[102:103], v12 offset:6656
  ds_read_b128 v[108:111], v11 offset:9216
  ds_read_b64_tr_b16 v[104:105], v13 offset:6144
  s_waitcnt lgkmcnt(9)
  v_mfma_f32_32x32x16_bf16 v[144:159], v[80:83], v[84:87], v[144:159]
  ds_read_b64_tr_b16 v[106:107], v13 offset:6656
  s_barrier
  s_waitcnt lgkmcnt(7)
  v_mfma_f32_32x32x16_bf16 v[128:143], v[88:91], v[96:99], v[128:143]
  ds_read_b64_tr_b16 v[64:65], v12 offset:20480
  ds_read_b64_tr_b16 v[66:67], v12 offset:20992
  ds_read_b128 v[72:75], v11 offset:20480
  s_waitcnt lgkmcnt(8)
  v_mfma_f32_32x32x16_bf16 v[144:159], v[92:95], v[96:99], v[144:159]
  ds_read_b64_tr_b16 v[68:69], v13 offset:20480
  ds_read_b64_tr_b16 v[70:71], v13 offset:20992
  ds_read_b64_tr_b16 v[76:77], v12 offset:22528
  s_waitcnt lgkmcnt(8)
  v_mfma_f32_32x32x16_bf16 v[128:143], v[100:103], v[108:111], v[128:143]
  ds_read_b64_tr_b16 v[78:79], v12 offset:23040
  ds_read_b128 v[84:87], v11 offset:23552
  ds_read_b64_tr_b16 v[80:81], v13 offset:22528
  s_waitcnt lgkmcnt(9)
  v_mfma_f32_32x32x16_bf16 v[144:159], v[104:107], v[108:111], v[144:159]
  ds_read_b64_tr_b16 v[82:83], v13 offset:23040
  s_waitcnt lgkmcnt(7)
  v_mfma_f32_32x32x16_bf16 v[128:143], v[64:67], v[72:75], v[128:143]
  ds_read_b64_tr_b16 v[88:89], v12 offset:24576
  ds_read_b64_tr_b16 v[90:91], v12 offset:25088
  ds_read_b128 v[96:99], v11 offset:26624
  s_waitcnt lgkmcnt(8)
  v_mfma_f32_32x32x16_bf16 v[144:159], v[68:71], v[72:75], v[144:159]
  ds_read_b64_tr_b16 v[92:93], v13 offset:24576
  ds_read_b64_tr_b16 v[94:95], v13 offset:25088
  ds_read_b64_tr_b16 v[100:101], v12 offset:26624
  s_waitcnt lgkmcnt(8)
  v_mfma_f32_32x32x16_bf16 v[128:143], v[76:79], v[84:87], v[128:143]
  ds_read_b64_tr_b16 v[102:103], v12 offset:27136
  ds_read_b128 v[108:111], v11 offset:29696
  ds_read_b64_tr_b16 v[104:105], v13 offset:26624
  s_waitcnt lgkmcnt(9)
  v_mfma_f32_32x32x16_bf16 v[144:159], v[80:83], v[84:87], v[144:159]
  ds_read_b64_tr_b16 v[106:107], v13 offset:27136
  s_barrier
  s_waitcnt lgkmcnt(7)
  v_mfma_f32_32x32x16_bf16 v[128:143], v[88:91], v[96:99], v[128:143]
  ds_read_b64_tr_b16 v[64:65], v12 offset:40960
  ds_read_b64_tr_b16 v[66:67], v12 offset:41472
  ds_read_b128 v[72:75], v11 offset:40960
  s_waitcnt lgkmcnt(8)
  v_mfma_f32_32x32x16_bf16 v[144:159], v[92:95], v[96:99], v[144:159]
  ds_read_b64_tr_b16 v[68:69], v13 offset:40960
  ds_read_b64_tr_b16 v[70:71], v13 offset:41472
  ds_read_b64_tr_b16 v[76:77], v12 offset:43008
  s_waitcnt lgkmcnt(8)
  v_mfma_f32_32x32x16_bf16 v[128:143], v[100:103], v[108:111], v[128:143]
  ds_read_b64_tr_b16 v[78:79], v12 offset:43520
  ds_read_b128 v[84:87], v11 offset:44032
  ds_read_b64_tr_b16 v[80:81], v13 offset:43008
  s_waitcnt lgkmcnt(9)
  v_mfma_f32_32x32x16_bf16 v[144:159], v[104:107], v[108:111], v[144:159]
  ds_read_b64_tr_b16 v[82:83], v13 offset:43520
  s_waitcnt lgkmcnt(7)
  v_mfma_f32_32x32x16_bf16 v[128:143], v[64:67], v[72:75], v[128:143]
  ds_read_b64_tr_b16 v[88:89], v12 offset:45056
  ds_read_b64_tr_b16 v[90:91], v12 offset:45568
  ds_read_b128 v[96:99], v11 offset:47104
  s_waitcnt lgkmcnt(8)
  v_mfma_f32_32x32x16_bf16 v[144:159], v[68:71], v[72:75], v[144:159]
  ds_read_b64_tr_b16 v[92:93], v13 offset:45056
  ds_read_b64_tr_b16 v[94:95], v13 offset:45568
  ds_read_b64_tr_b16 v[100:101], v12 offset:47104
  s_waitcnt lgkmcnt(8)
  v_mfma_f32_32x32x16_bf16 v[128:143], v[76:79], v[84:87], v[128:143]
  ds_read_b64_tr_b16 v[102:103], v12 offset:47616
  ds_read_b128 v[108:111], v11 offset:50176
  ds_read_b64_tr_b16 v[104:105], v13 offset:47104
  s_waitcnt lgkmcnt(9)
  v_mfma_f32_32x32x16_bf16 v[144:159], v[80:83], v[84:87], v[144:159]
  ds_read_b64_tr_b16 v[106:107], v13 offset:47616
  s_barrier
  s_waitcnt lgkmcnt(7)
  v_mfma_f32_32x32x16_bf16 v[128:143], v[88:91], v[96:99], v[128:143]
  ds_read_b64_tr_b16 v[64:65], v33 offset:0
  ds_read_b64_tr_b16 v[66:67], v33 offset:512
  ds_read_b128 v[72:75], v32 offset:0
  s_waitcnt lgkmcnt(8)
  v_mfma_f32_32x32x16_bf16 v[144:159], v[92:95], v[96:99], v[144:159]
  ds_read_b64_tr_b16 v[68:69], v34 offset:0
  ds_read_b64_tr_b16 v[70:71], v34 offset:512
  ds_read_b64_tr_b16 v[76:77], v33 offset:2048
  s_waitcnt lgkmcnt(8)
  v_mfma_f32_32x32x16_bf16 v[128:143], v[100:103], v[108:111], v[128:143]
  ds_read_b64_tr_b16 v[78:79], v33 offset:2560
  ds_read_b128 v[84:87], v32 offset:3072
  ds_read_b64_tr_b16 v[80:81], v34 offset:2048
  s_waitcnt lgkmcnt(9)
  v_mfma_f32_32x32x16_bf16 v[144:159], v[104:107], v[108:111], v[144:159]
  ds_read_b64_tr_b16 v[82:83], v34 offset:2560
  s_waitcnt lgkmcnt(7)
  v_mfma_f32_32x32x16_bf16 v[128:143], v[64:67], v[72:75], v[128:143]
  ds_read_b64_tr_b16 v[88:89], v33 offset:4096
  ds_read_b64_tr_b16 v[90:91], v33 offset:4608
  ds_read_b128 v[96:99], v32 offset:6144
  s_waitcnt lgkmcnt(8)
  v_mfma_f32_32x32x16_bf16 v[144:159], v[68:71], v[72:75], v[144:159]
  ds_read_b64_tr_b16 v[92:93], v34 offset:4096
  ds_read_b64_tr_b16 v[94:95], v34 offset:4608
  ds_read_b64_tr_b16 v[100:101], v33 offset:6144
  s_waitcnt lgkmcnt(8)
  v_mfma_f32_32x32x16_bf16 v[128:143], v[76:79], v[84:87], v[128:143]
  ds_read_b64_tr_b16 v[102:103], v33 offset:6656
  ds_read_b128 v[108:111], v32 offset:9216
  ds_read_b64_tr_b16 v[104:105], v34 offset:6144
  s_waitcnt lgkmcnt(9)
  v_mfma_f32_32x32x16_bf16 v[144:159], v[80:83], v[84:87], v[144:159]
  ds_read_b64_tr_b16 v[106:107], v34 offset:6656
  s_barrier
  s_waitcnt lgkmcnt(7)
  v_mfma_f32_32x32x16_bf16 v[128:143], v[88:91], v[96:99], v[128:143]
  ds_read_b64_tr_b16 v[64:65], v9 offset:0
  ds_read_b64_tr_b16 v[66:67], v9 offset:512
  ds_read_b128 v[72:75], v8 offset:0
  s_waitcnt lgkmcnt(8)
  v_mfma_f32_32x32x16_bf16 v[144:159], v[92:95], v[96:99], v[144:159]
  ds_read_b64_tr_b16 v[68:69], v10 offset:0
  ds_read_b64_tr_b16 v[70:71], v10 offset:512
  ds_read_b64_tr_b16 v[76:77], v9 offset:2048
  s_waitcnt lgkmcnt(8)
  v_mfma_f32_32x32x16_bf16 v[128:143], v[100:103], v[108:111], v[128:143]
  ds_read_b64_tr_b16 v[78:79], v9 offset:2560
  ds_read_b128 v[84:87], v8 offset:3072
  ds_read_b64_tr_b16 v[80:81], v10 offset:2048
  s_waitcnt lgkmcnt(9)
  v_mfma_f32_32x32x16_bf16 v[144:159], v[104:107], v[108:111], v[144:159]
  ds_read_b64_tr_b16 v[82:83], v10 offset:2560
  s_waitcnt lgkmcnt(7)
  v_mfma_f32_32x32x16_bf16 v[128:143], v[64:67], v[72:75], v[128:143]
  ds_read_b64_tr_b16 v[88:89], v9 offset:4096
  ds_read_b64_tr_b16 v[90:91], v9 offset:4608
  ds_read_b128 v[96:99], v8 offset:6144
  s_waitcnt lgkmcnt(8)
  v_mfma_f32_32x32x16_bf16 v[144:159], v[68:71], v[72:75], v[144:159]
  ds_read_b64_tr_b16 v[92:93], v10 offset:4096
  ds_read_b64_tr_b16 v[94:95], v10 offset:4608
  ds_read_b64_tr_b16 v[100:101], v9 offset:6144
  s_waitcnt lgkmcnt(8)
  v_mfma_f32_32x32x16_bf16 v[128:143], v[76:79], v[84:87], v[128:143]
  ds_read_b64_tr_b16 v[102:103], v9 offset:6656
  ds_read_b128 v[108:111], v8 offset:9216
  ds_read_b64_tr_b16 v[104:105], v10 offset:6144
  s_waitcnt lgkmcnt(9)
  v_mfma_f32_32x32x16_bf16 v[144:159], v[80:83], v[84:87], v[144:159]
  ds_read_b64_tr_b16 v[106:107], v10 offset:6656
  s_barrier
  s_waitcnt lgkmcnt(7)
  v_mfma_f32_32x32x16_bf16 v[128:143], v[88:91], v[96:99], v[128:143]
  ds_read_b64_tr_b16 v[64:65], v9 offset:20480
  ds_read_b64_tr_b16 v[66:67], v9 offset:20992
  ds_read_b128 v[72:75], v8 offset:20480
  s_waitcnt lgkmcnt(8)
  v_mfma_f32_32x32x16_bf16 v[144:159], v[92:95], v[96:99], v[144:159]
  ds_read_b64_tr_b16 v[68:69], v10 offset:20480
  ds_read_b64_tr_b16 v[70:71], v10 offset:20992
  ds_read_b64_tr_b16 v[76:77], v9 offset:22528
  s_waitcnt lgkmcnt(8)
  v_mfma_f32_32x32x16_bf16 v[128:143], v[100:103], v[108:111], v[128:143]
  ds_read_b64_tr_b16 v[78:79], v9 offset:23040
  ds_read_b128 v[84:87], v8 offset:23552
  ds_read_b64_tr_b16 v[80:81], v10 offset:22528
  s_waitcnt lgkmcnt(9)
  v_mfma_f32_32x32x16_bf16 v[144:159], v[104:107], v[108:111], v[144:159]
  ds_read_b64_tr_b16 v[82:83], v10 offset:23040
  s_waitcnt lgkmcnt(7)
  v_mfma_f32_32x32x16_bf16 v[128:143], v[64:67], v[72:75], v[128:143]
  ds_read_b64_tr_b16 v[88:89], v9 offset:24576
  ds_read_b64_tr_b16 v[90:91], v9 offset:25088
  ds_read_b128 v[96:99], v8 offset:26624
  s_waitcnt lgkmcnt(8)
  v_mfma_f32_32x32x16_bf16 v[144:159], v[68:71], v[72:75], v[144:159]
  ds_read_b64_tr_b16 v[92:93], v10 offset:24576
  ds_read_b64_tr_b16 v[94:95], v10 offset:25088
  ds_read_b64_tr_b16 v[100:101], v9 offset:26624
  s_waitcnt lgkmcnt(8)
  v_mfma_f32_32x32x16_bf16 v[128:143], v[76:79], v[84:87], v[128:143]
  ds_read_b64_tr_b16 v[102:103], v9 offset:27136
  ds_read_b128 v[108:111], v8 offset:29696
  ds_read_b64_tr_b16 v[104:105], v10 offset:26624
  s_waitcnt lgkmcnt(9)
  v_mfma_f32_32x32x16_bf16 v[144:159], v[80:83], v[84:87], v[144:159]
  ds_read_b64_tr_b16 v[106:107], v10 offset:27136
  s_barrier
  s_waitcnt lgkmcnt(7)
  v_mfma_f32_32x32x16_bf16 v[128:143], v[88:91], v[96:99], v[128:143]
  ds_read_b64_tr_b16 v[64:65], v9 offset:40960
  ds_read_b64_tr_b16 v[66:67], v9 offset:41472
  ds_read_b128 v[72:75], v8 offset:40960
  s_waitcnt lgkmcnt(8)
  v_mfma_f32_32x32x16_bf16 v[144:159], v[92:95], v[96:99], v[144:159]
  ds_read_b64_tr_b16 v[68:69], v10 offset:40960
  ds_read_b64_tr_b16 v[70:71], v10 offset:41472
  ds_read_b64_tr_b16 v[76:77], v9 offset:43008
  s_waitcnt lgkmcnt(8)
  v_mfma_f32_32x32x16_bf16 v[128:143], v[100:103], v[108:111], v[128:143]
  ds_read_b64_tr_b16 v[78:79], v9 offset:43520
  ds_read_b128 v[84:87], v8 offset:44032
  ds_read_b64_tr_b16 v[80:81], v10 offset:43008
  s_waitcnt lgkmcnt(9)
  v_mfma_f32_32x32x16_bf16 v[144:159], v[104:107], v[108:111], v[144:159]
  ds_read_b64_tr_b16 v[82:83], v10 offset:43520
  s_waitcnt lgkmcnt(7)
  v_mfma_f32_32x32x16_bf16 v[128:143], v[64:67], v[72:75], v[128:143]
  ds_read_b64_tr_b16 v[88:89], v9 offset:45056
  ds_read_b64_tr_b16 v[90:91], v9 offset:45568
  ds_read_b128 v[96:99], v8 offset:47104
  s_waitcnt lgkmcnt(8)
  v_mfma_f32_32x32x16_bf16 v[144:159], v[68:71], v[72:75], v[144:159]
  ds_read_b64_tr_b16 v[92:93], v10 offset:45056
  ds_read_b64_tr_b16 v[94:95], v10 offset:45568
  ds_read_b64_tr_b16 v[100:101], v9 offset:47104
  s_waitcnt lgkmcnt(8)
  v_mfma_f32_32x32x16_bf16 v[128:143], v[76:79], v[84:87], v[128:143]
  ds_read_b64_tr_b16 v[102:103], v9 offset:47616
  ds_read_b128 v[108:111], v8 offset:50176
  ds_read_b64_tr_b16 v[104:105], v10 offset:47104
  s_waitcnt lgkmcnt(9)
  v_mfma_f32_32x32x16_bf16 v[144:159], v[80:83], v[84:87], v[144:159]
  ds_read_b64_tr_b16 v[106:107], v10 offset:47616
  s_barrier
  s_waitcnt lgkmcnt(7)
  v_mfma_f32_32x32x16_bf16 v[128:143], v[88:91], v[96:99], v[128:143]
  ds_read_b64_tr_b16 v[64:65], v12 offset:0
  ds_read_b64_tr_b16 v[66:67], v12 offset:512
  ds_read_b128 v[72:75], v11 offset:0
  s_waitcnt lgkmcnt(8)
  v_mfma_f32_32x32x16_bf16 v[144:159], v[92:95], v[96:99], v[144:159]
  ds_read_b64_tr_b16 v[68:69], v13 offset:0
  ds_read_b64_tr_b16 v[70:71], v13 offset:512
  ds_read_b64_tr_b16 v[76:77], v12 offset:2048
  s_waitcnt lgkmcnt(8)
  v_mfma_f32_32x32x16_bf16 v[128:143], v[100:103], v[108:111], v[128:143]
  ds_read_b64_tr_b16 v[78:79], v12 offset:2560
  ds_read_b128 v[84:87], v11 offset:3072
  ds_read_b64_tr_b16 v[80:81], v13 offset:2048
  s_waitcnt lgkmcnt(9)
  v_mfma_f32_32x32x16_bf16 v[144:159], v[104:107], v[108:111], v[144:159]
  ds_read_b64_tr_b16 v[82:83], v13 offset:2560
  s_waitcnt lgkmcnt(7)
  v_mfma_f32_32x32x16_bf16 v[128:143], v[64:67], v[72:75], v[128:143]
  ds_read_b64_tr_b16 v[88:89], v12 offset:4096
  ds_read_b64_tr_b16 v[90:91], v12 offset:4608
  ds_read_b128 v[96:99], v11 offset:6144
  s_waitcnt lgkmcnt(8)
  v_mfma_f32_32x32x16_bf16 v[144:159], v[68:71], v[72:75], v[144:159]
  ds_read_b64_tr_b16 v[92:93], v13 offset:4096
  ds_read_b64_tr_b16 v[94:95], v13 offset:4608
  ds_read_b64_tr_b16 v[100:101], v12 offset:6144
  s_waitcnt lgkmcnt(8)
  v_mfma_f32_32x32x16_bf16 v[128:143], v[76:79], v[84:87], v[128:143]
  ds_read_b64_tr_b16 v[102:103], v12 offset:6656
  ds_read_b128 v[108:111], v11 offset:9216
  ds_read_b64_tr_b16 v[104:105], v13 offset:6144
  s_waitcnt lgkmcnt(9)
  v_mfma_f32_32x32x16_bf16 v[144:159], v[80:83], v[84:87], v[144:159]
  ds_read_b64_tr_b16 v[106:107], v13 offset:6656
  s_barrier
  s_waitcnt lgkmcnt(7)
  v_mfma_f32_32x32x16_bf16 v[128:143], v[88:91], v[96:99], v[128:143]
  ds_read_b64_tr_b16 v[64:65], v12 offset:20480
  ds_read_b64_tr_b16 v[66:67], v12 offset:20992
  ds_read_b128 v[72:75], v11 offset:20480
  s_waitcnt lgkmcnt(8)
  v_mfma_f32_32x32x16_bf16 v[144:159], v[92:95], v[96:99], v[144:159]
  ds_read_b64_tr_b16 v[68:69], v13 offset:20480
  ds_read_b64_tr_b16 v[70:71], v13 offset:20992
  ds_read_b64_tr_b16 v[76:77], v12 offset:22528
  s_waitcnt lgkmcnt(8)
  v_mfma_f32_32x32x16_bf16 v[128:143], v[100:103], v[108:111], v[128:143]
  ds_read_b64_tr_b16 v[78:79], v12 offset:23040
  ds_read_b128 v[84:87], v11 offset:23552
  ds_read_b64_tr_b16 v[80:81], v13 offset:22528
  s_waitcnt lgkmcnt(9)
  v_mfma_f32_32x32x16_bf16 v[144:159], v[104:107], v[108:111], v[144:159]
  ds_read_b64_tr_b16 v[82:83], v13 offset:23040
  s_waitcnt lgkmcnt(7)
  v_mfma_f32_32x32x16_bf16 v[128:143], v[64:67], v[72:75], v[128:143]
  ds_read_b64_tr_b16 v[88:89], v12 offset:24576
  ds_read_b64_tr_b16 v[90:91], v12 offset:25088
  ds_read_b128 v[96:99], v11 offset:26624
  s_waitcnt lgkmcnt(8)
  v_mfma_f32_32x32x16_bf16 v[144:159], v[68:71], v[72:75], v[144:159]
  ds_read_b64_tr_b16 v[92:93], v13 offset:24576
  ds_read_b64_tr_b16 v[94:95], v13 offset:25088
  ds_read_b64_tr_b16 v[100:101], v12 offset:26624
  s_waitcnt lgkmcnt(8)
  v_mfma_f32_32x32x16_bf16 v[128:143], v[76:79], v[84:87], v[128:143]
  ds_read_b64_tr_b16 v[102:103], v12 offset:27136
  ds_read_b128 v[108:111], v11 offset:29696
  ds_read_b64_tr_b16 v[104:105], v13 offset:26624
  s_waitcnt lgkmcnt(9)
  v_mfma_f32_32x32x16_bf16 v[144:159], v[80:83], v[84:87], v[144:159]
  ds_read_b64_tr_b16 v[106:107], v13 offset:27136
  s_barrier
  s_waitcnt lgkmcnt(7)
  v_mfma_f32_32x32x16_bf16 v[128:143], v[88:91], v[96:99], v[128:143]
  ds_read_b64_tr_b16 v[64:65], v12 offset:40960
  ds_read_b64_tr_b16 v[66:67], v12 offset:41472
  ds_read_b128 v[72:75], v11 offset:40960
  s_waitcnt lgkmcnt(8)
  v_mfma_f32_32x32x16_bf16 v[144:159], v[92:95], v[96:99], v[144:159]
  ds_read_b64_tr_b16 v[68:69], v13 offset:40960
  ds_read_b64_tr_b16 v[70:71], v13 offset:41472
  ds_read_b64_tr_b16 v[76:77], v12 offset:43008
  s_waitcnt lgkmcnt(8)
  v_mfma_f32_32x32x16_bf16 v[128:143], v[100:103], v[108:111], v[128:143]
  ds_read_b64_tr_b16 v[78:79], v12 offset:43520
  ds_read_b128 v[84:87], v11 offset:44032
  ds_read_b64_tr_b16 v[80:81], v13 offset:43008
  s_waitcnt lgkmcnt(9)
  v_mfma_f32_32x32x16_bf16 v[144:159], v[104:107], v[108:111], v[144:159]
  ds_read_b64_tr_b16 v[82:83], v13 offset:43520
  s_waitcnt lgkmcnt(7)
  v_mfma_f32_32x32x16_bf16 v[128:143], v[64:67], v[72:75], v[128:143]
  ds_read_b64_tr_b16 v[88:89], v12 offset:45056
  ds_read_b64_tr_b16 v[90:91], v12 offset:45568
  ds_read_b128 v[96:99], v11 offset:47104
  s_waitcnt lgkmcnt(8)
  v_mfma_f32_32x32x16_bf16 v[144:159], v[68:71], v[72:75], v[144:159]
  ds_read_b64_tr_b16 v[92:93], v13 offset:45056
  ds_read_b64_tr_b16 v[94:95], v13 offset:45568
  ds_read_b64_tr_b16 v[100:101], v12 offset:47104
  s_waitcnt lgkmcnt(8)
  v_mfma_f32_32x32x16_bf16 v[128:143], v[76:79], v[84:87], v[128:143]
  ds_read_b64_tr_b16 v[102:103], v12 offset:47616
  ds_read_b128 v[108:111], v11 offset:50176
  ds_read_b64_tr_b16 v[104:105], v13 offset:47104
  s_waitcnt lgkmcnt(9)
  v_mfma_f32_32x32x16_bf16 v[144:159], v[80:83], v[84:87], v[144:159]
  ds_read_b64_tr_b16 v[106:107], v13 offset:47616
  s_barrier
  s_waitcnt lgkmcnt(7)
  v_mfma_f32_32x32x16_bf16 v[128:143], v[88:91], v[96:99], v[128:143]
  ds_read_b64_tr_b16 v[64:65], v33 offset:0
  ds_read_b64_tr_b16 v[66:67], v33 offset:512
  ds_read_b128 v[72:75], v32 offset:0
  s_waitcnt lgkmcnt(8)
  v_mfma_f32_32x32x16_bf16 v[144:159], v[92:95], v[96:99], v[144:159]
  ds_read_b64_tr_b16 v[68:69], v34 offset:0
  ds_read_b64_tr_b16 v[70:71], v34 offset:512
  ds_read_b64_tr_b16 v[76:77], v33 offset:2048
  s_waitcnt lgkmcnt(8)
  v_mfma_f32_32x32x16_bf16 v[128:143], v[100:103], v[108:111], v[128:143]
  ds_read_b64_tr_b16 v[78:79], v33 offset:2560
  ds_read_b128 v[84:87], v32 offset:3072
  ds_read_b64_tr_b16 v[80:81], v34 offset:2048
  s_waitcnt lgkmcnt(9)
  v_mfma_f32_32x32x16_bf16 v[144:159], v[104:107], v[108:111], v[144:159]
  ds_read_b64_tr_b16 v[82:83], v34 offset:2560
  s_waitcnt lgkmcnt(7)
  v_mfma_f32_32x32x16_bf16 v[128:143], v[64:67], v[72:75], v[128:143]
  ds_read_b64_tr_b16 v[88:89], v33 offset:4096
  ds_read_b64_tr_b16 v[90:91], v33 offset:4608
  ds_read_b128 v[96:99], v32 offset:6144
  s_waitcnt lgkmcnt(8)
  v_mfma_f32_32x32x16_bf16 v[144:159], v[68:71], v[72:75], v[144:159]
  ds_read_b64_tr_b16 v[92:93], v34 offset:4096
  ds_read_b64_tr_b16 v[94:95], v34 offset:4608
  ds_read_b64_tr_b16 v[100:101], v33 offset:6144
  s_waitcnt lgkmcnt(8)
  v_mfma_f32_32x32x16_bf16 v[128:143], v[76:79], v[84:87], v[128:143]
  ds_read_b64_tr_b16 v[102:103], v33 offset:6656
  ds_read_b128 v[108:111], v32 offset:9216
  ds_read_b64_tr_b16 v[104:105], v34 offset:6144
  s_waitcnt lgkmcnt(9)
  v_mfma_f32_32x32x16_bf16 v[144:159], v[80:83], v[84:87], v[144:159]
  ds_read_b64_tr_b16 v[106:107], v34 offset:6656
  s_barrier
  s_waitcnt lgkmcnt(7)
  v_mfma_f32_32x32x16_bf16 v[128:143], v[88:91], v[96:99], v[128:143]
  ds_read_b64_tr_b16 v[64:65], v9 offset:0
  ds_read_b64_tr_b16 v[66:67], v9 offset:512
  ds_read_b128 v[72:75], v8 offset:0
  s_waitcnt lgkmcnt(8)
  v_mfma_f32_32x32x16_bf16 v[144:159], v[92:95], v[96:99], v[144:159]
  ds_read_b64_tr_b16 v[68:69], v10 offset:0
  ds_read_b64_tr_b16 v[70:71], v10 offset:512
  ds_read_b64_tr_b16 v[76:77], v9 offset:2048
  s_waitcnt lgkmcnt(8)
  v_mfma_f32_32x32x16_bf16 v[128:143], v[100:103], v[108:111], v[128:143]
  ds_read_b64_tr_b16 v[78:79], v9 offset:2560
  ds_read_b128 v[84:87], v8 offset:3072
  ds_read_b64_tr_b16 v[80:81], v10 offset:2048
  s_waitcnt lgkmcnt(9)
  v_mfma_f32_32x32x16_bf16 v[144:159], v[104:107], v[108:111], v[144:159]
  ds_read_b64_tr_b16 v[82:83], v10 offset:2560
  s_waitcnt lgkmcnt(7)
  v_mfma_f32_32x32x16_bf16 v[128:143], v[64:67], v[72:75], v[128:143]
  ds_read_b64_tr_b16 v[88:89], v9 offset:4096
  ds_read_b64_tr_b16 v[90:91], v9 offset:4608
  ds_read_b128 v[96:99], v8 offset:6144
  s_waitcnt lgkmcnt(8)
  v_mfma_f32_32x32x16_bf16 v[144:159], v[68:71], v[72:75], v[144:159]
  ds_read_b64_tr_b16 v[92:93], v10 offset:4096
  ds_read_b64_tr_b16 v[94:95], v10 offset:4608
  ds_read_b64_tr_b16 v[100:101], v9 offset:6144
  s_waitcnt lgkmcnt(8)
  v_mfma_f32_32x32x16_bf16 v[128:143], v[76:79], v[84:87], v[128:143]
  ds_read_b64_tr_b16 v[102:103], v9 offset:6656
  ds_read_b128 v[108:111], v8 offset:9216
  ds_read_b64_tr_b16 v[104:105], v10 offset:6144
  s_waitcnt lgkmcnt(9)
  v_mfma_f32_32x32x16_bf16 v[144:159], v[80:83], v[84:87], v[144:159]
  ds_read_b64_tr_b16 v[106:107], v10 offset:6656
  s_barrier
  s_waitcnt lgkmcnt(7)
  v_mfma_f32_32x32x16_bf16 v[128:143], v[88:91], v[96:99], v[128:143]
  ds_read_b64_tr_b16 v[64:65], v9 offset:20480
  ds_read_b64_tr_b16 v[66:67], v9 offset:20992
  ds_read_b128 v[72:75], v8 offset:20480
  s_waitcnt lgkmcnt(8)
  v_mfma_f32_32x32x16_bf16 v[144:159], v[92:95], v[96:99], v[144:159]
  ds_read_b64_tr_b16 v[68:69], v10 offset:20480
  ds_read_b64_tr_b16 v[70:71], v10 offset:20992
  ds_read_b64_tr_b16 v[76:77], v9 offset:22528
  s_waitcnt lgkmcnt(8)
  v_mfma_f32_32x32x16_bf16 v[128:143], v[100:103], v[108:111], v[128:143]
  ds_read_b64_tr_b16 v[78:79], v9 offset:23040
  ds_read_b128 v[84:87], v8 offset:23552
  ds_read_b64_tr_b16 v[80:81], v10 offset:22528
  s_waitcnt lgkmcnt(9)
  v_mfma_f32_32x32x16_bf16 v[144:159], v[104:107], v[108:111], v[144:159]
  ds_read_b64_tr_b16 v[82:83], v10 offset:23040
  s_waitcnt lgkmcnt(7)
  v_mfma_f32_32x32x16_bf16 v[128:143], v[64:67], v[72:75], v[128:143]
  ds_read_b64_tr_b16 v[88:89], v9 offset:24576
  ds_read_b64_tr_b16 v[90:91], v9 offset:25088
  ds_read_b128 v[96:99], v8 offset:26624
  s_waitcnt lgkmcnt(8)
  v_mfma_f32_32x32x16_bf16 v[144:159], v[68:71], v[72:75], v[144:159]
  ds_read_b64_tr_b16 v[92:93], v10 offset:24576
  ds_read_b64_tr_b16 v[94:95], v10 offset:25088
  ds_read_b64_tr_b16 v[100:101], v9 offset:26624
  s_waitcnt lgkmcnt(8)
  v_mfma_f32_32x32x16_bf16 v[128:143], v[76:79], v[84:87], v[128:143]
  ds_read_b64_tr_b16 v[102:103], v9 offset:27136
  ds_read_b128 v[108:111], v8 offset:29696
  ds_read_b64_tr_b16 v[104:105], v10 offset:26624
  s_waitcnt lgkmcnt(9)
  v_mfma_f32_32x32x16_bf16 v[144:159], v[80:83], v[84:87], v[144:159]
  ds_read_b64_tr_b16 v[106:107], v10 offset:27136
  s_barrier
  s_waitcnt lgkmcnt(7)
  v_mfma_f32_32x32x16_bf16 v[128:143], v[88:91], v[96:99], v[128:143]
  ds_read_b64_tr_b16 v[64:65], v9 offset:40960
  ds_read_b64_tr_b16 v[66:67], v9 offset:41472
  ds_read_b128 v[72:75], v8 offset:40960
  s_waitcnt lgkmcnt(8)
  v_mfma_f32_32x32x16_bf16 v[144:159], v[92:95], v[96:99], v[144:159]
  ds_read_b64_tr_b16 v[68:69], v10 offset:40960
  ds_read_b64_tr_b16 v[70:71], v10 offset:41472
  ds_read_b64_tr_b16 v[76:77], v9 offset:43008
  s_waitcnt lgkmcnt(8)
  v_mfma_f32_32x32x16_bf16 v[128:143], v[100:103], v[108:111], v[128:143]
  ds_read_b64_tr_b16 v[78:79], v9 offset:43520
  ds_read_b128 v[84:87], v8 offset:44032
  ds_read_b64_tr_b16 v[80:81], v10 offset:43008
  s_waitcnt lgkmcnt(9)
  v_mfma_f32_32x32x16_bf16 v[144:159], v[104:107], v[108:111], v[144:159]
  ds_read_b64_tr_b16 v[82:83], v10 offset:43520
  s_waitcnt lgkmcnt(7)
  v_mfma_f32_32x32x16_bf16 v[128:143], v[64:67], v[72:75], v[128:143]
  ds_read_b64_tr_b16 v[88:89], v9 offset:45056
  ds_read_b64_tr_b16 v[90:91], v9 offset:45568
  ds_read_b128 v[96:99], v8 offset:47104
  s_waitcnt lgkmcnt(8)
  v_mfma_f32_32x32x16_bf16 v[144:159], v[68:71], v[72:75], v[144:159]
  ds_read_b64_tr_b16 v[92:93], v10 offset:45056
  ds_read_b64_tr_b16 v[94:95], v10 offset:45568
  ds_read_b64_tr_b16 v[100:101], v9 offset:47104
  s_waitcnt lgkmcnt(8)
  v_mfma_f32_32x32x16_bf16 v[128:143], v[76:79], v[84:87], v[128:143]
  ds_read_b64_tr_b16 v[102:103], v9 offset:47616
  ds_read_b128 v[108:111], v8 offset:50176
  ds_read_b64_tr_b16 v[104:105], v10 offset:47104
  s_waitcnt lgkmcnt(9)
  v_mfma_f32_32x32x16_bf16 v[144:159], v[80:83], v[84:87], v[144:159]
  ds_read_b64_tr_b16 v[106:107], v10 offset:47616
  s_barrier
  s_waitcnt lgkmcnt(7)
  v_mfma_f32_32x32x16_bf16 v[128:143], v[88:91], v[96:99], v[128:143]
  ds_read_b64_tr_b16 v[64:65], v12 offset:0
  ds_read_b64_tr_b16 v[66:67], v12 offset:512
  ds_read_b128 v[72:75], v11 offset:0
  s_waitcnt lgkmcnt(8)
  v_mfma_f32_32x32x16_bf16 v[144:159], v[92:95], v[96:99], v[144:159]
  ds_read_b64_tr_b16 v[68:69], v13 offset:0
  ds_read_b64_tr_b16 v[70:71], v13 offset:512
  ds_read_b64_tr_b16 v[76:77], v12 offset:2048
  s_waitcnt lgkmcnt(8)
  v_mfma_f32_32x32x16_bf16 v[128:143], v[100:103], v[108:111], v[128:143]
  ds_read_b64_tr_b16 v[78:79], v12 offset:2560
  ds_read_b128 v[84:87], v11 offset:3072
  ds_read_b64_tr_b16 v[80:81], v13 offset:2048
  s_waitcnt lgkmcnt(9)
  v_mfma_f32_32x32x16_bf16 v[144:159], v[104:107], v[108:111], v[144:159]
  ds_read_b64_tr_b16 v[82:83], v13 offset:2560
  s_waitcnt lgkmcnt(7)
  v_mfma_f32_32x32x16_bf16 v[128:143], v[64:67], v[72:75], v[128:143]
  ds_read_b64_tr_b16 v[88:89], v12 offset:4096
  ds_read_b64_tr_b16 v[90:91], v12 offset:4608
  ds_read_b128 v[96:99], v11 offset:6144
  s_waitcnt lgkmcnt(8)
  v_mfma_f32_32x32x16_bf16 v[144:159], v[68:71], v[72:75], v[144:159]
  ds_read_b64_tr_b16 v[92:93], v13 offset:4096
  ds_read_b64_tr_b16 v[94:95], v13 offset:4608
  ds_read_b64_tr_b16 v[100:101], v12 offset:6144
  s_waitcnt lgkmcnt(8)
  v_mfma_f32_32x32x16_bf16 v[128:143], v[76:79], v[84:87], v[128:143]
  ds_read_b64_tr_b16 v[102:103], v12 offset:6656
  ds_read_b128 v[108:111], v11 offset:9216
  ds_read_b64_tr_b16 v[104:105], v13 offset:6144
  s_waitcnt lgkmcnt(9)
  v_mfma_f32_32x32x16_bf16 v[144:159], v[80:83], v[84:87], v[144:159]
  ds_read_b64_tr_b16 v[106:107], v13 offset:6656
  s_barrier
  s_waitcnt lgkmcnt(7)
  v_mfma_f32_32x32x16_bf16 v[128:143], v[88:91], v[96:99], v[128:143]
  ds_read_b64_tr_b16 v[64:65], v12 offset:20480
  ds_read_b64_tr_b16 v[66:67], v12 offset:20992
  ds_read_b128 v[72:75], v11 offset:20480
  s_waitcnt lgkmcnt(8)
  v_mfma_f32_32x32x16_bf16 v[144:159], v[92:95], v[96:99], v[144:159]
  ds_read_b64_tr_b16 v[68:69], v13 offset:20480
  ds_read_b64_tr_b16 v[70:71], v13 offset:20992
  ds_read_b64_tr_b16 v[76:77], v12 offset:22528
  s_waitcnt lgkmcnt(8)
  v_mfma_f32_32x32x16_bf16 v[128:143], v[100:103], v[108:111], v[128:143]
  ds_read_b64_tr_b16 v[78:79], v12 offset:23040
  ds_read_b128 v[84:87], v11 offset:23552
  ds_read_b64_tr_b16 v[80:81], v13 offset:22528
  s_waitcnt lgkmcnt(9)
  v_mfma_f32_32x32x16_bf16 v[144:159], v[104:107], v[108:111], v[144:159]
  ds_read_b64_tr_b16 v[82:83], v13 offset:23040
  s_waitcnt lgkmcnt(7)
  v_mfma_f32_32x32x16_bf16 v[128:143], v[64:67], v[72:75], v[128:143]
  ds_read_b64_tr_b16 v[88:89], v12 offset:24576
  ds_read_b64_tr_b16 v[90:91], v12 offset:25088
  ds_read_b128 v[96:99], v11 offset:26624
  s_waitcnt lgkmcnt(8)
  v_mfma_f32_32x32x16_bf16 v[144:159], v[68:71], v[72:75], v[144:159]
  ds_read_b64_tr_b16 v[92:93], v13 offset:24576
  ds_read_b64_tr_b16 v[94:95], v13 offset:25088
  ds_read_b64_tr_b16 v[100:101], v12 offset:26624
  s_waitcnt lgkmcnt(8)
  v_mfma_f32_32x32x16_bf16 v[128:143], v[76:79], v[84:87], v[128:143]
  ds_read_b64_tr_b16 v[102:103], v12 offset:27136
  ds_read_b128 v[108:111], v11 offset:29696
  ds_read_b64_tr_b16 v[104:105], v13 offset:26624
  s_waitcnt lgkmcnt(9)
  v_mfma_f32_32x32x16_bf16 v[144:159], v[80:83], v[84:87], v[144:159]
  ds_read_b64_tr_b16 v[106:107], v13 offset:27136
  s_barrier
  s_waitcnt lgkmcnt(7)
  v_mfma_f32_32x32x16_bf16 v[128:143], v[88:91], v[96:99], v[128:143]
  ds_read_b64_tr_b16 v[64:65], v12 offset:40960
  ds_read_b64_tr_b16 v[66:67], v12 offset:41472
  ds_read_b128 v[72:75], v11 offset:40960
  s_waitcnt lgkmcnt(8)
  v_mfma_f32_32x32x16_bf16 v[144:159], v[92:95], v[96:99], v[144:159]
  ds_read_b64_tr_b16 v[68:69], v13 offset:40960
  ds_read_b64_tr_b16 v[70:71], v13 offset:41472
  ds_read_b64_tr_b16 v[76:77], v12 offset:43008
  s_waitcnt lgkmcnt(8)
  v_mfma_f32_32x32x16_bf16 v[128:143], v[100:103], v[108:111], v[128:143]
  ds_read_b64_tr_b16 v[78:79], v12 offset:43520
  ds_read_b128 v[84:87], v11 offset:44032
  ds_read_b64_tr_b16 v[80:81], v13 offset:43008
  s_waitcnt lgkmcnt(9)
  v_mfma_f32_32x32x16_bf16 v[144:159], v[104:107], v[108:111], v[144:159]
  ds_read_b64_tr_b16 v[82:83], v13 offset:43520
  s_waitcnt lgkmcnt(7)
  v_mfma_f32_32x32x16_bf16 v[128:143], v[64:67], v[72:75], v[128:143]
  ds_read_b64_tr_b16 v[88:89], v12 offset:45056
  ds_read_b64_tr_b16 v[90:91], v12 offset:45568
  ds_read_b128 v[96:99], v11 offset:47104
  s_waitcnt lgkmcnt(8)
  v_mfma_f32_32x32x16_bf16 v[144:159], v[68:71], v[72:75], v[144:159]
  ds_read_b64_tr_b16 v[92:93], v13 offset:45056
  ds_read_b64_tr_b16 v[94:95], v13 offset:45568
  ds_read_b64_tr_b16 v[100:101], v12 offset:47104
  s_waitcnt lgkmcnt(8)
  v_mfma_f32_32x32x16_bf16 v[128:143], v[76:79], v[84:87], v[128:143]
  ds_read_b64_tr_b16 v[102:103], v12 offset:47616
  ds_read_b128 v[108:111], v11 offset:50176
  ds_read_b64_tr_b16 v[104:105], v13 offset:47104
  s_waitcnt lgkmcnt(9)
  v_mfma_f32_32x32x16_bf16 v[144:159], v[80:83], v[84:87], v[144:159]
  ds_read_b64_tr_b16 v[106:107], v13 offset:47616
  s_waitcnt lgkmcnt(7)
  v_mfma_f32_32x32x16_bf16 v[128:143], v[88:91], v[96:99], v[128:143]
  s_waitcnt lgkmcnt(5)
  v_mfma_f32_32x32x16_bf16 v[144:159], v[92:95], v[96:99], v[144:159]
  s_waitcnt lgkmcnt(2)
  v_mfma_f32_32x32x16_bf16 v[128:143], v[100:103], v[108:111], v[128:143]
  s_waitcnt lgkmcnt(0)
  v_mfma_f32_32x32x16_bf16 v[144:159], v[104:107], v[108:111], v[144:159]
  s_cmp_eq_u32 s37, 1
  s_cbranch_scc1 main_w275_fin
  s_waitcnt vmcnt(0)
  s_nop 7
  s_nop 3
  v_lshlrev_b32 v64, 16, v16
  v_and_b32 v65, 0xffff0000, v16
  v_lshlrev_b32 v66, 16, v17
  v_and_b32 v67, 0xffff0000, v17
  v_pk_add_f32 v[128:129], v[128:129], v[64:65]
  v_pk_add_f32 v[130:131], v[130:131], v[66:67]
  v_lshlrev_b32 v72, 16, v112
  v_and_b32 v73, 0xffff0000, v112
  v_lshlrev_b32 v74, 16, v113
  v_and_b32 v75, 0xffff0000, v113
  v_pk_add_f32 v[128:129], v[128:129], v[72:73]
  v_pk_add_f32 v[130:131], v[130:131], v[74:75]
  v_lshlrev_b32 v68, 16, v18
  v_and_b32 v69, 0xffff0000, v18
  v_lshlrev_b32 v70, 16, v19
  v_and_b32 v71, 0xffff0000, v19
  v_pk_add_f32 v[132:133], v[132:133], v[68:69]
  v_pk_add_f32 v[134:135], v[134:135], v[70:71]
  v_lshlrev_b32 v76, 16, v114
  v_and_b32 v77, 0xffff0000, v114
  v_lshlrev_b32 v78, 16, v115
  v_and_b32 v79, 0xffff0000, v115
  v_pk_add_f32 v[132:133], v[132:133], v[76:77]
  v_pk_add_f32 v[134:135], v[134:135], v[78:79]
  v_lshlrev_b32 v64, 16, v20
  v_and_b32 v65, 0xffff0000, v20
  v_lshlrev_b32 v66, 16, v21
  v_and_b32 v67, 0xffff0000, v21
  v_pk_add_f32 v[136:137], v[136:137], v[64:65]
  v_pk_add_f32 v[138:139], v[138:139], v[66:67]
  v_lshlrev_b32 v72, 16, v116
  v_and_b32 v73, 0xffff0000, v116
  v_lshlrev_b32 v74, 16, v117
  v_and_b32 v75, 0xffff0000, v117
  v_pk_add_f32 v[136:137], v[136:137], v[72:73]
  v_pk_add_f32 v[138:139], v[138:139], v[74:75]
  v_lshlrev_b32 v68, 16, v22
  v_and_b32 v69, 0xffff0000, v22
  v_lshlrev_b32 v70, 16, v23
  v_and_b32 v71, 0xffff0000, v23
  v_pk_add_f32 v[140:141], v[140:141], v[68:69]
  v_pk_add_f32 v[142:143], v[142:143], v[70:71]
  v_lshlrev_b32 v76, 16, v118
  v_and_b32 v77, 0xffff0000, v118
  v_lshlrev_b32 v78, 16, v119
  v_and_b32 v79, 0xffff0000, v119
  v_pk_add_f32 v[140:141], v[140:141], v[76:77]
  v_pk_add_f32 v[142:143], v[142:143], v[78:79]
  v_lshlrev_b32 v64, 16, v24
  v_and_b32 v65, 0xffff0000, v24
  v_lshlrev_b32 v66, 16, v25
  v_and_b32 v67, 0xffff0000, v25
  v_pk_add_f32 v[144:145], v[144:145], v[64:65]
  v_pk_add_f32 v[146:147], v[146:147], v[66:67]
  v_lshlrev_b32 v72, 16, v120
  v_and_b32 v73, 0xffff0000, v120
  v_lshlrev_b32 v74, 16, v121
  v_and_b32 v75, 0xffff0000, v121
  v_pk_add_f32 v[144:145], v[144:145], v[72:73]
  v_pk_add_f32 v[146:147], v[146:147], v[74:75]
  v_lshlrev_b32 v68, 16, v26
  v_and_b32 v69, 0xffff0000, v26
  v_lshlrev_b32 v70, 16, v27
  v_and_b32 v71, 0xffff0000, v27
  v_pk_add_f32 v[148:149], v[148:149], v[68:69]
  v_pk_add_f32 v[150:151], v[150:151], v[70:71]
  v_lshlrev_b32 v76, 16, v122
  v_and_b32 v77, 0xffff0000, v122
  v_lshlrev_b32 v78, 16, v123
  v_and_b32 v79, 0xffff0000, v123
  v_pk_add_f32 v[148:149], v[148:149], v[76:77]
  v_pk_add_f32 v[150:151], v[150:151], v[78:79]
  v_lshlrev_b32 v64, 16, v28
  v_and_b32 v65, 0xffff0000, v28
  v_lshlrev_b32 v66, 16, v29
  v_and_b32 v67, 0xffff0000, v29
  v_pk_add_f32 v[152:153], v[152:153], v[64:65]
  v_pk_add_f32 v[154:155], v[154:155], v[66:67]
  v_lshlrev_b32 v72, 16, v124
  v_and_b32 v73, 0xffff0000, v124
  v_lshlrev_b32 v74, 16, v125
  v_and_b32 v75, 0xffff0000, v125
  v_pk_add_f32 v[152:153], v[152:153], v[72:73]
  v_pk_add_f32 v[154:155], v[154:155], v[74:75]
  v_lshlrev_b32 v68, 16, v30
  v_and_b32 v69, 0xffff0000, v30
  v_lshlrev_b32 v70, 16, v31
  v_and_b32 v71, 0xffff0000, v31
  v_pk_add_f32 v[156:157], v[156:157], v[68:69]
  v_pk_add_f32 v[158:159], v[158:159], v[70:71]
  v_lshlrev_b32 v76, 16, v126
  v_and_b32 v77, 0xffff0000, v126
  v_lshlrev_b32 v78, 16, v127
  v_and_b32 v79, 0xffff0000, v127
  v_pk_add_f32 v[156:157], v[156:157], v[76:77]
  v_pk_add_f32 v[158:159], v[158:159], v[78:79]
  v_cvt_pk_bf16_f32 v80, v128, v129
  v_cvt_pk_bf16_f32 v81, v130, v131
  v_cvt_pk_bf16_f32 v82, v132, v133
  v_cvt_pk_bf16_f32 v83, v134, v135
  s_nop 1
  v_permlane32_swap_b32 v80, v82
  v_permlane32_swap_b32 v81, v83
  v_cvt_pk_bf16_f32 v84, v136, v137
  v_cvt_pk_bf16_f32 v85, v138, v139
  v_cvt_pk_bf16_f32 v86, v140, v141
  v_cvt_pk_bf16_f32 v87, v142, v143
  s_nop 1
  v_permlane32_swap_b32 v84, v86
  v_permlane32_swap_b32 v85, v87
  v_cvt_pk_bf16_f32 v88, v144, v145
  v_cvt_pk_bf16_f32 v89, v146, v147
  v_cvt_pk_bf16_f32 v90, v148, v149
  v_cvt_pk_bf16_f32 v91, v150, v151
  s_nop 1
  v_permlane32_swap_b32 v88, v90
  v_permlane32_swap_b32 v89, v91
  v_cvt_pk_bf16_f32 v92, v152, v153
  v_cvt_pk_bf16_f32 v93, v154, v155
  v_cvt_pk_bf16_f32 v94, v156, v157
  v_cvt_pk_bf16_f32 v95, v158, v159
  s_nop 1
  v_permlane32_swap_b32 v92, v94
  v_permlane32_swap_b32 v93, v95
  s_cmp_eq_u32 s5, 0
  s_cbranch_scc1 main_w275_nf
  s_mov_b32 s34, 1280
  v_mul_lo_u32 v14, v5, s34
  v_lshlrev_b32 v15, 4, v3
  v_add_u32 v14, v14, v15
  s_lshl_b32 s34, s25, 7
  buffer_store_dwordx4 v[80:83], v14, s[96:99], s34 offen offset:0
  buffer_store_dwordx4 v[84:87], v14, s[96:99], s34 offen offset:32
  buffer_store_dwordx4 v[88:91], v14, s[96:99], s34 offen offset:64
  buffer_store_dwordx4 v[92:95], v14, s[96:99], s34 offen offset:96
  s_endpgm
main_w275_nf:
  v_lshlrev_b32 v14, 15, v3
  v_lshlrev_b32 v15, 4, v5
  v_add_u32 v14, v14, v15
  s_lshl_b32 s34, s25, 18
  s_add_u32 s34, s34, s5
  s_add_u32 s34, s34, 45350912
  buffer_store_dwordx4 v[80:83], v14, s[8:11], s34 offen sc1
  s_add_u32 s34, s34, 65536
  buffer_store_dwordx4 v[84:87], v14, s[8:11], s34 offen sc1
  s_add_u32 s34, s34, 65536
  buffer_store_dwordx4 v[88:91], v14, s[8:11], s34 offen sc1
  s_add_u32 s34, s34, 65536
  buffer_store_dwordx4 v[92:95], v14, s[8:11], s34 offen sc1
  s_add_u32 s34, s34, 65536
  v_pk_add_f32 v[100:101], v[128:129], v[130:131]
  v_pk_mul_f32 v[102:103], v[128:129], v[128:129]
  v_pk_fma_f32 v[102:103], v[130:131], v[130:131], v[102:103]
  v_pk_add_f32 v[100:101], v[100:101], v[132:133]
  v_pk_fma_f32 v[102:103], v[132:133], v[132:133], v[102:103]
  v_pk_add_f32 v[100:101], v[100:101], v[134:135]
  v_pk_fma_f32 v[102:103], v[134:135], v[134:135], v[102:103]
  v_pk_add_f32 v[100:101], v[100:101], v[136:137]
  v_pk_fma_f32 v[102:103], v[136:137], v[136:137], v[102:103]
  v_pk_add_f32 v[100:101], v[100:101], v[138:139]
  v_pk_fma_f32 v[102:103], v[138:139], v[138:139], v[102:103]
  v_pk_add_f32 v[100:101], v[100:101], v[140:141]
  v_pk_fma_f32 v[102:103], v[140:141], v[140:141], v[102:103]
  v_pk_add_f32 v[100:101], v[100:101], v[142:143]
  v_pk_fma_f32 v[102:103], v[142:143], v[142:143], v[102:103]
  v_pk_add_f32 v[100:101], v[100:101], v[144:145]
  v_pk_fma_f32 v[102:103], v[144:145], v[144:145], v[102:103]
  v_pk_add_f32 v[100:101], v[100:101], v[146:147]
  v_pk_fma_f32 v[102:103], v[146:147], v[146:147], v[102:103]
  v_pk_add_f32 v[100:101], v[100:101], v[148:149]
  v_pk_fma_f32 v[102:103], v[148:149], v[148:149], v[102:103]
  v_pk_add_f32 v[100:101], v[100:101], v[150:151]
  v_pk_fma_f32 v[102:103], v[150:151], v[150:151], v[102:103]
  v_pk_add_f32 v[100:101], v[100:101], v[152:153]
  v_pk_fma_f32 v[102:103], v[152:153], v[152:153], v[102:103]
  v_pk_add_f32 v[100:101], v[100:101], v[154:155]
  v_pk_fma_f32 v[102:103], v[154:155], v[154:155], v[102:103]
  v_pk_add_f32 v[100:101], v[100:101], v[156:157]
  v_pk_fma_f32 v[102:103], v[156:157], v[156:157], v[102:103]
  v_pk_add_f32 v[100:101], v[100:101], v[158:159]
  v_pk_fma_f32 v[102:103], v[158:159], v[158:159], v[102:103]
  v_add_f32 v100, v100, v101
  v_add_f32 v101, v102, v103
  v_mov_b32 v104, v100
  s_nop 1
  v_permlane32_swap_b32 v100, v104
  s_nop 1
  v_add_f32 v100, v100, v104
  v_mov_b32 v104, v101
  s_nop 1
  v_permlane32_swap_b32 v101, v104
  s_nop 1
  v_add_f32 v101, v101, v104
  v_lshlrev_b32 v15, 3, v4
  s_lshl_b32 s35, s31, 3
  s_lshl_b32 s36, s25, 14
  s_add_u32 s35, s35, s36
  s_add_u32 s35, s35, s5
  s_add_u32 s35, s35, 48136192
  v_cmp_gt_u32 vcc, 32, v1
  s_and_saveexec_b64 s[40:41], vcc
  buffer_store_dwordx2 v[100:101], v15, s[8:11], s35 offen sc1
  s_mov_b64 exec, s[40:41]
main_w275_fin:
  s_cmp_eq_u32 s5, 0
  s_cbranch_scc1 main_w275_le
  s_endpgm
main_w275_le:
  s_waitcnt vmcnt(0)
main_w275_fin2:
  s_barrier
  s_cmp_eq_u32 s3, 0
  s_cbranch_scc0 main_ar80
  s_mul_i32 s46, s24, 128
  s_add_u32 s46, s46, s5
  s_add_u32 s46, s46, 49360896
  v_and_b32 v60, 63, v0
  v_lshlrev_b32 v60, 14, v60
  v_mov_b32 v61, 1
  s_mov_b64 s[44:45], exec
  s_mov_b64 exec, 255
  buffer_atomic_add v61, v60, s[8:11], s46 offen sc1
  s_mov_b64 exec, s[44:45]
main_ar80:
main_w275_end:
  s_cmp_eq_u32 s5, 0
  s_cbranch_scc0 main_end
  s_mov_b32 s5, 25165824
  s_branch main_loop
main_end:
  s_endpgm
main_qkv1_aux:
  s_cmp_eq_u32 s5, 0
  s_cbranch_scc0 main_qkv1_end
  v_and_b32 v1, 63, v0
  s_sub_u32 s24, s2, 240
  s_and_b32 s33, s24, 7
  s_lshl_b32 s33, s33, 14
  s_lshr_b32 s34, s24, 3
  s_mul_i32 s34, s34, 25165824
  s_add_u32 s33, s33, s34
  s_add_u32 s33, s33, 24182784
  v_lshlrev_b32 v3, 4, v0
  v_mov_b32 v4, 0
  v_mov_b32 v5, 0
  v_mov_b32 v6, 0
  v_mov_b32 v7, 0
  buffer_store_dwordx4 v[4:7], v3, s[8:11], s33 offen sc1
  s_add_u32 s33, s33, 8192
  buffer_store_dwordx4 v[4:7], v3, s[8:11], s33 offen sc1
  s_cmp_eq_u32 s24, 15
  s_cbranch_scc1 main_az81
  v_lshrrev_b32 v3, 4, v0
  v_and_b32 v4, 15, v0
  s_mov_b32 s32, 3840
  v_mul_lo_u32 v3, v3, s32
  v_lshlrev_b32 v4, 4, v4
  v_add_u32 v3, v3, v4
  s_lshl_b32 s33, s24, 8
  v_add_u32 v3, s33, v3
  s_mov_b32 s37, 0
  buffer_load_dwordx4 v[64:67], v3, s[12:15], s37 offen
  s_add_u32 s37, s37, 122880
  buffer_load_dwordx4 v[68:71], v3, s[12:15], s37 offen
  s_add_u32 s37, s37, 122880
  buffer_load_dwordx4 v[72:75], v3, s[12:15], s37 offen
  s_add_u32 s37, s37, 122880
  buffer_load_dwordx4 v[76:79], v3, s[12:15], s37 offen
  s_add_u32 s37, s37, 122880
  buffer_load_dwordx4 v[80:83], v3, s[12:15], s37 offen
  s_add_u32 s37, s37, 122880
  buffer_load_dwordx4 v[84:87], v3, s[12:15], s37 offen
  s_add_u32 s37, s37, 122880
  buffer_load_dwordx4 v[88:91], v3, s[12:15], s37 offen
  s_add_u32 s37, s37, 122880
  buffer_load_dwordx4 v[92:95], v3, s[12:15], s37 offen
  s_add_u32 s37, s37, 122880
  buffer_load_dwordx4 v[96:99], v3, s[12:15], s37 offen
  s_add_u32 s37, s37, 122880
  buffer_load_dwordx4 v[100:103], v3, s[12:15], s37 offen
  s_add_u32 s37, s37, 122880
  buffer_load_dwordx4 v[104:107], v3, s[12:15], s37 offen
  s_add_u32 s37, s37, 122880
  buffer_load_dwordx4 v[108:111], v3, s[12:15], s37 offen
  s_add_u32 s37, s37, 122880
  buffer_load_dwordx4 v[112:115], v3, s[12:15], s37 offen
  s_add_u32 s37, s37, 122880
  buffer_load_dwordx4 v[116:119], v3, s[12:15], s37 offen
  s_add_u32 s37, s37, 122880
  buffer_load_dwordx4 v[120:123], v3, s[12:15], s37 offen
  s_add_u32 s37, s37, 122880
  buffer_load_dwordx4 v[124:127], v3, s[12:15], s37 offen
  s_add_u32 s37, s37, 122880
  buffer_load_dwordx4 v[128:131], v3, s[12:15], s37 offen
  s_add_u32 s37, s37, 122880
  buffer_load_dwordx4 v[132:135], v3, s[12:15], s37 offen
  s_add_u32 s37, s37, 122880
  buffer_load_dwordx4 v[136:139], v3, s[12:15], s37 offen
  s_add_u32 s37, s37, 122880
  buffer_load_dwordx4 v[140:143], v3, s[12:15], s37 offen
  s_add_u32 s37, s37, 122880
  v_mov_b32 v16, 0
  v_mov_b32 v17, 0
  v_mov_b32 v18, 0
  v_mov_b32 v19, 0
  v_mov_b32 v20, 0
  v_mov_b32 v21, 0
  v_mov_b32 v22, 0
  v_mov_b32 v23, 0
  s_waitcnt vmcnt(19)
  v_lshlrev_b32 v8, 16, v64
  v_and_b32 v9, 0xffff0000, v64
  v_pk_add_f32 v[16:17], v[16:17], v[8:9]
  v_lshlrev_b32 v10, 16, v65
  v_and_b32 v11, 0xffff0000, v65
  v_pk_add_f32 v[18:19], v[18:19], v[10:11]
  v_lshlrev_b32 v8, 16, v66
  v_and_b32 v9, 0xffff0000, v66
  v_pk_add_f32 v[20:21], v[20:21], v[8:9]
  v_lshlrev_b32 v10, 16, v67
  v_and_b32 v11, 0xffff0000, v67
  v_pk_add_f32 v[22:23], v[22:23], v[10:11]
  s_waitcnt vmcnt(18)
  v_lshlrev_b32 v8, 16, v68
  v_and_b32 v9, 0xffff0000, v68
  v_pk_add_f32 v[16:17], v[16:17], v[8:9]
  v_lshlrev_b32 v10, 16, v69
  v_and_b32 v11, 0xffff0000, v69
  v_pk_add_f32 v[18:19], v[18:19], v[10:11]
  v_lshlrev_b32 v8, 16, v70
  v_and_b32 v9, 0xffff0000, v70
  v_pk_add_f32 v[20:21], v[20:21], v[8:9]
  v_lshlrev_b32 v10, 16, v71
  v_and_b32 v11, 0xffff0000, v71
  v_pk_add_f32 v[22:23], v[22:23], v[10:11]
  s_waitcnt vmcnt(17)
  v_lshlrev_b32 v8, 16, v72
  v_and_b32 v9, 0xffff0000, v72
  v_pk_add_f32 v[16:17], v[16:17], v[8:9]
  v_lshlrev_b32 v10, 16, v73
  v_and_b32 v11, 0xffff0000, v73
  v_pk_add_f32 v[18:19], v[18:19], v[10:11]
  v_lshlrev_b32 v8, 16, v74
  v_and_b32 v9, 0xffff0000, v74
  v_pk_add_f32 v[20:21], v[20:21], v[8:9]
  v_lshlrev_b32 v10, 16, v75
  v_and_b32 v11, 0xffff0000, v75
  v_pk_add_f32 v[22:23], v[22:23], v[10:11]
  s_waitcnt vmcnt(16)
  v_lshlrev_b32 v8, 16, v76
  v_and_b32 v9, 0xffff0000, v76
  v_pk_add_f32 v[16:17], v[16:17], v[8:9]
  v_lshlrev_b32 v10, 16, v77
  v_and_b32 v11, 0xffff0000, v77
  v_pk_add_f32 v[18:19], v[18:19], v[10:11]
  v_lshlrev_b32 v8, 16, v78
  v_and_b32 v9, 0xffff0000, v78
  v_pk_add_f32 v[20:21], v[20:21], v[8:9]
  v_lshlrev_b32 v10, 16, v79
  v_and_b32 v11, 0xffff0000, v79
  v_pk_add_f32 v[22:23], v[22:23], v[10:11]
  s_waitcnt vmcnt(15)
  v_lshlrev_b32 v8, 16, v80
  v_and_b32 v9, 0xffff0000, v80
  v_pk_add_f32 v[16:17], v[16:17], v[8:9]
  v_lshlrev_b32 v10, 16, v81
  v_and_b32 v11, 0xffff0000, v81
  v_pk_add_f32 v[18:19], v[18:19], v[10:11]
  v_lshlrev_b32 v8, 16, v82
  v_and_b32 v9, 0xffff0000, v82
  v_pk_add_f32 v[20:21], v[20:21], v[8:9]
  v_lshlrev_b32 v10, 16, v83
  v_and_b32 v11, 0xffff0000, v83
  v_pk_add_f32 v[22:23], v[22:23], v[10:11]
  s_waitcnt vmcnt(14)
  v_lshlrev_b32 v8, 16, v84
  v_and_b32 v9, 0xffff0000, v84
  v_pk_add_f32 v[16:17], v[16:17], v[8:9]
  v_lshlrev_b32 v10, 16, v85
  v_and_b32 v11, 0xffff0000, v85
  v_pk_add_f32 v[18:19], v[18:19], v[10:11]
  v_lshlrev_b32 v8, 16, v86
  v_and_b32 v9, 0xffff0000, v86
  v_pk_add_f32 v[20:21], v[20:21], v[8:9]
  v_lshlrev_b32 v10, 16, v87
  v_and_b32 v11, 0xffff0000, v87
  v_pk_add_f32 v[22:23], v[22:23], v[10:11]
  s_waitcnt vmcnt(13)
  v_lshlrev_b32 v8, 16, v88
  v_and_b32 v9, 0xffff0000, v88
  v_pk_add_f32 v[16:17], v[16:17], v[8:9]
  v_lshlrev_b32 v10, 16, v89
  v_and_b32 v11, 0xffff0000, v89
  v_pk_add_f32 v[18:19], v[18:19], v[10:11]
  v_lshlrev_b32 v8, 16, v90
  v_and_b32 v9, 0xffff0000, v90
  v_pk_add_f32 v[20:21], v[20:21], v[8:9]
  v_lshlrev_b32 v10, 16, v91
  v_and_b32 v11, 0xffff0000, v91
  v_pk_add_f32 v[22:23], v[22:23], v[10:11]
  s_waitcnt vmcnt(12)
  v_lshlrev_b32 v8, 16, v92
  v_and_b32 v9, 0xffff0000, v92
  v_pk_add_f32 v[16:17], v[16:17], v[8:9]
  v_lshlrev_b32 v10, 16, v93
  v_and_b32 v11, 0xffff0000, v93
  v_pk_add_f32 v[18:19], v[18:19], v[10:11]
  v_lshlrev_b32 v8, 16, v94
  v_and_b32 v9, 0xffff0000, v94
  v_pk_add_f32 v[20:21], v[20:21], v[8:9]
  v_lshlrev_b32 v10, 16, v95
  v_and_b32 v11, 0xffff0000, v95
  v_pk_add_f32 v[22:23], v[22:23], v[10:11]
  s_waitcnt vmcnt(11)
  v_lshlrev_b32 v8, 16, v96
  v_and_b32 v9, 0xffff0000, v96
  v_pk_add_f32 v[16:17], v[16:17], v[8:9]
  v_lshlrev_b32 v10, 16, v97
  v_and_b32 v11, 0xffff0000, v97
  v_pk_add_f32 v[18:19], v[18:19], v[10:11]
  v_lshlrev_b32 v8, 16, v98
  v_and_b32 v9, 0xffff0000, v98
  v_pk_add_f32 v[20:21], v[20:21], v[8:9]
  v_lshlrev_b32 v10, 16, v99
  v_and_b32 v11, 0xffff0000, v99
  v_pk_add_f32 v[22:23], v[22:23], v[10:11]
  s_waitcnt vmcnt(10)
  v_lshlrev_b32 v8, 16, v100
  v_and_b32 v9, 0xffff0000, v100
  v_pk_add_f32 v[16:17], v[16:17], v[8:9]
  v_lshlrev_b32 v10, 16, v101
  v_and_b32 v11, 0xffff0000, v101
  v_pk_add_f32 v[18:19], v[18:19], v[10:11]
  v_lshlrev_b32 v8, 16, v102
  v_and_b32 v9, 0xffff0000, v102
  v_pk_add_f32 v[20:21], v[20:21], v[8:9]
  v_lshlrev_b32 v10, 16, v103
  v_and_b32 v11, 0xffff0000, v103
  v_pk_add_f32 v[22:23], v[22:23], v[10:11]
  s_waitcnt vmcnt(9)
  v_lshlrev_b32 v8, 16, v104
  v_and_b32 v9, 0xffff0000, v104
  v_pk_add_f32 v[16:17], v[16:17], v[8:9]
  v_lshlrev_b32 v10, 16, v105
  v_and_b32 v11, 0xffff0000, v105
  v_pk_add_f32 v[18:19], v[18:19], v[10:11]
  v_lshlrev_b32 v8, 16, v106
  v_and_b32 v9, 0xffff0000, v106
  v_pk_add_f32 v[20:21], v[20:21], v[8:9]
  v_lshlrev_b32 v10, 16, v107
  v_and_b32 v11, 0xffff0000, v107
  v_pk_add_f32 v[22:23], v[22:23], v[10:11]
  s_waitcnt vmcnt(8)
  v_lshlrev_b32 v8, 16, v108
  v_and_b32 v9, 0xffff0000, v108
  v_pk_add_f32 v[16:17], v[16:17], v[8:9]
  v_lshlrev_b32 v10, 16, v109
  v_and_b32 v11, 0xffff0000, v109
  v_pk_add_f32 v[18:19], v[18:19], v[10:11]
  v_lshlrev_b32 v8, 16, v110
  v_and_b32 v9, 0xffff0000, v110
  v_pk_add_f32 v[20:21], v[20:21], v[8:9]
  v_lshlrev_b32 v10, 16, v111
  v_and_b32 v11, 0xffff0000, v111
  v_pk_add_f32 v[22:23], v[22:23], v[10:11]
  s_waitcnt vmcnt(7)
  v_lshlrev_b32 v8, 16, v112
  v_and_b32 v9, 0xffff0000, v112
  v_pk_add_f32 v[16:17], v[16:17], v[8:9]
  v_lshlrev_b32 v10, 16, v113
  v_and_b32 v11, 0xffff0000, v113
  v_pk_add_f32 v[18:19], v[18:19], v[10:11]
  v_lshlrev_b32 v8, 16, v114
  v_and_b32 v9, 0xffff0000, v114
  v_pk_add_f32 v[20:21], v[20:21], v[8:9]
  v_lshlrev_b32 v10, 16, v115
  v_and_b32 v11, 0xffff0000, v115
  v_pk_add_f32 v[22:23], v[22:23], v[10:11]
  s_waitcnt vmcnt(6)
  v_lshlrev_b32 v8, 16, v116
  v_and_b32 v9, 0xffff0000, v116
  v_pk_add_f32 v[16:17], v[16:17], v[8:9]
  v_lshlrev_b32 v10, 16, v117
  v_and_b32 v11, 0xffff0000, v117
  v_pk_add_f32 v[18:19], v[18:19], v[10:11]
  v_lshlrev_b32 v8, 16, v118
  v_and_b32 v9, 0xffff0000, v118
  v_pk_add_f32 v[20:21], v[20:21], v[8:9]
  v_lshlrev_b32 v10, 16, v119
  v_and_b32 v11, 0xffff0000, v119
  v_pk_add_f32 v[22:23], v[22:23], v[10:11]
  s_waitcnt vmcnt(5)
  v_lshlrev_b32 v8, 16, v120
  v_and_b32 v9, 0xffff0000, v120
  v_pk_add_f32 v[16:17], v[16:17], v[8:9]
  v_lshlrev_b32 v10, 16, v121
  v_and_b32 v11, 0xffff0000, v121
  v_pk_add_f32 v[18:19], v[18:19], v[10:11]
  v_lshlrev_b32 v8, 16, v122
  v_and_b32 v9, 0xffff0000, v122
  v_pk_add_f32 v[20:21], v[20:21], v[8:9]
  v_lshlrev_b32 v10, 16, v123
  v_and_b32 v11, 0xffff0000, v123
  v_pk_add_f32 v[22:23], v[22:23], v[10:11]
  s_waitcnt vmcnt(4)
  v_lshlrev_b32 v8, 16, v124
  v_and_b32 v9, 0xffff0000, v124
  v_pk_add_f32 v[16:17], v[16:17], v[8:9]
  v_lshlrev_b32 v10, 16, v125
  v_and_b32 v11, 0xffff0000, v125
  v_pk_add_f32 v[18:19], v[18:19], v[10:11]
  v_lshlrev_b32 v8, 16, v126
  v_and_b32 v9, 0xffff0000, v126
  v_pk_add_f32 v[20:21], v[20:21], v[8:9]
  v_lshlrev_b32 v10, 16, v127
  v_and_b32 v11, 0xffff0000, v127
  v_pk_add_f32 v[22:23], v[22:23], v[10:11]
  s_waitcnt vmcnt(3)
  v_lshlrev_b32 v8, 16, v128
  v_and_b32 v9, 0xffff0000, v128
  v_pk_add_f32 v[16:17], v[16:17], v[8:9]
  v_lshlrev_b32 v10, 16, v129
  v_and_b32 v11, 0xffff0000, v129
  v_pk_add_f32 v[18:19], v[18:19], v[10:11]
  v_lshlrev_b32 v8, 16, v130
  v_and_b32 v9, 0xffff0000, v130
  v_pk_add_f32 v[20:21], v[20:21], v[8:9]
  v_lshlrev_b32 v10, 16, v131
  v_and_b32 v11, 0xffff0000, v131
  v_pk_add_f32 v[22:23], v[22:23], v[10:11]
  s_waitcnt vmcnt(2)
  v_lshlrev_b32 v8, 16, v132
  v_and_b32 v9, 0xffff0000, v132
  v_pk_add_f32 v[16:17], v[16:17], v[8:9]
  v_lshlrev_b32 v10, 16, v133
  v_and_b32 v11, 0xffff0000, v133
  v_pk_add_f32 v[18:19], v[18:19], v[10:11]
  v_lshlrev_b32 v8, 16, v134
  v_and_b32 v9, 0xffff0000, v134
  v_pk_add_f32 v[20:21], v[20:21], v[8:9]
  v_lshlrev_b32 v10, 16, v135
  v_and_b32 v11, 0xffff0000, v135
  v_pk_add_f32 v[22:23], v[22:23], v[10:11]
  s_waitcnt vmcnt(1)
  v_lshlrev_b32 v8, 16, v136
  v_and_b32 v9, 0xffff0000, v136
  v_pk_add_f32 v[16:17], v[16:17], v[8:9]
  v_lshlrev_b32 v10, 16, v137
  v_and_b32 v11, 0xffff0000, v137
  v_pk_add_f32 v[18:19], v[18:19], v[10:11]
  v_lshlrev_b32 v8, 16, v138
  v_and_b32 v9, 0xffff0000, v138
  v_pk_add_f32 v[20:21], v[20:21], v[8:9]
  v_lshlrev_b32 v10, 16, v139
  v_and_b32 v11, 0xffff0000, v139
  v_pk_add_f32 v[22:23], v[22:23], v[10:11]
  s_waitcnt vmcnt(0)
  v_lshlrev_b32 v8, 16, v140
  v_and_b32 v9, 0xffff0000, v140
  v_pk_add_f32 v[16:17], v[16:17], v[8:9]
  v_lshlrev_b32 v10, 16, v141
  v_and_b32 v11, 0xffff0000, v141
  v_pk_add_f32 v[18:19], v[18:19], v[10:11]
  v_lshlrev_b32 v8, 16, v142
  v_and_b32 v9, 0xffff0000, v142
  v_pk_add_f32 v[20:21], v[20:21], v[8:9]
  v_lshlrev_b32 v10, 16, v143
  v_and_b32 v11, 0xffff0000, v143
  v_pk_add_f32 v[22:23], v[22:23], v[10:11]
  v_xor_b32 v6, 16, v1
  v_lshlrev_b32 v6, 2, v6
  v_xor_b32 v7, 32, v1
  v_lshlrev_b32 v7, 2, v7
  ds_bpermute_b32 v24, v6, v16
  ds_bpermute_b32 v25, v6, v17
  ds_bpermute_b32 v26, v6, v18
  ds_bpermute_b32 v27, v6, v19
  ds_bpermute_b32 v28, v6, v20
  ds_bpermute_b32 v29, v6, v21
  ds_bpermute_b32 v30, v6, v22
  ds_bpermute_b32 v31, v6, v23
  s_waitcnt lgkmcnt(0)
  v_add_f32 v16, v16, v24
  v_add_f32 v17, v17, v25
  v_add_f32 v18, v18, v26
  v_add_f32 v19, v19, v27
  v_add_f32 v20, v20, v28
  v_add_f32 v21, v21, v29
  v_add_f32 v22, v22, v30
  v_add_f32 v23, v23, v31
  ds_bpermute_b32 v24, v7, v16
  ds_bpermute_b32 v25, v7, v17
  ds_bpermute_b32 v26, v7, v18
  ds_bpermute_b32 v27, v7, v19
  ds_bpermute_b32 v28, v7, v20
  ds_bpermute_b32 v29, v7, v21
  ds_bpermute_b32 v30, v7, v22
  ds_bpermute_b32 v31, v7, v23
  s_waitcnt lgkmcnt(0)
  v_add_f32 v16, v16, v24
  v_add_f32 v17, v17, v25
  v_add_f32 v18, v18, v26
  v_add_f32 v19, v19, v27
  v_add_f32 v20, v20, v28
  v_add_f32 v21, v21, v29
  v_add_f32 v22, v22, v30
  v_add_f32 v23, v23, v31
  s_lshl_b32 s33, s3, 9
  v_and_b32 v10, 15, v1
  v_lshlrev_b32 v10, 5, v10
  v_add_u32 v9, s33, v10
  ds_write_b128 v9, v[16:19]
  ds_write_b128 v9, v[20:23] offset:16
  s_waitcnt lgkmcnt(0)
  s_barrier
  s_cmp_ge_u32 s3, 2
  s_cbranch_scc1 main_cs83
  v_lshlrev_b32 v9, 2, v0
  ds_read_b32 v16, v9 offset:0
  ds_read_b32 v17, v9 offset:512
  ds_read_b32 v18, v9 offset:1024
  ds_read_b32 v19, v9 offset:1536
  ds_read_b32 v20, v9 offset:2048
  ds_read_b32 v21, v9 offset:2560
  ds_read_b32 v22, v9 offset:3072
  ds_read_b32 v23, v9 offset:3584
  s_waitcnt lgkmcnt(0)
  v_add_f32 v16, v16, v17
  v_add_f32 v16, v16, v18
  v_add_f32 v16, v16, v19
  v_add_f32 v16, v16, v20
  v_add_f32 v16, v16, v21
  v_add_f32 v16, v16, v22
  v_add_f32 v16, v16, v23
  s_lshl_b32 s34, s24, 9
  s_add_u32 s34, s34, 24117248
  buffer_store_dword v16, v9, s[8:11], s34 offen sc1
main_cs83:
  s_waitcnt vmcnt(0)
  s_barrier
  s_cmp_eq_u32 s3, 0
  s_cbranch_scc0 main_da84
  v_mov_b32 v61, 1
  s_mov_b64 s[44:45], exec
  s_mov_b64 exec, 1
  buffer_atomic_add v61, off, s[80:83], 0 offset:0 sc1
  s_mov_b64 exec, s[44:45]
main_da84:
  s_cmp_ge_u32 s24, 14
  s_cbranch_scc1 main_a182
  v_lshrrev_b32 v3, 4, v0
  v_and_b32 v4, 15, v0
  s_mov_b32 s32, 3456
  v_mul_lo_u32 v3, v3, s32
  v_lshlrev_b32 v4, 4, v4
  v_add_u32 v3, v3, v4
  s_lshl_b32 s33, s24, 8
  v_add_u32 v3, s33, v3
  s_mov_b32 s37, 0
  buffer_load_dwordx4 v[64:67], v3, s[20:23], s37 offen
  s_add_u32 s37, s37, 110592
  buffer_load_dwordx4 v[68:71], v3, s[20:23], s37 offen
  s_add_u32 s37, s37, 110592
  buffer_load_dwordx4 v[72:75], v3, s[20:23], s37 offen
  s_add_u32 s37, s37, 110592
  buffer_load_dwordx4 v[76:79], v3, s[20:23], s37 offen
  s_add_u32 s37, s37, 110592
  buffer_load_dwordx4 v[80:83], v3, s[20:23], s37 offen
  s_add_u32 s37, s37, 110592
  buffer_load_dwordx4 v[84:87], v3, s[20:23], s37 offen
  s_add_u32 s37, s37, 110592
  buffer_load_dwordx4 v[88:91], v3, s[20:23], s37 offen
  s_add_u32 s37, s37, 110592
  buffer_load_dwordx4 v[92:95], v3, s[20:23], s37 offen
  s_add_u32 s37, s37, 110592
  buffer_load_dwordx4 v[96:99], v3, s[20:23], s37 offen
  s_add_u32 s37, s37, 110592
  buffer_load_dwordx4 v[100:103], v3, s[20:23], s37 offen
  s_add_u32 s37, s37, 110592
  buffer_load_dwordx4 v[104:107], v3, s[20:23], s37 offen
  s_add_u32 s37, s37, 110592
  buffer_load_dwordx4 v[108:111], v3, s[20:23], s37 offen
  s_add_u32 s37, s37, 110592
  buffer_load_dwordx4 v[112:115], v3, s[20:23], s37 offen
  s_add_u32 s37, s37, 110592
  buffer_load_dwordx4 v[116:119], v3, s[20:23], s37 offen
  s_add_u32 s37, s37, 110592
  buffer_load_dwordx4 v[120:123], v3, s[20:23], s37 offen
  s_add_u32 s37, s37, 110592
  buffer_load_dwordx4 v[124:127], v3, s[20:23], s37 offen
  s_add_u32 s37, s37, 110592
  buffer_load_dwordx4 v[128:131], v3, s[20:23], s37 offen
  s_add_u32 s37, s37, 110592
  buffer_load_dwordx4 v[132:135], v3, s[20:23], s37 offen
  s_add_u32 s37, s37, 110592
  buffer_load_dwordx4 v[136:139], v3, s[20:23], s37 offen
  s_add_u32 s37, s37, 110592
  buffer_load_dwordx4 v[140:143], v3, s[20:23], s37 offen
  s_add_u32 s37, s37, 110592
  v_mov_b32 v16, 0
  v_mov_b32 v17, 0
  v_mov_b32 v18, 0
  v_mov_b32 v19, 0
  v_mov_b32 v20, 0
  v_mov_b32 v21, 0
  v_mov_b32 v22, 0
  v_mov_b32 v23, 0
  s_waitcnt vmcnt(19)
  v_lshlrev_b32 v8, 16, v64
  v_and_b32 v9, 0xffff0000, v64
  v_pk_add_f32 v[16:17], v[16:17], v[8:9]
  v_lshlrev_b32 v10, 16, v65
  v_and_b32 v11, 0xffff0000, v65
  v_pk_add_f32 v[18:19], v[18:19], v[10:11]
  v_lshlrev_b32 v8, 16, v66
  v_and_b32 v9, 0xffff0000, v66
  v_pk_add_f32 v[20:21], v[20:21], v[8:9]
  v_lshlrev_b32 v10, 16, v67
  v_and_b32 v11, 0xffff0000, v67
  v_pk_add_f32 v[22:23], v[22:23], v[10:11]
  s_waitcnt vmcnt(18)
  v_lshlrev_b32 v8, 16, v68
  v_and_b32 v9, 0xffff0000, v68
  v_pk_add_f32 v[16:17], v[16:17], v[8:9]
  v_lshlrev_b32 v10, 16, v69
  v_and_b32 v11, 0xffff0000, v69
  v_pk_add_f32 v[18:19], v[18:19], v[10:11]
  v_lshlrev_b32 v8, 16, v70
  v_and_b32 v9, 0xffff0000, v70
  v_pk_add_f32 v[20:21], v[20:21], v[8:9]
  v_lshlrev_b32 v10, 16, v71
  v_and_b32 v11, 0xffff0000, v71
  v_pk_add_f32 v[22:23], v[22:23], v[10:11]
  s_waitcnt vmcnt(17)
  v_lshlrev_b32 v8, 16, v72
  v_and_b32 v9, 0xffff0000, v72
  v_pk_add_f32 v[16:17], v[16:17], v[8:9]
  v_lshlrev_b32 v10, 16, v73
  v_and_b32 v11, 0xffff0000, v73
  v_pk_add_f32 v[18:19], v[18:19], v[10:11]
  v_lshlrev_b32 v8, 16, v74
  v_and_b32 v9, 0xffff0000, v74
  v_pk_add_f32 v[20:21], v[20:21], v[8:9]
  v_lshlrev_b32 v10, 16, v75
  v_and_b32 v11, 0xffff0000, v75
  v_pk_add_f32 v[22:23], v[22:23], v[10:11]
  s_waitcnt vmcnt(16)
  v_lshlrev_b32 v8, 16, v76
  v_and_b32 v9, 0xffff0000, v76
  v_pk_add_f32 v[16:17], v[16:17], v[8:9]
  v_lshlrev_b32 v10, 16, v77
  v_and_b32 v11, 0xffff0000, v77
  v_pk_add_f32 v[18:19], v[18:19], v[10:11]
  v_lshlrev_b32 v8, 16, v78
  v_and_b32 v9, 0xffff0000, v78
  v_pk_add_f32 v[20:21], v[20:21], v[8:9]
  v_lshlrev_b32 v10, 16, v79
  v_and_b32 v11, 0xffff0000, v79
  v_pk_add_f32 v[22:23], v[22:23], v[10:11]
  s_waitcnt vmcnt(15)
  v_lshlrev_b32 v8, 16, v80
  v_and_b32 v9, 0xffff0000, v80
  v_pk_add_f32 v[16:17], v[16:17], v[8:9]
  v_lshlrev_b32 v10, 16, v81
  v_and_b32 v11, 0xffff0000, v81
  v_pk_add_f32 v[18:19], v[18:19], v[10:11]
  v_lshlrev_b32 v8, 16, v82
  v_and_b32 v9, 0xffff0000, v82
  v_pk_add_f32 v[20:21], v[20:21], v[8:9]
  v_lshlrev_b32 v10, 16, v83
  v_and_b32 v11, 0xffff0000, v83
  v_pk_add_f32 v[22:23], v[22:23], v[10:11]
  s_waitcnt vmcnt(14)
  v_lshlrev_b32 v8, 16, v84
  v_and_b32 v9, 0xffff0000, v84
  v_pk_add_f32 v[16:17], v[16:17], v[8:9]
  v_lshlrev_b32 v10, 16, v85
  v_and_b32 v11, 0xffff0000, v85
  v_pk_add_f32 v[18:19], v[18:19], v[10:11]
  v_lshlrev_b32 v8, 16, v86
  v_and_b32 v9, 0xffff0000, v86
  v_pk_add_f32 v[20:21], v[20:21], v[8:9]
  v_lshlrev_b32 v10, 16, v87
  v_and_b32 v11, 0xffff0000, v87
  v_pk_add_f32 v[22:23], v[22:23], v[10:11]
  s_waitcnt vmcnt(13)
  v_lshlrev_b32 v8, 16, v88
  v_and_b32 v9, 0xffff0000, v88
  v_pk_add_f32 v[16:17], v[16:17], v[8:9]
  v_lshlrev_b32 v10, 16, v89
  v_and_b32 v11, 0xffff0000, v89
  v_pk_add_f32 v[18:19], v[18:19], v[10:11]
  v_lshlrev_b32 v8, 16, v90
  v_and_b32 v9, 0xffff0000, v90
  v_pk_add_f32 v[20:21], v[20:21], v[8:9]
  v_lshlrev_b32 v10, 16, v91
  v_and_b32 v11, 0xffff0000, v91
  v_pk_add_f32 v[22:23], v[22:23], v[10:11]
  s_waitcnt vmcnt(12)
  v_lshlrev_b32 v8, 16, v92
  v_and_b32 v9, 0xffff0000, v92
  v_pk_add_f32 v[16:17], v[16:17], v[8:9]
  v_lshlrev_b32 v10, 16, v93
  v_and_b32 v11, 0xffff0000, v93
  v_pk_add_f32 v[18:19], v[18:19], v[10:11]
  v_lshlrev_b32 v8, 16, v94
  v_and_b32 v9, 0xffff0000, v94
  v_pk_add_f32 v[20:21], v[20:21], v[8:9]
  v_lshlrev_b32 v10, 16, v95
  v_and_b32 v11, 0xffff0000, v95
  v_pk_add_f32 v[22:23], v[22:23], v[10:11]
  s_waitcnt vmcnt(11)
  v_lshlrev_b32 v8, 16, v96
  v_and_b32 v9, 0xffff0000, v96
  v_pk_add_f32 v[16:17], v[16:17], v[8:9]
  v_lshlrev_b32 v10, 16, v97
  v_and_b32 v11, 0xffff0000, v97
  v_pk_add_f32 v[18:19], v[18:19], v[10:11]
  v_lshlrev_b32 v8, 16, v98
  v_and_b32 v9, 0xffff0000, v98
  v_pk_add_f32 v[20:21], v[20:21], v[8:9]
  v_lshlrev_b32 v10, 16, v99
  v_and_b32 v11, 0xffff0000, v99
  v_pk_add_f32 v[22:23], v[22:23], v[10:11]
  s_waitcnt vmcnt(10)
  v_lshlrev_b32 v8, 16, v100
  v_and_b32 v9, 0xffff0000, v100
  v_pk_add_f32 v[16:17], v[16:17], v[8:9]
  v_lshlrev_b32 v10, 16, v101
  v_and_b32 v11, 0xffff0000, v101
  v_pk_add_f32 v[18:19], v[18:19], v[10:11]
  v_lshlrev_b32 v8, 16, v102
  v_and_b32 v9, 0xffff0000, v102
  v_pk_add_f32 v[20:21], v[20:21], v[8:9]
  v_lshlrev_b32 v10, 16, v103
  v_and_b32 v11, 0xffff0000, v103
  v_pk_add_f32 v[22:23], v[22:23], v[10:11]
  s_waitcnt vmcnt(9)
  v_lshlrev_b32 v8, 16, v104
  v_and_b32 v9, 0xffff0000, v104
  v_pk_add_f32 v[16:17], v[16:17], v[8:9]
  v_lshlrev_b32 v10, 16, v105
  v_and_b32 v11, 0xffff0000, v105
  v_pk_add_f32 v[18:19], v[18:19], v[10:11]
  v_lshlrev_b32 v8, 16, v106
  v_and_b32 v9, 0xffff0000, v106
  v_pk_add_f32 v[20:21], v[20:21], v[8:9]
  v_lshlrev_b32 v10, 16, v107
  v_and_b32 v11, 0xffff0000, v107
  v_pk_add_f32 v[22:23], v[22:23], v[10:11]
  s_waitcnt vmcnt(8)
  v_lshlrev_b32 v8, 16, v108
  v_and_b32 v9, 0xffff0000, v108
  v_pk_add_f32 v[16:17], v[16:17], v[8:9]
  v_lshlrev_b32 v10, 16, v109
  v_and_b32 v11, 0xffff0000, v109
  v_pk_add_f32 v[18:19], v[18:19], v[10:11]
  v_lshlrev_b32 v8, 16, v110
  v_and_b32 v9, 0xffff0000, v110
  v_pk_add_f32 v[20:21], v[20:21], v[8:9]
  v_lshlrev_b32 v10, 16, v111
  v_and_b32 v11, 0xffff0000, v111
  v_pk_add_f32 v[22:23], v[22:23], v[10:11]
  s_waitcnt vmcnt(7)
  v_lshlrev_b32 v8, 16, v112
  v_and_b32 v9, 0xffff0000, v112
  v_pk_add_f32 v[16:17], v[16:17], v[8:9]
  v_lshlrev_b32 v10, 16, v113
  v_and_b32 v11, 0xffff0000, v113
  v_pk_add_f32 v[18:19], v[18:19], v[10:11]
  v_lshlrev_b32 v8, 16, v114
  v_and_b32 v9, 0xffff0000, v114
  v_pk_add_f32 v[20:21], v[20:21], v[8:9]
  v_lshlrev_b32 v10, 16, v115
  v_and_b32 v11, 0xffff0000, v115
  v_pk_add_f32 v[22:23], v[22:23], v[10:11]
  s_waitcnt vmcnt(6)
  v_lshlrev_b32 v8, 16, v116
  v_and_b32 v9, 0xffff0000, v116
  v_pk_add_f32 v[16:17], v[16:17], v[8:9]
  v_lshlrev_b32 v10, 16, v117
  v_and_b32 v11, 0xffff0000, v117
  v_pk_add_f32 v[18:19], v[18:19], v[10:11]
  v_lshlrev_b32 v8, 16, v118
  v_and_b32 v9, 0xffff0000, v118
  v_pk_add_f32 v[20:21], v[20:21], v[8:9]
  v_lshlrev_b32 v10, 16, v119
  v_and_b32 v11, 0xffff0000, v119
  v_pk_add_f32 v[22:23], v[22:23], v[10:11]
  s_waitcnt vmcnt(5)
  v_lshlrev_b32 v8, 16, v120
  v_and_b32 v9, 0xffff0000, v120
  v_pk_add_f32 v[16:17], v[16:17], v[8:9]
  v_lshlrev_b32 v10, 16, v121
  v_and_b32 v11, 0xffff0000, v121
  v_pk_add_f32 v[18:19], v[18:19], v[10:11]
  v_lshlrev_b32 v8, 16, v122
  v_and_b32 v9, 0xffff0000, v122
  v_pk_add_f32 v[20:21], v[20:21], v[8:9]
  v_lshlrev_b32 v10, 16, v123
  v_and_b32 v11, 0xffff0000, v123
  v_pk_add_f32 v[22:23], v[22:23], v[10:11]
  s_waitcnt vmcnt(4)
  v_lshlrev_b32 v8, 16, v124
  v_and_b32 v9, 0xffff0000, v124
  v_pk_add_f32 v[16:17], v[16:17], v[8:9]
  v_lshlrev_b32 v10, 16, v125
  v_and_b32 v11, 0xffff0000, v125
  v_pk_add_f32 v[18:19], v[18:19], v[10:11]
  v_lshlrev_b32 v8, 16, v126
  v_and_b32 v9, 0xffff0000, v126
  v_pk_add_f32 v[20:21], v[20:21], v[8:9]
  v_lshlrev_b32 v10, 16, v127
  v_and_b32 v11, 0xffff0000, v127
  v_pk_add_f32 v[22:23], v[22:23], v[10:11]
  s_waitcnt vmcnt(3)
  v_lshlrev_b32 v8, 16, v128
  v_and_b32 v9, 0xffff0000, v128
  v_pk_add_f32 v[16:17], v[16:17], v[8:9]
  v_lshlrev_b32 v10, 16, v129
  v_and_b32 v11, 0xffff0000, v129
  v_pk_add_f32 v[18:19], v[18:19], v[10:11]
  v_lshlrev_b32 v8, 16, v130
  v_and_b32 v9, 0xffff0000, v130
  v_pk_add_f32 v[20:21], v[20:21], v[8:9]
  v_lshlrev_b32 v10, 16, v131
  v_and_b32 v11, 0xffff0000, v131
  v_pk_add_f32 v[22:23], v[22:23], v[10:11]
  s_waitcnt vmcnt(2)
  v_lshlrev_b32 v8, 16, v132
  v_and_b32 v9, 0xffff0000, v132
  v_pk_add_f32 v[16:17], v[16:17], v[8:9]
  v_lshlrev_b32 v10, 16, v133
  v_and_b32 v11, 0xffff0000, v133
  v_pk_add_f32 v[18:19], v[18:19], v[10:11]
  v_lshlrev_b32 v8, 16, v134
  v_and_b32 v9, 0xffff0000, v134
  v_pk_add_f32 v[20:21], v[20:21], v[8:9]
  v_lshlrev_b32 v10, 16, v135
  v_and_b32 v11, 0xffff0000, v135
  v_pk_add_f32 v[22:23], v[22:23], v[10:11]
  s_waitcnt vmcnt(1)
  v_lshlrev_b32 v8, 16, v136
  v_and_b32 v9, 0xffff0000, v136
  v_pk_add_f32 v[16:17], v[16:17], v[8:9]
  v_lshlrev_b32 v10, 16, v137
  v_and_b32 v11, 0xffff0000, v137
  v_pk_add_f32 v[18:19], v[18:19], v[10:11]
  v_lshlrev_b32 v8, 16, v138
  v_and_b32 v9, 0xffff0000, v138
  v_pk_add_f32 v[20:21], v[20:21], v[8:9]
  v_lshlrev_b32 v10, 16, v139
  v_and_b32 v11, 0xffff0000, v139
  v_pk_add_f32 v[22:23], v[22:23], v[10:11]
  s_waitcnt vmcnt(0)
  v_lshlrev_b32 v8, 16, v140
  v_and_b32 v9, 0xffff0000, v140
  v_pk_add_f32 v[16:17], v[16:17], v[8:9]
  v_lshlrev_b32 v10, 16, v141
  v_and_b32 v11, 0xffff0000, v141
  v_pk_add_f32 v[18:19], v[18:19], v[10:11]
  v_lshlrev_b32 v8, 16, v142
  v_and_b32 v9, 0xffff0000, v142
  v_pk_add_f32 v[20:21], v[20:21], v[8:9]
  v_lshlrev_b32 v10, 16, v143
  v_and_b32 v11, 0xffff0000, v143
  v_pk_add_f32 v[22:23], v[22:23], v[10:11]
  v_xor_b32 v6, 16, v1
  v_lshlrev_b32 v6, 2, v6
  v_xor_b32 v7, 32, v1
  v_lshlrev_b32 v7, 2, v7
  ds_bpermute_b32 v24, v6, v16
  ds_bpermute_b32 v25, v6, v17
  ds_bpermute_b32 v26, v6, v18
  ds_bpermute_b32 v27, v6, v19
  ds_bpermute_b32 v28, v6, v20
  ds_bpermute_b32 v29, v6, v21
  ds_bpermute_b32 v30, v6, v22
  ds_bpermute_b32 v31, v6, v23
  s_waitcnt lgkmcnt(0)
  v_add_f32 v16, v16, v24
  v_add_f32 v17, v17, v25
  v_add_f32 v18, v18, v26
  v_add_f32 v19, v19, v27
  v_add_f32 v20, v20, v28
  v_add_f32 v21, v21, v29
  v_add_f32 v22, v22, v30
  v_add_f32 v23, v23, v31
  ds_bpermute_b32 v24, v7, v16
  ds_bpermute_b32 v25, v7, v17
  ds_bpermute_b32 v26, v7, v18
  ds_bpermute_b32 v27, v7, v19
  ds_bpermute_b32 v28, v7, v20
  ds_bpermute_b32 v29, v7, v21
  ds_bpermute_b32 v30, v7, v22
  ds_bpermute_b32 v31, v7, v23
  s_waitcnt lgkmcnt(0)
  v_add_f32 v16, v16, v24
  v_add_f32 v17, v17, v25
  v_add_f32 v18, v18, v26
  v_add_f32 v19, v19, v27
  v_add_f32 v20, v20, v28
  v_add_f32 v21, v21, v29
  v_add_f32 v22, v22, v30
  v_add_f32 v23, v23, v31
  s_lshl_b32 s33, s3, 9
  v_and_b32 v10, 15, v1
  v_lshlrev_b32 v10, 5, v10
  v_add_u32 v9, s33, v10
  ds_write_b128 v9, v[16:19]
  ds_write_b128 v9, v[20:23] offset:16
  s_waitcnt lgkmcnt(0)
  s_barrier
  s_cmp_ge_u32 s3, 2
  s_cbranch_scc1 main_cs85
  v_lshlrev_b32 v9, 2, v0
  ds_read_b32 v16, v9 offset:0
  ds_read_b32 v17, v9 offset:512
  ds_read_b32 v18, v9 offset:1024
  ds_read_b32 v19, v9 offset:1536
  ds_read_b32 v20, v9 offset:2048
  ds_read_b32 v21, v9 offset:2560
  ds_read_b32 v22, v9 offset:3072
  ds_read_b32 v23, v9 offset:3584
  s_waitcnt lgkmcnt(0)
  v_add_f32 v16, v16, v17
  v_add_f32 v16, v16, v18
  v_add_f32 v16, v16, v19
  v_add_f32 v16, v16, v20
  v_add_f32 v16, v16, v21
  v_add_f32 v16, v16, v22
  v_add_f32 v16, v16, v23
  s_lshl_b32 s34, s24, 9
  s_add_u32 s34, s34, 24125440
  buffer_store_dword v16, v9, s[8:11], s34 offen sc1
main_cs85:
main_a182:
  s_waitcnt vmcnt(0)
  s_barrier
  s_cmp_eq_u32 s3, 0
  s_cbranch_scc0 main_da86
  v_mov_b32 v61, 1
  s_mov_b64 s[44:45], exec
  s_mov_b64 exec, 1
  buffer_atomic_add v61, off, s[80:83], 0 offset:128 sc1
  s_mov_b64 exec, s[44:45]
main_da86:
  s_branch main_qkv1_end
main_az81:
  s_waitcnt vmcnt(0)
  s_barrier
  s_cmp_eq_u32 s3, 0
  s_cbranch_scc0 main_da87
  v_mov_b32 v61, 1
  s_mov_b64 s[44:45], exec
  s_mov_b64 exec, 1
  buffer_atomic_add v61, off, s[80:83], 0 offset:0 sc1
  buffer_atomic_add v61, off, s[80:83], 0 offset:128 sc1
  s_mov_b64 exec, s[44:45]
main_da87:
  s_branch main_qkv1_end
main_sk28:
  s_nop 7
  s_nop 7
  s_branch main_nx29
main_sk30:
  s_nop 7
  s_nop 7
  s_branch main_nx31
main_sk32:
  s_nop 7
  s_nop 7
  s_branch main_nx33
main_sk34:
  s_nop 7
  s_nop 7
  s_branch main_nx35
main_sk36:
  s_nop 7
  s_nop 7
  s_branch main_nx37
main_sk38:
  s_nop 7
  s_nop 7
  s_branch main_nx39
main_sk40:
  s_nop 7
  s_nop 7
  s_branch main_nx41
main_sk43:
  s_nop 7
  s_nop 7
  s_branch main_nx44
main_sk45:
  s_nop 7
  s_nop 7
  s_branch main_nx46
main_sk47:
  s_nop 7
  s_nop 7
  s_branch main_nx48
main_sk49:
  s_nop 7
  s_nop 7
  s_branch main_nx50
main_sk51:
  s_nop 7
  s_nop 7
  s_branch main_nx52
main_sk53:
  s_nop 7
  s_nop 7
  s_branch main_nx54
main_sk55:
  s_nop 7
  s_nop 7
  s_branch main_nx56
.section .rodata,"a"
.p2align 6
.amdhsa_kernel main_kernel
  .amdhsa_next_free_vgpr 256
  .amdhsa_next_free_sgpr 102
  .amdhsa_accum_offset 256
  .amdhsa_group_segment_fixed_size 0
  .amdhsa_kernarg_size 88
  .amdhsa_user_sgpr_count 2
  .amdhsa_user_sgpr_kernarg_segment_ptr 1
  .amdhsa_system_sgpr_workgroup_id_x 1
.end_amdhsa_kernel
```
